```python
import torch

def _softmax(x, axis=-1):
    return torch.softmax(x, dim=axis)
def _gelu(x):
    return torch.nn.functional.gelu(x, approximate="tanh")
def _silu(x):
    return torch.nn.functional.silu(x)
def _sigmoid(x):
    return torch.sigmoid(x)
def _layernorm(x, axis=-1, eps=1e-5):
    m = x.mean(dim=axis, keepdim=True)
    v = x.var(dim=axis, keepdim=True, unbiased=False)
    return (x - m) / torch.sqrt(v + eps)
def _scatter_add(tgt, idx, src, axis=0):
    return tgt.clone().index_add_(axis, idx, src)
def _segment_sum(src, seg, n):
    out = torch.zeros((n,) + src.shape[1:], dtype=src.dtype)
    return out.index_add_(0, seg, src)
def _pad(x, pw):
    flat = tuple(v for pair in reversed(pw) for v in pair)
    return torch.nn.functional.pad(x, flat)

kernel_name = 'standalone__mha_block_cached__near_ridge'

def setup_inputs():

    _w = (lambda a: (lambda t: t.to(torch.bfloat16) if t.is_floating_point() else t)(torch.as_tensor(a)))
    B, Sq, D = 8, 240, 512
    H, Sk, Dh = 32, 1024, 128
    return {
        "x": _w((lambda *s: torch.randn(*s, dtype=torch.bfloat16) * 0.8)(B, Sq, D)),
        "k_cache": _w((lambda *s: torch.randn(*s, dtype=torch.bfloat16) * 0.8)(B, H, Sk, Dh)),
        "v_cache": _w((lambda *s: torch.randn(*s, dtype=torch.bfloat16) * 0.05)(B, H, Sk, Dh)),
        "wq": _w((lambda *s: torch.randn(*s, dtype=torch.bfloat16) * 0.8)(D, H * Dh) * (D ** -0.5)),
        "wo": _w((lambda *s: torch.randn(*s, dtype=torch.bfloat16) * 0.05)(H * Dh, D) * ((H * Dh) ** -0.5)),
    }

def reference(x, k_cache, v_cache, wq, wo):
    B, Sq, D = x.shape
    H, Dh = 32, 128
    q = (lambda x, *d: x.permute(*d))((x @ wq).reshape(B, Sq, H, Dh), 0, 2, 1, 3)
    scores = torch.einsum("bhqd,bhkd->bhqk", q, k_cache) * (Dh ** -0.5)
    p = _softmax(scores, axis=-1)
    o = torch.einsum("bhqk,bhkd->bhqd", p, v_cache)
    return (lambda x, *d: x.permute(*d))(o, 0, 2, 1, 3).reshape(B, Sq, H * Dh) @ wo
```

```asm
; @launch grid=(256,1,1) block=(256,1,1) lds=163840
.amdgcn_target "amdgcn-amd-amdhsa--gfx950"
.text
.globl standalone__mha_block_cached__near_ridge_kernel
.p2align 8
.type standalone__mha_block_cached__near_ridge_kernel,@function
standalone__mha_block_cached__near_ridge_kernel:
    s_cmp_ge_u32 s2, 256
    s_cbranch_scc1 L_end
    s_load_dwordx16 s[4:19], s[0:1], 0
    v_lshrrev_b32 v1, 6, v0
    v_and_b32 v2, 63, v0
    v_readfirstlane_b32 s40, v1

    s_getpc_b64 s[28:29]
L_pc:
    s_mov_b32 s30, L_codeend-L_pc
    s_mov_b32 s31, 0x20000
    s_lshr_b32 s3, s2, 3
    s_lshl_b32 s3, s3, 9
    v_lshlrev_b32 v9, 14, v2
    v_lshl_add_u32 v9, v1, 7, v9
    buffer_load_dword v255, v9, s[28:31], s3 offen
    s_and_b32 s3, s2, 1
    s_lshl_b32 s3, s3, 2
    s_bfe_u32 s41, s2, 0x20003
    s_lshl_b32 s68, s41, 0
    s_add_u32 s41, s41, s3
    s_bfe_u32 s3, s2, 0x20001
    s_lshl_b32 s3, s3, 3
    s_lshr_b32 s42, s2, 5
    s_add_u32 s68, s68, s42
    s_add_u32 s42, s42, s3
    s_and_b32 s68, s68, 7
    s_mul_i32 s68, s68, 1

    s_lshl_b32 s63, s40, 13
    s_lshl_b32 s64, s40, 12
    v_lshrrev_b32 v3, 4, v2
    v_and_b32 v4, 15, v2
    v_lshrrev_b32 v7, 3, v2
    v_and_b32 v8, 7, v2

    v_lshlrev_b32 v10, 1, v3
    v_xor_b32 v10, v10, v4
    v_lshlrev_b32 v13, 4, v10
    v_lshl_add_u32 v240, v3, 13, v13
    v_xor_b32 v241, 0x80, v240
    v_xor_b32 v10, v3, v8
    v_lshlrev_b32 v10, 4, v10
    v_lshl_add_u32 v46, v7, 10, v10
    v_xor_b32 v47, 64, v46
    s_lshl_b32 s44, s40, 16
    s_movk_i32 s3, 7168
    s_add_u32 s48, s44, 0x8000
    s_add_u32 s45, s44, s3
    s_add_u32 s46, s45, s3
    s_add_u32 s47, s46, s3
    s_add_u32 s49, s48, s3
    s_add_u32 s50, s49, s3
    s_add_u32 s51, s50, s3
    s_lshl_b32 s52, s40, 17
    s_movk_i32 s3, 31744
    s_add_u32 s53, s52, s3
    s_add_u32 s54, s53, s3
    s_add_u32 s55, s54, s3
    s_mul_i32 s65, s41, 245760
    s_lshl_b32 s66, s42, 8
    s_mov_b32 s22, 244864
    s_mov_b32 s23, 0x20000
    s_mov_b32 s26, 516352
    s_mov_b32 s27, 0x20000
    s_waitcnt lgkmcnt(0)
    s_add_u32 s4, s4, s65
    s_addc_u32 s5, s5, 0
    s_add_u32 s10, s10, s66
    s_addc_u32 s11, s11, 0

    s_lshl_b32 s69, s68, 7
    s_add_u32 s20, s4, s69
    s_addc_u32 s21, s5, 0
    s_lshl_b32 s69, s68, 19
    s_add_u32 s24, s10, s69
    s_addc_u32 s25, s11, 0
    s_add_u32 m0, s64, 114688
    s_nop 0
    buffer_load_dwordx4 v240, s[24:27], s52 offen offset:0 lds
    buffer_load_dwordx4 v240, s[24:27], s53 offen offset:1024 lds
    buffer_load_dwordx4 v241, s[24:27], s54 offen offset:2048 lds
    buffer_load_dwordx4 v241, s[24:27], s55 offen offset:3072 lds
    s_add_u32 m0, s63, 32768
    s_nop 0
    buffer_load_dwordx4 v46, s[20:23], s44 offen offset:0 lds
    buffer_load_dwordx4 v47, s[20:23], s45 offen offset:1024 lds
    buffer_load_dwordx4 v46, s[20:23], s46 offen offset:2048 lds
    buffer_load_dwordx4 v47, s[20:23], s47 offen offset:3072 lds
    s_add_u32 m0, s63, 36864
    s_nop 0
    buffer_load_dwordx4 v46, s[20:23], s48 offen offset:0 lds
    buffer_load_dwordx4 v47, s[20:23], s49 offen offset:1024 lds
    buffer_load_dwordx4 v46, s[20:23], s50 offen offset:2048 lds
    buffer_load_dwordx4 v47, s[20:23], s51 offen offset:3072 lds
    s_add_u32 s68, s68, 1
    s_and_b32 s68, s68, 7
    s_lshl_b32 s69, s68, 7
    s_add_u32 s20, s4, s69
    s_addc_u32 s21, s5, 0
    s_lshl_b32 s69, s68, 19
    s_add_u32 s24, s10, s69
    s_addc_u32 s25, s11, 0
    s_mov_b32 s88, s16
    s_mov_b32 s89, s17
    s_mov_b32 s90, 256
    s_mov_b32 s91, 0x20000
    s_lshl_b32 s3, s2, 2
    s_or_b32 s3, s3, s40
    s_cmp_lg_u32 s3, 0
    s_cbranch_scc1 L_notag
    s_memrealtime s[66:67]
    v_mov_b32 v9, 0
    s_waitcnt lgkmcnt(0)
    s_bitset1_b32 s67, 31
    v_mov_b32 v10, s66
    v_mov_b32 v11, s67
    buffer_store_dwordx2 v[10:11], v9, s[88:91], 0 offen sc1
L_notag:
    s_lshl_b32 s3, s41, 5
    s_add_u32 s3, s3, s42
    s_lshl_b32 s3, s3, 18
    s_add_u32 s6, s6, s3
    s_addc_u32 s7, s7, 0
    s_add_u32 s8, s8, s3
    s_addc_u32 s9, s9, 0

    s_mov_b32 s28, s6
    s_mov_b32 s29, s7
    s_mov_b32 s30, 262144
    s_mov_b32 s31, 0x20000
    s_mov_b32 s32, s8
    s_mov_b32 s33, s9
    s_mov_b32 s34, 262144
    s_mov_b32 s35, 0x20000
    v_add_u32 v9, 0, v3
    v_xor_b32 v9, v9, v4
    v_lshlrev_b32 v9, 4, v9
    v_lshl_add_u32 v28, v3, 8, v9
    v_add_u32 v9, 4, v3
    v_xor_b32 v9, v9, v4
    v_lshlrev_b32 v9, 4, v9
    v_lshl_add_u32 v29, v3, 8, v9
    v_add_u32 v9, 8, v3
    v_xor_b32 v9, v9, v4
    v_lshlrev_b32 v9, 4, v9
    v_lshl_add_u32 v30, v3, 8, v9
    v_add_u32 v9, 12, v3
    v_xor_b32 v9, v9, v4
    v_lshlrev_b32 v9, 4, v9
    v_lshl_add_u32 v31, v3, 8, v9
    v_add_u32 v9, 0, v3
    v_lshlrev_b32 v9, 1, v9
    v_xor_b32 v9, v9, v4
    v_lshlrev_b32 v9, 4, v9
    v_lshl_add_u32 v32, v3, 8, v9
    v_mov_b32 v34, v32
    v_add_u32 v9, 4, v3
    v_lshlrev_b32 v9, 1, v9
    v_xor_b32 v9, v9, v4
    v_lshlrev_b32 v9, 4, v9
    v_lshl_add_u32 v33, v3, 8, v9
    v_mov_b32 v35, v33
    s_lshl_b32 s3, s41, 2
    s_add_u32 s3, s3, s40
    s_lshl_b32 s3, s3, 5
    s_add_u32 s3, s3, s42
    s_lshl_b32 s3, s3, 14
    s_add_u32 s66, s18, s3
    s_addc_u32 s67, s19, 0

    s_mov_b32 s36, s66
    s_mov_b32 s37, s67
    s_mov_b32 s38, 16384
    s_mov_b32 s39, 0x20000
    s_add_u32 s66, s18, 16777216
    s_addc_u32 s67, s19, 0
    s_mov_b32 s84, s66
    s_mov_b32 s85, s67
    s_mov_b32 s86, 131072
    s_mov_b32 s87, 0x20000
    s_lshr_b32 s93, s42, 3
    s_and_b32 s95, s42, 1
    s_bfe_u32 s94, s42, 0x20001
    s_lshl_b32 s3, s93, 20
    s_lshl_b32 s65, s94, 8
    s_add_u32 s3, s3, s65
    s_add_u32 s66, s12, s3
    s_addc_u32 s67, s13, 0

    s_mov_b32 s80, s66
    s_mov_b32 s81, s67
    s_mov_b32 s82, 1047808
    s_mov_b32 s83, 0x20000
    s_add_u32 s3, s94, 0
    s_and_b32 s3, s3, 3
    s_lshl_b32 s96, s3, 15
    s_add_u32 s3, s94, 1
    s_and_b32 s3, s3, 3
    s_lshl_b32 s97, s3, 15
    s_add_u32 s3, s94, 2
    s_and_b32 s3, s3, 3
    s_lshl_b32 s98, s3, 15
    s_add_u32 s3, s94, 3
    s_and_b32 s3, s3, 3
    s_lshl_b32 s99, s3, 15
    v_bfe_u32 v5, v2, 2, 2
    v_and_b32 v6, 3, v2
    v_lshl_add_u32 v254, v3, 10, v13
    v_add_u32 v9, 0, v3
    v_xor_b32 v9, v9, v4
    v_lshlrev_b32 v9, 4, v9
    v_lshl_add_u32 v16, v4, 8, v9
    v_add_u32 v9, 4, v3
    v_xor_b32 v9, v9, v4
    v_lshlrev_b32 v9, 4, v9
    v_lshl_add_u32 v17, v4, 8, v9
    v_add_u32 v9, 8, v3
    v_xor_b32 v9, v9, v4
    v_lshlrev_b32 v9, 4, v9
    v_lshl_add_u32 v18, v4, 8, v9
    v_add_u32 v9, 12, v3
    v_xor_b32 v9, v9, v4
    v_lshlrev_b32 v9, 4, v9
    v_lshl_add_u32 v19, v4, 8, v9
    v_lshl_add_u32 v11, v3, 2, v5
    v_and_b32 v12, 7, v11
    v_lshlrev_b32 v13, 3, v6
    v_lshl_add_u32 v11, v11, 8, v13
    v_add_u32 v11, 0x10000, v11
    v_xor_b32 v9, 0, v12
    v_lshl_add_u32 v20, v9, 5, v11
    v_xor_b32 v9, 1, v12
    v_lshl_add_u32 v21, v9, 5, v11
    v_xor_b32 v9, 2, v12
    v_lshl_add_u32 v22, v9, 5, v11
    v_xor_b32 v9, 3, v12
    v_lshl_add_u32 v23, v9, 5, v11
    v_xor_b32 v9, 4, v12
    v_lshl_add_u32 v24, v9, 5, v11
    v_xor_b32 v9, 5, v12
    v_lshl_add_u32 v25, v9, 5, v11
    v_xor_b32 v9, 6, v12
    v_lshl_add_u32 v26, v9, 5, v11
    v_xor_b32 v9, 7, v12
    v_lshl_add_u32 v27, v9, 5, v11
    v_lshl_add_u32 v11, v3, 3, v5
    v_and_b32 v9, 1, v6
    v_lshlrev_b32 v9, 4, v9
    v_lshl_add_u32 v11, v11, 8, v9
    v_add_u32 v11, 114688, v11
    v_and_b32 v12, 1, v3
    v_lshl_add_u32 v12, v12, 2, v5
    v_lshrrev_b32 v9, 1, v6
    v_xor_b32 v12, v12, v9
    v_xor_b32 v9, 0, v12
    v_lshl_add_u32 v38, v9, 5, v11
    v_xor_b32 v9, 2, v12
    v_lshl_add_u32 v39, v9, 5, v11
    v_xor_b32 v9, 4, v12
    v_lshl_add_u32 v40, v9, 5, v11
    v_xor_b32 v9, 6, v12
    v_lshl_add_u32 v41, v9, 5, v11
    v_lshrrev_b32 v12, 1, v4
    s_add_u32 s3, s63, 32768
    v_lshlrev_b32 v11, 7, v4
    v_add_u32 v11, s3, v11
    v_add_u32 v9, 0, v3
    v_xor_b32 v9, v9, v12
    v_lshl_add_u32 v36, v9, 4, v11
    v_add_u32 v9, 4, v3
    v_xor_b32 v9, v9, v12
    v_lshl_add_u32 v37, v9, 4, v11
    v_lshlrev_b32 v15, 4, v2
    s_mov_b32 s62, 0
    v_mov_b32 v14, 0x3f803f80
    s_add_u32 m0, s64, 98304
    s_nop 0
    buffer_load_dwordx4 v240, s[24:27], s52 offen offset:0 lds
    buffer_load_dwordx4 v240, s[24:27], s53 offen offset:1024 lds
    buffer_load_dwordx4 v241, s[24:27], s54 offen offset:2048 lds
    buffer_load_dwordx4 v241, s[24:27], s55 offen offset:3072 lds
    s_add_u32 m0, s63, 131072
    s_nop 0
    buffer_load_dwordx4 v46, s[20:23], s44 offen offset:0 lds
    buffer_load_dwordx4 v47, s[20:23], s45 offen offset:1024 lds
    buffer_load_dwordx4 v46, s[20:23], s46 offen offset:2048 lds
    buffer_load_dwordx4 v47, s[20:23], s47 offen offset:3072 lds
    s_add_u32 m0, s63, 135168
    s_nop 0
    buffer_load_dwordx4 v46, s[20:23], s48 offen offset:0 lds
    buffer_load_dwordx4 v47, s[20:23], s49 offen offset:1024 lds
    buffer_load_dwordx4 v46, s[20:23], s50 offen offset:2048 lds
    buffer_load_dwordx4 v47, s[20:23], s51 offen offset:3072 lds
    s_add_u32 s68, s68, 1
    s_and_b32 s68, s68, 7
    s_lshl_b32 s69, s68, 7
    s_add_u32 s20, s4, s69
    s_addc_u32 s21, s5, 0
    s_lshl_b32 s69, s68, 19
    s_add_u32 s24, s10, s69
    s_addc_u32 s25, s11, 0
    s_waitcnt vmcnt(12)
    s_barrier
    ds_read_b128 a[224:227], v36 offset:0
    ds_read_b128 a[228:231], v36 offset:2048
    ds_read_b128 a[232:235], v36 offset:4096
    ds_read_b128 a[236:239], v36 offset:6144
    ds_read_b64_tr_b16 a[160:161], v38 offset:0
    ds_read_b64_tr_b16 a[162:163], v38 offset:1024
    ds_read_b64_tr_b16 a[164:165], v38 offset:8
    ds_read_b64_tr_b16 a[166:167], v38 offset:1032
    ds_read_b64_tr_b16 a[168:169], v39 offset:0
    ds_read_b64_tr_b16 a[170:171], v39 offset:1024
    ds_read_b64_tr_b16 a[172:173], v39 offset:8
    ds_read_b64_tr_b16 a[174:175], v39 offset:1032
    ds_read_b64_tr_b16 a[176:177], v40 offset:0
    ds_read_b64_tr_b16 a[178:179], v40 offset:1024
    ds_read_b64_tr_b16 a[180:181], v40 offset:8
    ds_read_b64_tr_b16 a[182:183], v40 offset:1032
    ds_read_b64_tr_b16 a[184:185], v41 offset:0
    ds_read_b64_tr_b16 a[186:187], v41 offset:1024
    ds_read_b64_tr_b16 a[188:189], v41 offset:8
    ds_read_b64_tr_b16 a[190:191], v41 offset:1032
    s_mov_b32 s75, 0x3e0293ee
    s_waitcnt lgkmcnt(0)
    v_mfma_f32_16x16x32_bf16 v[112:115], a[160:163], a[224:227], 0
    ds_read_b128 a[240:243], v37 offset:0
    s_add_u32 m0, s64, 16384
    v_mfma_f32_16x16x32_bf16 v[116:119], a[160:163], a[228:231], 0
    ds_read_b128 a[244:247], v37 offset:2048
    buffer_load_dwordx4 v240, s[24:27], s52 offen offset:0 lds
    v_mfma_f32_16x16x32_bf16 v[120:123], a[160:163], a[232:235], 0
    ds_read_b128 a[248:251], v37 offset:4096
    v_mfma_f32_16x16x32_bf16 v[124:127], a[160:163], a[236:239], 0
    ds_read_b128 a[252:255], v37 offset:6144
    v_mfma_f32_16x16x32_bf16 v[128:131], a[164:167], a[224:227], 0
    ds_read_b64_tr_b16 a[192:193], v38 offset:8192
    buffer_load_dwordx4 v240, s[24:27], s53 offen offset:1024 lds
    v_mfma_f32_16x16x32_bf16 v[132:135], a[164:167], a[228:231], 0
    ds_read_b64_tr_b16 a[194:195], v38 offset:9216
    v_accvgpr_write_b32 a0, 0
    v_mfma_f32_16x16x32_bf16 v[136:139], a[164:167], a[232:235], 0
    ds_read_b64_tr_b16 a[196:197], v38 offset:8200
    v_accvgpr_write_b32 a1, 0
    v_mfma_f32_16x16x32_bf16 v[140:143], a[164:167], a[236:239], 0
    ds_read_b64_tr_b16 a[198:199], v38 offset:9224
    buffer_load_dwordx4 v241, s[24:27], s54 offen offset:2048 lds
    v_mfma_f32_16x16x32_bf16 v[144:147], a[168:171], a[224:227], 0
    ds_read_b64_tr_b16 a[200:201], v39 offset:8192
    v_accvgpr_write_b32 a2, 0
    v_mfma_f32_16x16x32_bf16 v[148:151], a[168:171], a[228:231], 0
    ds_read_b64_tr_b16 a[202:203], v39 offset:9216
    v_accvgpr_write_b32 a3, 0
    v_mfma_f32_16x16x32_bf16 v[152:155], a[168:171], a[232:235], 0
    ds_read_b64_tr_b16 a[204:205], v39 offset:8200
    buffer_load_dwordx4 v241, s[24:27], s55 offen offset:3072 lds
    v_mfma_f32_16x16x32_bf16 v[156:159], a[168:171], a[236:239], 0
    ds_read_b64_tr_b16 a[206:207], v39 offset:9224
    v_accvgpr_write_b32 a4, 0
    v_mfma_f32_16x16x32_bf16 v[160:163], a[172:175], a[224:227], 0
    ds_read_b64_tr_b16 a[208:209], v40 offset:8192
    v_accvgpr_write_b32 a5, 0
    v_mfma_f32_16x16x32_bf16 v[164:167], a[172:175], a[228:231], 0
    ds_read_b64_tr_b16 a[210:211], v40 offset:9216
    s_add_u32 m0, s63, 65536
    v_mfma_f32_16x16x32_bf16 v[168:171], a[172:175], a[232:235], 0
    ds_read_b64_tr_b16 a[212:213], v40 offset:8200
    buffer_load_dwordx4 v46, s[20:23], s44 offen offset:0 lds
    v_mfma_f32_16x16x32_bf16 v[172:175], a[172:175], a[236:239], 0
    ds_read_b64_tr_b16 a[214:215], v40 offset:9224
    v_accvgpr_write_b32 a6, 0
    v_mfma_f32_16x16x32_bf16 v[176:179], a[176:179], a[224:227], 0
    ds_read_b64_tr_b16 a[216:217], v41 offset:8192
    v_accvgpr_write_b32 a7, 0
    v_mfma_f32_16x16x32_bf16 v[180:183], a[176:179], a[228:231], 0
    ds_read_b64_tr_b16 a[218:219], v41 offset:9216
    buffer_load_dwordx4 v47, s[20:23], s45 offen offset:1024 lds
    v_mfma_f32_16x16x32_bf16 v[184:187], a[176:179], a[232:235], 0
    ds_read_b64_tr_b16 a[220:221], v41 offset:8200
    v_accvgpr_write_b32 a8, 0
    v_mfma_f32_16x16x32_bf16 v[188:191], a[176:179], a[236:239], 0
    ds_read_b64_tr_b16 a[222:223], v41 offset:9224
    v_accvgpr_write_b32 a9, 0
    v_mfma_f32_16x16x32_bf16 v[192:195], a[180:183], a[224:227], 0
    buffer_load_dwordx4 v46, s[20:23], s46 offen offset:2048 lds
    v_mfma_f32_16x16x32_bf16 v[196:199], a[180:183], a[228:231], 0
    v_accvgpr_write_b32 a10, 0
    v_mfma_f32_16x16x32_bf16 v[200:203], a[180:183], a[232:235], 0
    v_accvgpr_write_b32 a11, 0
    v_mfma_f32_16x16x32_bf16 v[204:207], a[180:183], a[236:239], 0
    buffer_load_dwordx4 v47, s[20:23], s47 offen offset:3072 lds
    v_mfma_f32_16x16x32_bf16 v[208:211], a[184:187], a[224:227], 0
    v_accvgpr_write_b32 a12, 0
    v_mfma_f32_16x16x32_bf16 v[212:215], a[184:187], a[228:231], 0
    v_accvgpr_write_b32 a13, 0
    v_mfma_f32_16x16x32_bf16 v[216:219], a[184:187], a[232:235], 0
    s_add_u32 m0, s63, 69632
    v_mfma_f32_16x16x32_bf16 v[220:223], a[184:187], a[236:239], 0
    buffer_load_dwordx4 v46, s[20:23], s48 offen offset:0 lds
    v_mfma_f32_16x16x32_bf16 v[224:227], a[188:191], a[224:227], 0
    v_accvgpr_write_b32 a14, 0
    v_mfma_f32_16x16x32_bf16 v[228:231], a[188:191], a[228:231], 0
    v_accvgpr_write_b32 a15, 0
    v_mfma_f32_16x16x32_bf16 v[232:235], a[188:191], a[232:235], 0
    v_accvgpr_write_b32 a16, 0
    v_mfma_f32_16x16x32_bf16 v[236:239], a[188:191], a[236:239], 0
    v_accvgpr_write_b32 a17, 0
    s_waitcnt vmcnt(9) lgkmcnt(0)
    s_barrier
    v_mfma_f32_16x16x32_bf16 v[112:115], a[192:195], a[240:243], v[112:115]
    v_add_u32 v36, 0x18000, v36
    v_add_u32 v37, 0x18000, v37
    v_mfma_f32_16x16x32_bf16 v[116:119], a[192:195], a[244:247], v[116:119]
    v_add_u32 v38, 0xffffc000, v38
    v_add_u32 v39, 0xffffc000, v39
    v_mfma_f32_16x16x32_bf16 v[120:123], a[192:195], a[248:251], v[120:123]
    v_add_u32 v40, 0xffffc000, v40
    v_add_u32 v41, 0xffffc000, v41
    v_mfma_f32_16x16x32_bf16 v[124:127], a[192:195], a[252:255], v[124:127]
    ds_read_b128 a[224:227], v36 offset:0
    buffer_load_dwordx4 v47, s[20:23], s49 offen offset:1024 lds
    v_mfma_f32_16x16x32_bf16 v[128:131], a[196:199], a[240:243], v[128:131]
    ds_read_b128 a[228:231], v36 offset:2048
    v_mfma_f32_16x16x32_bf16 v[132:135], a[196:199], a[244:247], v[132:135]
    ds_read_b128 a[232:235], v36 offset:4096
    v_accvgpr_write_b32 a18, 0
    v_mfma_f32_16x16x32_bf16 v[136:139], a[196:199], a[248:251], v[136:139]
    ds_read_b128 a[236:239], v36 offset:6144
    buffer_load_dwordx4 v46, s[20:23], s50 offen offset:2048 lds
    v_mfma_f32_16x16x32_bf16 v[140:143], a[196:199], a[252:255], v[140:143]
    ds_read_b64_tr_b16 a[160:161], v38 offset:0
    v_accvgpr_write_b32 a19, 0
    v_mfma_f32_16x16x32_bf16 v[144:147], a[200:203], a[240:243], v[144:147]
    ds_read_b64_tr_b16 a[162:163], v38 offset:1024
    v_accvgpr_write_b32 a20, 0
    v_mfma_f32_16x16x32_bf16 v[148:151], a[200:203], a[244:247], v[148:151]
    ds_read_b64_tr_b16 a[164:165], v38 offset:8
    buffer_load_dwordx4 v47, s[20:23], s51 offen offset:3072 lds
    v_mfma_f32_16x16x32_bf16 v[152:155], a[200:203], a[248:251], v[152:155]
    ds_read_b64_tr_b16 a[166:167], v38 offset:1032
    v_accvgpr_write_b32 a21, 0
    v_mfma_f32_16x16x32_bf16 v[156:159], a[200:203], a[252:255], v[156:159]
    ds_read_b64_tr_b16 a[168:169], v39 offset:0
    v_accvgpr_write_b32 a22, 0
    v_mfma_f32_16x16x32_bf16 v[160:163], a[204:207], a[240:243], v[160:163]
    ds_read_b64_tr_b16 a[170:171], v39 offset:1024
    s_add_u32 m0, s64, 0
    v_mfma_f32_16x16x32_bf16 v[164:167], a[204:207], a[244:247], v[164:167]
    ds_read_b64_tr_b16 a[172:173], v39 offset:8
    s_add_u32 s65, s64, 0
    v_mfma_f32_16x16x32_bf16 v[168:171], a[204:207], a[248:251], v[168:171]
    ds_read_b64_tr_b16 a[174:175], v39 offset:1032
    buffer_load_dwordx4 v28, s[28:31], s65 offen offset:0 nt lds
    v_mfma_f32_16x16x32_bf16 v[172:175], a[204:207], a[252:255], v[172:175]
    ds_read_b64_tr_b16 a[176:177], v40 offset:0
    v_accvgpr_write_b32 a23, 0
    v_mfma_f32_16x16x32_bf16 v[176:179], a[208:211], a[240:243], v[176:179]
    ds_read_b64_tr_b16 a[178:179], v40 offset:1024
    v_accvgpr_write_b32 a24, 0
    v_mfma_f32_16x16x32_bf16 v[180:183], a[208:211], a[244:247], v[180:183]
    ds_read_b64_tr_b16 a[180:181], v40 offset:8
    buffer_load_dwordx4 v29, s[28:31], s65 offen offset:1024 nt lds
    v_mfma_f32_16x16x32_bf16 v[184:187], a[208:211], a[248:251], v[184:187]
    ds_read_b64_tr_b16 a[182:183], v40 offset:1032
    v_accvgpr_write_b32 a25, 0
    v_mfma_f32_16x16x32_bf16 v[188:191], a[208:211], a[252:255], v[188:191]
    ds_read_b64_tr_b16 a[184:185], v41 offset:0
    v_accvgpr_write_b32 a26, 0
    v_mfma_f32_16x16x32_bf16 v[192:195], a[212:215], a[240:243], v[192:195]
    ds_read_b64_tr_b16 a[186:187], v41 offset:1024
    s_add_u32 s68, s68, 1
    v_mfma_f32_16x16x32_bf16 v[196:199], a[212:215], a[244:247], v[196:199]
    ds_read_b64_tr_b16 a[188:189], v41 offset:8
    s_and_b32 s68, s68, 7
    v_mfma_f32_16x16x32_bf16 v[200:203], a[212:215], a[248:251], v[200:203]
    ds_read_b64_tr_b16 a[190:191], v41 offset:1032
    s_lshl_b32 s69, s68, 7
    v_mfma_f32_16x16x32_bf16 v[204:207], a[212:215], a[252:255], v[204:207]
    s_add_u32 s20, s4, s69
    v_mfma_f32_16x16x32_bf16 v[208:211], a[216:219], a[240:243], v[208:211]
    s_addc_u32 s21, s5, 0
    v_mfma_f32_16x16x32_bf16 v[212:215], a[216:219], a[244:247], v[212:215]
    s_lshl_b32 s69, s68, 19
    v_mfma_f32_16x16x32_bf16 v[216:219], a[216:219], a[248:251], v[216:219]
    s_add_u32 s24, s10, s69
    v_mfma_f32_16x16x32_bf16 v[220:223], a[216:219], a[252:255], v[220:223]
    s_addc_u32 s25, s11, 0
    v_mfma_f32_16x16x32_bf16 v[224:227], a[220:223], a[240:243], v[224:227]
    v_accvgpr_write_b32 a27, 0
    v_mfma_f32_16x16x32_bf16 v[228:231], a[220:223], a[244:247], v[228:231]
    v_accvgpr_write_b32 a28, 0
    v_mfma_f32_16x16x32_bf16 v[232:235], a[220:223], a[248:251], v[232:235]
    v_accvgpr_write_b32 a29, 0
    v_mfma_f32_16x16x32_bf16 v[236:239], a[220:223], a[252:255], v[236:239]
    v_accvgpr_write_b32 a30, 0
    s_waitcnt lgkmcnt(0)
    v_mfma_f32_16x16x32_bf16 v[112:115], a[160:163], a[224:227], v[112:115]
    ds_read_b128 a[240:243], v37 offset:0
    s_add_u32 m0, s64, 114688
    v_mfma_f32_16x16x32_bf16 v[116:119], a[160:163], a[228:231], v[116:119]
    ds_read_b128 a[244:247], v37 offset:2048
    buffer_load_dwordx4 v240, s[24:27], s52 offen offset:0 lds
    v_mfma_f32_16x16x32_bf16 v[120:123], a[160:163], a[232:235], v[120:123]
    ds_read_b128 a[248:251], v37 offset:4096
    v_mfma_f32_16x16x32_bf16 v[124:127], a[160:163], a[236:239], v[124:127]
    ds_read_b128 a[252:255], v37 offset:6144
    v_mfma_f32_16x16x32_bf16 v[128:131], a[164:167], a[224:227], v[128:131]
    ds_read_b64_tr_b16 a[192:193], v38 offset:8192
    buffer_load_dwordx4 v240, s[24:27], s53 offen offset:1024 lds
    v_mfma_f32_16x16x32_bf16 v[132:135], a[164:167], a[228:231], v[132:135]
    ds_read_b64_tr_b16 a[194:195], v38 offset:9216
    v_accvgpr_write_b32 a31, 0
    v_mfma_f32_16x16x32_bf16 v[136:139], a[164:167], a[232:235], v[136:139]
    ds_read_b64_tr_b16 a[196:197], v38 offset:8200
    v_accvgpr_write_b32 a32, 0
    v_mfma_f32_16x16x32_bf16 v[140:143], a[164:167], a[236:239], v[140:143]
    ds_read_b64_tr_b16 a[198:199], v38 offset:9224
    buffer_load_dwordx4 v241, s[24:27], s54 offen offset:2048 lds
    v_mfma_f32_16x16x32_bf16 v[144:147], a[168:171], a[224:227], v[144:147]
    ds_read_b64_tr_b16 a[200:201], v39 offset:8192
    v_accvgpr_write_b32 a33, 0
    v_mfma_f32_16x16x32_bf16 v[148:151], a[168:171], a[228:231], v[148:151]
    ds_read_b64_tr_b16 a[202:203], v39 offset:9216
    v_accvgpr_write_b32 a34, 0
    v_mfma_f32_16x16x32_bf16 v[152:155], a[168:171], a[232:235], v[152:155]
    ds_read_b64_tr_b16 a[204:205], v39 offset:8200
    buffer_load_dwordx4 v241, s[24:27], s55 offen offset:3072 lds
    v_mfma_f32_16x16x32_bf16 v[156:159], a[168:171], a[236:239], v[156:159]
    ds_read_b64_tr_b16 a[206:207], v39 offset:9224
    v_accvgpr_write_b32 a35, 0
    v_mfma_f32_16x16x32_bf16 v[160:163], a[172:175], a[224:227], v[160:163]
    ds_read_b64_tr_b16 a[208:209], v40 offset:8192
    v_accvgpr_write_b32 a36, 0
    v_mfma_f32_16x16x32_bf16 v[164:167], a[172:175], a[228:231], v[164:167]
    ds_read_b64_tr_b16 a[210:211], v40 offset:9216
    s_add_u32 m0, s63, 32768
    v_mfma_f32_16x16x32_bf16 v[168:171], a[172:175], a[232:235], v[168:171]
    ds_read_b64_tr_b16 a[212:213], v40 offset:8200
    buffer_load_dwordx4 v46, s[20:23], s44 offen offset:0 lds
    v_mfma_f32_16x16x32_bf16 v[172:175], a[172:175], a[236:239], v[172:175]
    ds_read_b64_tr_b16 a[214:215], v40 offset:9224
    v_accvgpr_write_b32 a37, 0
    v_mfma_f32_16x16x32_bf16 v[176:179], a[176:179], a[224:227], v[176:179]
    ds_read_b64_tr_b16 a[216:217], v41 offset:8192
    v_accvgpr_write_b32 a38, 0
    v_mfma_f32_16x16x32_bf16 v[180:183], a[176:179], a[228:231], v[180:183]
    ds_read_b64_tr_b16 a[218:219], v41 offset:9216
    buffer_load_dwordx4 v47, s[20:23], s45 offen offset:1024 lds
    v_mfma_f32_16x16x32_bf16 v[184:187], a[176:179], a[232:235], v[184:187]
    ds_read_b64_tr_b16 a[220:221], v41 offset:8200
    v_accvgpr_write_b32 a39, 0
    v_mfma_f32_16x16x32_bf16 v[188:191], a[176:179], a[236:239], v[188:191]
    ds_read_b64_tr_b16 a[222:223], v41 offset:9224
    v_accvgpr_write_b32 a40, 0
    v_mfma_f32_16x16x32_bf16 v[192:195], a[180:183], a[224:227], v[192:195]
    buffer_load_dwordx4 v46, s[20:23], s46 offen offset:2048 lds
    v_mfma_f32_16x16x32_bf16 v[196:199], a[180:183], a[228:231], v[196:199]
    v_accvgpr_write_b32 a41, 0
    v_mfma_f32_16x16x32_bf16 v[200:203], a[180:183], a[232:235], v[200:203]
    v_accvgpr_write_b32 a42, 0
    v_mfma_f32_16x16x32_bf16 v[204:207], a[180:183], a[236:239], v[204:207]
    buffer_load_dwordx4 v47, s[20:23], s47 offen offset:3072 lds
    v_mfma_f32_16x16x32_bf16 v[208:211], a[184:187], a[224:227], v[208:211]
    v_accvgpr_write_b32 a43, 0
    v_mfma_f32_16x16x32_bf16 v[212:215], a[184:187], a[228:231], v[212:215]
    v_accvgpr_write_b32 a44, 0
    v_mfma_f32_16x16x32_bf16 v[216:219], a[184:187], a[232:235], v[216:219]
    s_add_u32 m0, s63, 36864
    v_mfma_f32_16x16x32_bf16 v[220:223], a[184:187], a[236:239], v[220:223]
    buffer_load_dwordx4 v46, s[20:23], s48 offen offset:0 lds
    v_mfma_f32_16x16x32_bf16 v[224:227], a[188:191], a[224:227], v[224:227]
    v_accvgpr_write_b32 a45, 0
    v_mfma_f32_16x16x32_bf16 v[228:231], a[188:191], a[228:231], v[228:231]
    v_accvgpr_write_b32 a46, 0
    v_mfma_f32_16x16x32_bf16 v[232:235], a[188:191], a[232:235], v[232:235]
    v_accvgpr_write_b32 a47, 0
    v_mfma_f32_16x16x32_bf16 v[236:239], a[188:191], a[236:239], v[236:239]
    v_accvgpr_write_b32 a48, 0
    s_waitcnt vmcnt(11) lgkmcnt(0)
    s_barrier
    v_mfma_f32_16x16x32_bf16 v[112:115], a[192:195], a[240:243], v[112:115]
    v_add_u32 v36, 0xffff0000, v36
    v_add_u32 v37, 0xffff0000, v37
    v_mfma_f32_16x16x32_bf16 v[116:119], a[192:195], a[244:247], v[116:119]
    v_add_u32 v38, 0xfffec000, v38
    v_add_u32 v39, 0xfffec000, v39
    v_mfma_f32_16x16x32_bf16 v[120:123], a[192:195], a[248:251], v[120:123]
    v_add_u32 v40, 0xfffec000, v40
    v_add_u32 v41, 0xfffec000, v41
    v_mfma_f32_16x16x32_bf16 v[124:127], a[192:195], a[252:255], v[124:127]
    ds_read_b128 a[224:227], v36 offset:0
    buffer_load_dwordx4 v47, s[20:23], s49 offen offset:1024 lds
    v_mfma_f32_16x16x32_bf16 v[128:131], a[196:199], a[240:243], v[128:131]
    ds_read_b128 a[228:231], v36 offset:2048
    v_mfma_f32_16x16x32_bf16 v[132:135], a[196:199], a[244:247], v[132:135]
    ds_read_b128 a[232:235], v36 offset:4096
    v_accvgpr_write_b32 a49, 0
    v_mfma_f32_16x16x32_bf16 v[136:139], a[196:199], a[248:251], v[136:139]
    ds_read_b128 a[236:239], v36 offset:6144
    buffer_load_dwordx4 v46, s[20:23], s50 offen offset:2048 lds
    v_mfma_f32_16x16x32_bf16 v[140:143], a[196:199], a[252:255], v[140:143]
    ds_read_b64_tr_b16 a[160:161], v38 offset:0
    v_accvgpr_write_b32 a50, 0
    v_mfma_f32_16x16x32_bf16 v[144:147], a[200:203], a[240:243], v[144:147]
    ds_read_b64_tr_b16 a[162:163], v38 offset:1024
    v_accvgpr_write_b32 a51, 0
    v_mfma_f32_16x16x32_bf16 v[148:151], a[200:203], a[244:247], v[148:151]
    ds_read_b64_tr_b16 a[164:165], v38 offset:8
    buffer_load_dwordx4 v47, s[20:23], s51 offen offset:3072 lds
    v_mfma_f32_16x16x32_bf16 v[152:155], a[200:203], a[248:251], v[152:155]
    ds_read_b64_tr_b16 a[166:167], v38 offset:1032
    v_accvgpr_write_b32 a52, 0
    v_mfma_f32_16x16x32_bf16 v[156:159], a[200:203], a[252:255], v[156:159]
    ds_read_b64_tr_b16 a[168:169], v39 offset:0
    v_accvgpr_write_b32 a53, 0
    v_mfma_f32_16x16x32_bf16 v[160:163], a[204:207], a[240:243], v[160:163]
    ds_read_b64_tr_b16 a[170:171], v39 offset:1024
    s_add_u32 s65, s64, 49152
    v_mfma_f32_16x16x32_bf16 v[164:167], a[204:207], a[244:247], v[164:167]
    ds_read_b64_tr_b16 a[172:173], v39 offset:8
    buffer_load_dwordx4 v[96:99], v28, s[28:31], s65 offen offset:0 nt
    v_mfma_f32_16x16x32_bf16 v[168:171], a[204:207], a[248:251], v[168:171]
    ds_read_b64_tr_b16 a[174:175], v39 offset:1032
    v_accvgpr_write_b32 a54, 0
    v_mfma_f32_16x16x32_bf16 v[172:175], a[204:207], a[252:255], v[172:175]
    ds_read_b64_tr_b16 a[176:177], v40 offset:0
    v_accvgpr_write_b32 a55, 0
    v_mfma_f32_16x16x32_bf16 v[176:179], a[208:211], a[240:243], v[176:179]
    ds_read_b64_tr_b16 a[178:179], v40 offset:1024
    s_add_u32 s65, s64, 49152
    v_mfma_f32_16x16x32_bf16 v[180:183], a[208:211], a[244:247], v[180:183]
    ds_read_b64_tr_b16 a[180:181], v40 offset:8
    buffer_load_dwordx4 v[100:103], v29, s[28:31], s65 offen offset:1024 nt
    v_mfma_f32_16x16x32_bf16 v[184:187], a[208:211], a[248:251], v[184:187]
    ds_read_b64_tr_b16 a[182:183], v40 offset:1032
    v_accvgpr_write_b32 a56, 0
    v_mfma_f32_16x16x32_bf16 v[188:191], a[208:211], a[252:255], v[188:191]
    ds_read_b64_tr_b16 a[184:185], v41 offset:0
    v_accvgpr_write_b32 a57, 0
    v_mfma_f32_16x16x32_bf16 v[192:195], a[212:215], a[240:243], v[192:195]
    ds_read_b64_tr_b16 a[186:187], v41 offset:1024
    s_add_u32 s68, s68, 1
    v_mfma_f32_16x16x32_bf16 v[196:199], a[212:215], a[244:247], v[196:199]
    ds_read_b64_tr_b16 a[188:189], v41 offset:8
    s_and_b32 s68, s68, 7
    v_mfma_f32_16x16x32_bf16 v[200:203], a[212:215], a[248:251], v[200:203]
    ds_read_b64_tr_b16 a[190:191], v41 offset:1032
    s_lshl_b32 s69, s68, 7
    v_mfma_f32_16x16x32_bf16 v[204:207], a[212:215], a[252:255], v[204:207]
    s_add_u32 s20, s4, s69
    v_mfma_f32_16x16x32_bf16 v[208:211], a[216:219], a[240:243], v[208:211]
    s_addc_u32 s21, s5, 0
    v_mfma_f32_16x16x32_bf16 v[212:215], a[216:219], a[244:247], v[212:215]
    s_lshl_b32 s69, s68, 19
    v_mfma_f32_16x16x32_bf16 v[216:219], a[216:219], a[248:251], v[216:219]
    s_add_u32 s24, s10, s69
    v_mfma_f32_16x16x32_bf16 v[220:223], a[216:219], a[252:255], v[220:223]
    s_addc_u32 s25, s11, 0
    v_mfma_f32_16x16x32_bf16 v[224:227], a[220:223], a[240:243], v[224:227]
    v_accvgpr_write_b32 a58, 0
    v_mfma_f32_16x16x32_bf16 v[228:231], a[220:223], a[244:247], v[228:231]
    v_accvgpr_write_b32 a59, 0
    v_mfma_f32_16x16x32_bf16 v[232:235], a[220:223], a[248:251], v[232:235]
    v_accvgpr_write_b32 a60, 0
    v_mfma_f32_16x16x32_bf16 v[236:239], a[220:223], a[252:255], v[236:239]
    v_accvgpr_write_b32 a61, 0
    s_waitcnt lgkmcnt(0)
    v_mfma_f32_16x16x32_bf16 v[112:115], a[160:163], a[224:227], v[112:115]
    ds_read_b128 a[240:243], v37 offset:0
    s_add_u32 m0, s64, 98304
    v_mfma_f32_16x16x32_bf16 v[116:119], a[160:163], a[228:231], v[116:119]
    ds_read_b128 a[244:247], v37 offset:2048
    buffer_load_dwordx4 v240, s[24:27], s52 offen offset:0 lds
    v_mfma_f32_16x16x32_bf16 v[120:123], a[160:163], a[232:235], v[120:123]
    ds_read_b128 a[248:251], v37 offset:4096
    v_mfma_f32_16x16x32_bf16 v[124:127], a[160:163], a[236:239], v[124:127]
    ds_read_b128 a[252:255], v37 offset:6144
    v_mfma_f32_16x16x32_bf16 v[128:131], a[164:167], a[224:227], v[128:131]
    ds_read_b64_tr_b16 a[192:193], v38 offset:8192
    buffer_load_dwordx4 v240, s[24:27], s53 offen offset:1024 lds
    v_mfma_f32_16x16x32_bf16 v[132:135], a[164:167], a[228:231], v[132:135]
    ds_read_b64_tr_b16 a[194:195], v38 offset:9216
    v_accvgpr_write_b32 a62, 0
    v_mfma_f32_16x16x32_bf16 v[136:139], a[164:167], a[232:235], v[136:139]
    ds_read_b64_tr_b16 a[196:197], v38 offset:8200
    v_accvgpr_write_b32 a63, 0
    v_mfma_f32_16x16x32_bf16 v[140:143], a[164:167], a[236:239], v[140:143]
    ds_read_b64_tr_b16 a[198:199], v38 offset:9224
    buffer_load_dwordx4 v241, s[24:27], s54 offen offset:2048 lds
    v_mfma_f32_16x16x32_bf16 v[144:147], a[168:171], a[224:227], v[144:147]
    ds_read_b64_tr_b16 a[200:201], v39 offset:8192
    v_accvgpr_write_b32 a64, 0
    v_mfma_f32_16x16x32_bf16 v[148:151], a[168:171], a[228:231], v[148:151]
    ds_read_b64_tr_b16 a[202:203], v39 offset:9216
    v_accvgpr_write_b32 a65, 0
    v_mfma_f32_16x16x32_bf16 v[152:155], a[168:171], a[232:235], v[152:155]
    ds_read_b64_tr_b16 a[204:205], v39 offset:8200
    buffer_load_dwordx4 v241, s[24:27], s55 offen offset:3072 lds
    v_mfma_f32_16x16x32_bf16 v[156:159], a[168:171], a[236:239], v[156:159]
    ds_read_b64_tr_b16 a[206:207], v39 offset:9224
    v_accvgpr_write_b32 a66, 0
    v_mfma_f32_16x16x32_bf16 v[160:163], a[172:175], a[224:227], v[160:163]
    ds_read_b64_tr_b16 a[208:209], v40 offset:8192
    v_accvgpr_write_b32 a67, 0
    v_mfma_f32_16x16x32_bf16 v[164:167], a[172:175], a[228:231], v[164:167]
    ds_read_b64_tr_b16 a[210:211], v40 offset:9216
    s_add_u32 m0, s63, 131072
    v_mfma_f32_16x16x32_bf16 v[168:171], a[172:175], a[232:235], v[168:171]
    ds_read_b64_tr_b16 a[212:213], v40 offset:8200
    buffer_load_dwordx4 v46, s[20:23], s44 offen offset:0 lds
    v_mfma_f32_16x16x32_bf16 v[172:175], a[172:175], a[236:239], v[172:175]
    ds_read_b64_tr_b16 a[214:215], v40 offset:9224
    v_accvgpr_write_b32 a68, 0
    v_mfma_f32_16x16x32_bf16 v[176:179], a[176:179], a[224:227], v[176:179]
    ds_read_b64_tr_b16 a[216:217], v41 offset:8192
    v_accvgpr_write_b32 a69, 0
    v_mfma_f32_16x16x32_bf16 v[180:183], a[176:179], a[228:231], v[180:183]
    ds_read_b64_tr_b16 a[218:219], v41 offset:9216
    buffer_load_dwordx4 v47, s[20:23], s45 offen offset:1024 lds
    v_mfma_f32_16x16x32_bf16 v[184:187], a[176:179], a[232:235], v[184:187]
    ds_read_b64_tr_b16 a[220:221], v41 offset:8200
    v_accvgpr_write_b32 a70, 0
    v_mfma_f32_16x16x32_bf16 v[188:191], a[176:179], a[236:239], v[188:191]
    ds_read_b64_tr_b16 a[222:223], v41 offset:9224
    v_accvgpr_write_b32 a71, 0
    v_mfma_f32_16x16x32_bf16 v[192:195], a[180:183], a[224:227], v[192:195]
    buffer_load_dwordx4 v46, s[20:23], s46 offen offset:2048 lds
    v_mfma_f32_16x16x32_bf16 v[196:199], a[180:183], a[228:231], v[196:199]
    v_accvgpr_write_b32 a72, 0
    v_mfma_f32_16x16x32_bf16 v[200:203], a[180:183], a[232:235], v[200:203]
    v_accvgpr_write_b32 a73, 0
    v_mfma_f32_16x16x32_bf16 v[204:207], a[180:183], a[236:239], v[204:207]
    buffer_load_dwordx4 v47, s[20:23], s47 offen offset:3072 lds
    v_mfma_f32_16x16x32_bf16 v[208:211], a[184:187], a[224:227], v[208:211]
    v_accvgpr_write_b32 a74, 0
    v_mfma_f32_16x16x32_bf16 v[212:215], a[184:187], a[228:231], v[212:215]
    v_accvgpr_write_b32 a75, 0
    v_mfma_f32_16x16x32_bf16 v[216:219], a[184:187], a[232:235], v[216:219]
    s_add_u32 m0, s63, 135168
    v_mfma_f32_16x16x32_bf16 v[220:223], a[184:187], a[236:239], v[220:223]
    buffer_load_dwordx4 v46, s[20:23], s48 offen offset:0 lds
    v_mfma_f32_16x16x32_bf16 v[224:227], a[188:191], a[224:227], v[224:227]
    v_accvgpr_write_b32 a76, 0
    v_mfma_f32_16x16x32_bf16 v[228:231], a[188:191], a[228:231], v[228:231]
    v_accvgpr_write_b32 a77, 0
    v_mfma_f32_16x16x32_bf16 v[232:235], a[188:191], a[232:235], v[232:235]
    v_accvgpr_write_b32 a78, 0
    v_mfma_f32_16x16x32_bf16 v[236:239], a[188:191], a[236:239], v[236:239]
    v_accvgpr_write_b32 a79, 0
    s_waitcnt vmcnt(11) lgkmcnt(0)
    s_barrier
    v_mfma_f32_16x16x32_bf16 v[112:115], a[192:195], a[240:243], v[112:115]
    v_add_u32 v36, 0xffff8000, v36
    v_add_u32 v37, 0xffff8000, v37
    v_mfma_f32_16x16x32_bf16 v[116:119], a[192:195], a[244:247], v[116:119]
    v_add_u32 v38, 0x18000, v38
    v_add_u32 v39, 0x18000, v39
    v_mfma_f32_16x16x32_bf16 v[120:123], a[192:195], a[248:251], v[120:123]
    v_add_u32 v40, 0x18000, v40
    v_add_u32 v41, 0x18000, v41
    v_mfma_f32_16x16x32_bf16 v[124:127], a[192:195], a[252:255], v[124:127]
    ds_read_b128 a[224:227], v36 offset:0
    buffer_load_dwordx4 v47, s[20:23], s49 offen offset:1024 lds
    v_mfma_f32_16x16x32_bf16 v[128:131], a[196:199], a[240:243], v[128:131]
    ds_read_b128 a[228:231], v36 offset:2048
    v_mfma_f32_16x16x32_bf16 v[132:135], a[196:199], a[244:247], v[132:135]
    ds_read_b128 a[232:235], v36 offset:4096
    v_accvgpr_write_b32 a80, 0
    v_mfma_f32_16x16x32_bf16 v[136:139], a[196:199], a[248:251], v[136:139]
    ds_read_b128 a[236:239], v36 offset:6144
    buffer_load_dwordx4 v46, s[20:23], s50 offen offset:2048 lds
    v_mfma_f32_16x16x32_bf16 v[140:143], a[196:199], a[252:255], v[140:143]
    ds_read_b64_tr_b16 a[160:161], v38 offset:0
    v_accvgpr_write_b32 a81, 0
    v_mfma_f32_16x16x32_bf16 v[144:147], a[200:203], a[240:243], v[144:147]
    ds_read_b64_tr_b16 a[162:163], v38 offset:1024
    v_accvgpr_write_b32 a82, 0
    v_mfma_f32_16x16x32_bf16 v[148:151], a[200:203], a[244:247], v[148:151]
    ds_read_b64_tr_b16 a[164:165], v38 offset:8
    buffer_load_dwordx4 v47, s[20:23], s51 offen offset:3072 lds
    v_mfma_f32_16x16x32_bf16 v[152:155], a[200:203], a[248:251], v[152:155]
    ds_read_b64_tr_b16 a[166:167], v38 offset:1032
    v_accvgpr_write_b32 a83, 0
    v_mfma_f32_16x16x32_bf16 v[156:159], a[200:203], a[252:255], v[156:159]
    ds_read_b64_tr_b16 a[168:169], v39 offset:0
    v_accvgpr_write_b32 a84, 0
    v_mfma_f32_16x16x32_bf16 v[160:163], a[204:207], a[240:243], v[160:163]
    ds_read_b64_tr_b16 a[170:171], v39 offset:1024
    s_add_u32 s65, s64, 49152
    v_mfma_f32_16x16x32_bf16 v[164:167], a[204:207], a[244:247], v[164:167]
    ds_read_b64_tr_b16 a[172:173], v39 offset:8
    buffer_load_dwordx4 v[104:107], v30, s[28:31], s65 offen offset:2048 nt
    v_mfma_f32_16x16x32_bf16 v[168:171], a[204:207], a[248:251], v[168:171]
    ds_read_b64_tr_b16 a[174:175], v39 offset:1032
    v_accvgpr_write_b32 a85, 0
    v_mfma_f32_16x16x32_bf16 v[172:175], a[204:207], a[252:255], v[172:175]
    ds_read_b64_tr_b16 a[176:177], v40 offset:0
    v_accvgpr_write_b32 a86, 0
    v_mfma_f32_16x16x32_bf16 v[176:179], a[208:211], a[240:243], v[176:179]
    ds_read_b64_tr_b16 a[178:179], v40 offset:1024
    s_add_u32 s65, s64, 49152
    v_mfma_f32_16x16x32_bf16 v[180:183], a[208:211], a[244:247], v[180:183]
    ds_read_b64_tr_b16 a[180:181], v40 offset:8
    buffer_load_dwordx4 v[108:111], v31, s[28:31], s65 offen offset:3072 nt
    v_mfma_f32_16x16x32_bf16 v[184:187], a[208:211], a[248:251], v[184:187]
    ds_read_b64_tr_b16 a[182:183], v40 offset:1032
    v_accvgpr_write_b32 a87, 0
    v_mfma_f32_16x16x32_bf16 v[188:191], a[208:211], a[252:255], v[188:191]
    ds_read_b64_tr_b16 a[184:185], v41 offset:0
    v_accvgpr_write_b32 a88, 0
    v_mfma_f32_16x16x32_bf16 v[192:195], a[212:215], a[240:243], v[192:195]
    ds_read_b64_tr_b16 a[186:187], v41 offset:1024
    s_add_u32 s68, s68, 1
    v_mfma_f32_16x16x32_bf16 v[196:199], a[212:215], a[244:247], v[196:199]
    ds_read_b64_tr_b16 a[188:189], v41 offset:8
    s_and_b32 s68, s68, 7
    v_mfma_f32_16x16x32_bf16 v[200:203], a[212:215], a[248:251], v[200:203]
    ds_read_b64_tr_b16 a[190:191], v41 offset:1032
    s_lshl_b32 s69, s68, 7
    v_mfma_f32_16x16x32_bf16 v[204:207], a[212:215], a[252:255], v[204:207]
    s_add_u32 s20, s4, s69
    v_mfma_f32_16x16x32_bf16 v[208:211], a[216:219], a[240:243], v[208:211]
    s_addc_u32 s21, s5, 0
    v_mfma_f32_16x16x32_bf16 v[212:215], a[216:219], a[244:247], v[212:215]
    s_lshl_b32 s69, s68, 19
    v_mfma_f32_16x16x32_bf16 v[216:219], a[216:219], a[248:251], v[216:219]
    s_add_u32 s24, s10, s69
    v_mfma_f32_16x16x32_bf16 v[220:223], a[216:219], a[252:255], v[220:223]
    s_addc_u32 s25, s11, 0
    v_mfma_f32_16x16x32_bf16 v[224:227], a[220:223], a[240:243], v[224:227]
    v_accvgpr_write_b32 a89, 0
    v_mfma_f32_16x16x32_bf16 v[228:231], a[220:223], a[244:247], v[228:231]
    v_accvgpr_write_b32 a90, 0
    v_mfma_f32_16x16x32_bf16 v[232:235], a[220:223], a[248:251], v[232:235]
    v_accvgpr_write_b32 a91, 0
    v_mfma_f32_16x16x32_bf16 v[236:239], a[220:223], a[252:255], v[236:239]
    v_accvgpr_write_b32 a92, 0
    s_waitcnt lgkmcnt(0)
    v_mfma_f32_16x16x32_bf16 v[112:115], a[160:163], a[224:227], v[112:115]
    ds_read_b128 a[240:243], v37 offset:0
    s_add_u32 m0, s64, 16384
    v_mfma_f32_16x16x32_bf16 v[116:119], a[160:163], a[228:231], v[116:119]
    ds_read_b128 a[244:247], v37 offset:2048
    buffer_load_dwordx4 v240, s[24:27], s52 offen offset:0 lds
    v_mfma_f32_16x16x32_bf16 v[120:123], a[160:163], a[232:235], v[120:123]
    ds_read_b128 a[248:251], v37 offset:4096
    v_mfma_f32_16x16x32_bf16 v[124:127], a[160:163], a[236:239], v[124:127]
    ds_read_b128 a[252:255], v37 offset:6144
    v_mfma_f32_16x16x32_bf16 v[128:131], a[164:167], a[224:227], v[128:131]
    ds_read_b64_tr_b16 a[192:193], v38 offset:8192
    buffer_load_dwordx4 v240, s[24:27], s53 offen offset:1024 lds
    v_mfma_f32_16x16x32_bf16 v[132:135], a[164:167], a[228:231], v[132:135]
    ds_read_b64_tr_b16 a[194:195], v38 offset:9216
    v_accvgpr_write_b32 a93, 0
    v_mfma_f32_16x16x32_bf16 v[136:139], a[164:167], a[232:235], v[136:139]
    ds_read_b64_tr_b16 a[196:197], v38 offset:8200
    v_accvgpr_write_b32 a94, 0
    v_mfma_f32_16x16x32_bf16 v[140:143], a[164:167], a[236:239], v[140:143]
    ds_read_b64_tr_b16 a[198:199], v38 offset:9224
    buffer_load_dwordx4 v241, s[24:27], s54 offen offset:2048 lds
    v_mfma_f32_16x16x32_bf16 v[144:147], a[168:171], a[224:227], v[144:147]
    ds_read_b64_tr_b16 a[200:201], v39 offset:8192
    v_accvgpr_write_b32 a95, 0
    v_mfma_f32_16x16x32_bf16 v[148:151], a[168:171], a[228:231], v[148:151]
    ds_read_b64_tr_b16 a[202:203], v39 offset:9216
    v_accvgpr_write_b32 a96, 0
    v_mfma_f32_16x16x32_bf16 v[152:155], a[168:171], a[232:235], v[152:155]
    ds_read_b64_tr_b16 a[204:205], v39 offset:8200
    buffer_load_dwordx4 v241, s[24:27], s55 offen offset:3072 lds
    v_mfma_f32_16x16x32_bf16 v[156:159], a[168:171], a[236:239], v[156:159]
    ds_read_b64_tr_b16 a[206:207], v39 offset:9224
    v_accvgpr_write_b32 a97, 0
    v_mfma_f32_16x16x32_bf16 v[160:163], a[172:175], a[224:227], v[160:163]
    ds_read_b64_tr_b16 a[208:209], v40 offset:8192
    v_accvgpr_write_b32 a98, 0
    v_mfma_f32_16x16x32_bf16 v[164:167], a[172:175], a[228:231], v[164:167]
    ds_read_b64_tr_b16 a[210:211], v40 offset:9216
    s_add_u32 m0, s63, 65536
    v_mfma_f32_16x16x32_bf16 v[168:171], a[172:175], a[232:235], v[168:171]
    ds_read_b64_tr_b16 a[212:213], v40 offset:8200
    buffer_load_dwordx4 v46, s[20:23], s44 offen offset:0 lds
    v_mfma_f32_16x16x32_bf16 v[172:175], a[172:175], a[236:239], v[172:175]
    ds_read_b64_tr_b16 a[214:215], v40 offset:9224
    v_accvgpr_write_b32 a99, 0
    v_mfma_f32_16x16x32_bf16 v[176:179], a[176:179], a[224:227], v[176:179]
    ds_read_b64_tr_b16 a[216:217], v41 offset:8192
    v_accvgpr_write_b32 a100, 0
    v_mfma_f32_16x16x32_bf16 v[180:183], a[176:179], a[228:231], v[180:183]
    ds_read_b64_tr_b16 a[218:219], v41 offset:9216
    buffer_load_dwordx4 v47, s[20:23], s45 offen offset:1024 lds
    v_mfma_f32_16x16x32_bf16 v[184:187], a[176:179], a[232:235], v[184:187]
    ds_read_b64_tr_b16 a[220:221], v41 offset:8200
    v_accvgpr_write_b32 a101, 0
    v_mfma_f32_16x16x32_bf16 v[188:191], a[176:179], a[236:239], v[188:191]
    ds_read_b64_tr_b16 a[222:223], v41 offset:9224
    v_accvgpr_write_b32 a102, 0
    v_mfma_f32_16x16x32_bf16 v[192:195], a[180:183], a[224:227], v[192:195]
    buffer_load_dwordx4 v46, s[20:23], s46 offen offset:2048 lds
    v_mfma_f32_16x16x32_bf16 v[196:199], a[180:183], a[228:231], v[196:199]
    v_accvgpr_write_b32 a103, 0
    v_mfma_f32_16x16x32_bf16 v[200:203], a[180:183], a[232:235], v[200:203]
    v_accvgpr_write_b32 a104, 0
    v_mfma_f32_16x16x32_bf16 v[204:207], a[180:183], a[236:239], v[204:207]
    buffer_load_dwordx4 v47, s[20:23], s47 offen offset:3072 lds
    v_mfma_f32_16x16x32_bf16 v[208:211], a[184:187], a[224:227], v[208:211]
    v_accvgpr_write_b32 a105, 0
    v_mfma_f32_16x16x32_bf16 v[212:215], a[184:187], a[228:231], v[212:215]
    v_accvgpr_write_b32 a106, 0
    v_mfma_f32_16x16x32_bf16 v[216:219], a[184:187], a[232:235], v[216:219]
    s_add_u32 m0, s63, 69632
    v_mfma_f32_16x16x32_bf16 v[220:223], a[184:187], a[236:239], v[220:223]
    buffer_load_dwordx4 v46, s[20:23], s48 offen offset:0 lds
    v_mfma_f32_16x16x32_bf16 v[224:227], a[188:191], a[224:227], v[224:227]
    v_accvgpr_write_b32 a107, 0
    v_mfma_f32_16x16x32_bf16 v[228:231], a[188:191], a[228:231], v[228:231]
    v_accvgpr_write_b32 a108, 0
    v_mfma_f32_16x16x32_bf16 v[232:235], a[188:191], a[232:235], v[232:235]
    v_accvgpr_write_b32 a109, 0
    v_mfma_f32_16x16x32_bf16 v[236:239], a[188:191], a[236:239], v[236:239]
    v_accvgpr_write_b32 a110, 0
    s_waitcnt vmcnt(11) lgkmcnt(0)
    s_barrier
    v_mfma_f32_16x16x32_bf16 v[112:115], a[192:195], a[240:243], v[112:115]
    v_add_u32 v36, 0x18000, v36
    v_add_u32 v37, 0x18000, v37
    v_mfma_f32_16x16x32_bf16 v[116:119], a[192:195], a[244:247], v[116:119]
    v_add_u32 v38, 0xffffc000, v38
    v_add_u32 v39, 0xffffc000, v39
    v_mfma_f32_16x16x32_bf16 v[120:123], a[192:195], a[248:251], v[120:123]
    v_add_u32 v40, 0xffffc000, v40
    v_add_u32 v41, 0xffffc000, v41
    v_mfma_f32_16x16x32_bf16 v[124:127], a[192:195], a[252:255], v[124:127]
    ds_read_b128 a[224:227], v36 offset:0
    buffer_load_dwordx4 v47, s[20:23], s49 offen offset:1024 lds
    v_mfma_f32_16x16x32_bf16 v[128:131], a[196:199], a[240:243], v[128:131]
    ds_read_b128 a[228:231], v36 offset:2048
    v_mfma_f32_16x16x32_bf16 v[132:135], a[196:199], a[244:247], v[132:135]
    ds_read_b128 a[232:235], v36 offset:4096
    v_accvgpr_write_b32 a111, 0
    v_mfma_f32_16x16x32_bf16 v[136:139], a[196:199], a[248:251], v[136:139]
    ds_read_b128 a[236:239], v36 offset:6144
    buffer_load_dwordx4 v46, s[20:23], s50 offen offset:2048 lds
    v_mfma_f32_16x16x32_bf16 v[140:143], a[196:199], a[252:255], v[140:143]
    ds_read_b64_tr_b16 a[160:161], v38 offset:0
    v_accvgpr_write_b32 a112, 0
    v_mfma_f32_16x16x32_bf16 v[144:147], a[200:203], a[240:243], v[144:147]
    ds_read_b64_tr_b16 a[162:163], v38 offset:1024
    v_accvgpr_write_b32 a113, 0
    v_mfma_f32_16x16x32_bf16 v[148:151], a[200:203], a[244:247], v[148:151]
    ds_read_b64_tr_b16 a[164:165], v38 offset:8
    buffer_load_dwordx4 v47, s[20:23], s51 offen offset:3072 lds
    v_mfma_f32_16x16x32_bf16 v[152:155], a[200:203], a[248:251], v[152:155]
    ds_read_b64_tr_b16 a[166:167], v38 offset:1032
    v_accvgpr_write_b32 a114, 0
    v_mfma_f32_16x16x32_bf16 v[156:159], a[200:203], a[252:255], v[156:159]
    ds_read_b64_tr_b16 a[168:169], v39 offset:0
    v_accvgpr_write_b32 a115, 0
    v_mfma_f32_16x16x32_bf16 v[160:163], a[204:207], a[240:243], v[160:163]
    ds_read_b64_tr_b16 a[170:171], v39 offset:1024
    s_add_u32 s65, s64, 32768
    v_mfma_f32_16x16x32_bf16 v[164:167], a[204:207], a[244:247], v[164:167]
    ds_read_b64_tr_b16 a[172:173], v39 offset:8
    buffer_load_dwordx4 v[80:83], v32, s[32:35], s65 offen offset:0 nt
    v_mfma_f32_16x16x32_bf16 v[168:171], a[204:207], a[248:251], v[168:171]
    ds_read_b64_tr_b16 a[174:175], v39 offset:1032
    v_accvgpr_write_b32 a116, 0
    v_mfma_f32_16x16x32_bf16 v[172:175], a[204:207], a[252:255], v[172:175]
    ds_read_b64_tr_b16 a[176:177], v40 offset:0
    v_accvgpr_write_b32 a117, 0
    v_mfma_f32_16x16x32_bf16 v[176:179], a[208:211], a[240:243], v[176:179]
    ds_read_b64_tr_b16 a[178:179], v40 offset:1024
    s_add_u32 s65, s64, 32768
    v_mfma_f32_16x16x32_bf16 v[180:183], a[208:211], a[244:247], v[180:183]
    ds_read_b64_tr_b16 a[180:181], v40 offset:8
    buffer_load_dwordx4 v[84:87], v33, s[32:35], s65 offen offset:1024 nt
    v_mfma_f32_16x16x32_bf16 v[184:187], a[208:211], a[248:251], v[184:187]
    ds_read_b64_tr_b16 a[182:183], v40 offset:1032
    v_accvgpr_write_b32 a118, 0
    v_mfma_f32_16x16x32_bf16 v[188:191], a[208:211], a[252:255], v[188:191]
    ds_read_b64_tr_b16 a[184:185], v41 offset:0
    v_accvgpr_write_b32 a119, 0
    v_mfma_f32_16x16x32_bf16 v[192:195], a[212:215], a[240:243], v[192:195]
    ds_read_b64_tr_b16 a[186:187], v41 offset:1024
    s_add_u32 s68, s68, 1
    v_mfma_f32_16x16x32_bf16 v[196:199], a[212:215], a[244:247], v[196:199]
    ds_read_b64_tr_b16 a[188:189], v41 offset:8
    s_and_b32 s68, s68, 7
    v_mfma_f32_16x16x32_bf16 v[200:203], a[212:215], a[248:251], v[200:203]
    ds_read_b64_tr_b16 a[190:191], v41 offset:1032
    s_lshl_b32 s69, s68, 7
    v_mfma_f32_16x16x32_bf16 v[204:207], a[212:215], a[252:255], v[204:207]
    s_add_u32 s20, s4, s69
    v_mfma_f32_16x16x32_bf16 v[208:211], a[216:219], a[240:243], v[208:211]
    s_addc_u32 s21, s5, 0
    v_mfma_f32_16x16x32_bf16 v[212:215], a[216:219], a[244:247], v[212:215]
    s_lshl_b32 s69, s68, 19
    v_mfma_f32_16x16x32_bf16 v[216:219], a[216:219], a[248:251], v[216:219]
    s_add_u32 s24, s10, s69
    v_mfma_f32_16x16x32_bf16 v[220:223], a[216:219], a[252:255], v[220:223]
    s_addc_u32 s25, s11, 0
    v_mfma_f32_16x16x32_bf16 v[224:227], a[220:223], a[240:243], v[224:227]
    v_accvgpr_write_b32 a120, 0
    v_mfma_f32_16x16x32_bf16 v[228:231], a[220:223], a[244:247], v[228:231]
    v_accvgpr_write_b32 a121, 0
    v_mfma_f32_16x16x32_bf16 v[232:235], a[220:223], a[248:251], v[232:235]
    v_accvgpr_write_b32 a122, 0
    v_mfma_f32_16x16x32_bf16 v[236:239], a[220:223], a[252:255], v[236:239]
    v_accvgpr_write_b32 a123, 0
    s_waitcnt lgkmcnt(0)
    v_mfma_f32_16x16x32_bf16 v[112:115], a[160:163], a[224:227], v[112:115]
    ds_read_b128 a[240:243], v37 offset:0
    s_add_u32 m0, s64, 114688
    v_mfma_f32_16x16x32_bf16 v[116:119], a[160:163], a[228:231], v[116:119]
    ds_read_b128 a[244:247], v37 offset:2048
    buffer_load_dwordx4 v240, s[24:27], s52 offen offset:0 lds
    v_mfma_f32_16x16x32_bf16 v[120:123], a[160:163], a[232:235], v[120:123]
    ds_read_b128 a[248:251], v37 offset:4096
    v_mfma_f32_16x16x32_bf16 v[124:127], a[160:163], a[236:239], v[124:127]
    ds_read_b128 a[252:255], v37 offset:6144
    v_mfma_f32_16x16x32_bf16 v[128:131], a[164:167], a[224:227], v[128:131]
    ds_read_b64_tr_b16 a[192:193], v38 offset:8192
    buffer_load_dwordx4 v240, s[24:27], s53 offen offset:1024 lds
    v_mfma_f32_16x16x32_bf16 v[132:135], a[164:167], a[228:231], v[132:135]
    ds_read_b64_tr_b16 a[194:195], v38 offset:9216
    v_accvgpr_write_b32 a124, 0
    v_mfma_f32_16x16x32_bf16 v[136:139], a[164:167], a[232:235], v[136:139]
    ds_read_b64_tr_b16 a[196:197], v38 offset:8200
    v_accvgpr_write_b32 a125, 0
    v_mfma_f32_16x16x32_bf16 v[140:143], a[164:167], a[236:239], v[140:143]
    ds_read_b64_tr_b16 a[198:199], v38 offset:9224
    buffer_load_dwordx4 v241, s[24:27], s54 offen offset:2048 lds
    v_mfma_f32_16x16x32_bf16 v[144:147], a[168:171], a[224:227], v[144:147]
    ds_read_b64_tr_b16 a[200:201], v39 offset:8192
    v_accvgpr_write_b32 a126, 0
    v_mfma_f32_16x16x32_bf16 v[148:151], a[168:171], a[228:231], v[148:151]
    ds_read_b64_tr_b16 a[202:203], v39 offset:9216
    v_accvgpr_write_b32 a127, 0
    v_mfma_f32_16x16x32_bf16 v[152:155], a[168:171], a[232:235], v[152:155]
    ds_read_b64_tr_b16 a[204:205], v39 offset:8200
    buffer_load_dwordx4 v241, s[24:27], s55 offen offset:3072 lds
    v_mfma_f32_16x16x32_bf16 v[156:159], a[168:171], a[236:239], v[156:159]
    ds_read_b64_tr_b16 a[206:207], v39 offset:9224
    v_accvgpr_write_b32 a128, 0
    v_mfma_f32_16x16x32_bf16 v[160:163], a[172:175], a[224:227], v[160:163]
    ds_read_b64_tr_b16 a[208:209], v40 offset:8192
    v_accvgpr_write_b32 a129, 0
    v_mfma_f32_16x16x32_bf16 v[164:167], a[172:175], a[228:231], v[164:167]
    ds_read_b64_tr_b16 a[210:211], v40 offset:9216
    s_add_u32 m0, s63, 32768
    v_mfma_f32_16x16x32_bf16 v[168:171], a[172:175], a[232:235], v[168:171]
    ds_read_b64_tr_b16 a[212:213], v40 offset:8200
    buffer_load_dwordx4 v46, s[20:23], s44 offen offset:0 lds
    v_mfma_f32_16x16x32_bf16 v[172:175], a[172:175], a[236:239], v[172:175]
    ds_read_b64_tr_b16 a[214:215], v40 offset:9224
    v_accvgpr_write_b32 a130, 0
    v_mfma_f32_16x16x32_bf16 v[176:179], a[176:179], a[224:227], v[176:179]
    ds_read_b64_tr_b16 a[216:217], v41 offset:8192
    v_accvgpr_write_b32 a131, 0
    v_mfma_f32_16x16x32_bf16 v[180:183], a[176:179], a[228:231], v[180:183]
    ds_read_b64_tr_b16 a[218:219], v41 offset:9216
    buffer_load_dwordx4 v47, s[20:23], s45 offen offset:1024 lds
    v_mfma_f32_16x16x32_bf16 v[184:187], a[176:179], a[232:235], v[184:187]
    ds_read_b64_tr_b16 a[220:221], v41 offset:8200
    v_accvgpr_write_b32 a132, 0
    v_mfma_f32_16x16x32_bf16 v[188:191], a[176:179], a[236:239], v[188:191]
    ds_read_b64_tr_b16 a[222:223], v41 offset:9224
    v_accvgpr_write_b32 a133, 0
    v_mfma_f32_16x16x32_bf16 v[192:195], a[180:183], a[224:227], v[192:195]
    buffer_load_dwordx4 v46, s[20:23], s46 offen offset:2048 lds
    v_mfma_f32_16x16x32_bf16 v[196:199], a[180:183], a[228:231], v[196:199]
    v_accvgpr_write_b32 a134, 0
    v_mfma_f32_16x16x32_bf16 v[200:203], a[180:183], a[232:235], v[200:203]
    v_accvgpr_write_b32 a135, 0
    v_mfma_f32_16x16x32_bf16 v[204:207], a[180:183], a[236:239], v[204:207]
    buffer_load_dwordx4 v47, s[20:23], s47 offen offset:3072 lds
    v_mfma_f32_16x16x32_bf16 v[208:211], a[184:187], a[224:227], v[208:211]
    v_accvgpr_write_b32 a136, 0
    v_mfma_f32_16x16x32_bf16 v[212:215], a[184:187], a[228:231], v[212:215]
    v_accvgpr_write_b32 a137, 0
    v_mfma_f32_16x16x32_bf16 v[216:219], a[184:187], a[232:235], v[216:219]
    s_add_u32 m0, s63, 36864
    v_mfma_f32_16x16x32_bf16 v[220:223], a[184:187], a[236:239], v[220:223]
    buffer_load_dwordx4 v46, s[20:23], s48 offen offset:0 lds
    v_mfma_f32_16x16x32_bf16 v[224:227], a[188:191], a[224:227], v[224:227]
    v_accvgpr_write_b32 a138, 0
    v_mfma_f32_16x16x32_bf16 v[228:231], a[188:191], a[228:231], v[228:231]
    v_accvgpr_write_b32 a139, 0
    v_mfma_f32_16x16x32_bf16 v[232:235], a[188:191], a[232:235], v[232:235]
    v_accvgpr_write_b32 a140, 0
    v_mfma_f32_16x16x32_bf16 v[236:239], a[188:191], a[236:239], v[236:239]
    v_accvgpr_write_b32 a141, 0
    s_waitcnt vmcnt(11) lgkmcnt(0)
    s_barrier
    v_mfma_f32_16x16x32_bf16 v[112:115], a[192:195], a[240:243], v[112:115]
    v_add_u32 v36, 0xffff0000, v36
    v_add_u32 v37, 0xffff0000, v37
    v_mfma_f32_16x16x32_bf16 v[116:119], a[192:195], a[244:247], v[116:119]
    v_add_u32 v38, 0xfffec000, v38
    v_add_u32 v39, 0xfffec000, v39
    v_mfma_f32_16x16x32_bf16 v[120:123], a[192:195], a[248:251], v[120:123]
    v_add_u32 v40, 0xfffec000, v40
    v_add_u32 v41, 0xfffec000, v41
    v_mfma_f32_16x16x32_bf16 v[124:127], a[192:195], a[252:255], v[124:127]
    ds_read_b128 a[224:227], v36 offset:0
    buffer_load_dwordx4 v47, s[20:23], s49 offen offset:1024 lds
    v_mfma_f32_16x16x32_bf16 v[128:131], a[196:199], a[240:243], v[128:131]
    ds_read_b128 a[228:231], v36 offset:2048
    v_mfma_f32_16x16x32_bf16 v[132:135], a[196:199], a[244:247], v[132:135]
    ds_read_b128 a[232:235], v36 offset:4096
    buffer_load_dwordx4 v46, s[20:23], s50 offen offset:2048 lds
    v_mfma_f32_16x16x32_bf16 v[136:139], a[196:199], a[248:251], v[136:139]
    ds_read_b128 a[236:239], v36 offset:6144
    v_accvgpr_write_b32 a142, 0
    v_mfma_f32_16x16x32_bf16 v[140:143], a[196:199], a[252:255], v[140:143]
    ds_read_b64_tr_b16 a[160:161], v38 offset:0
    buffer_load_dwordx4 v47, s[20:23], s51 offen offset:3072 lds
    v_mfma_f32_16x16x32_bf16 v[144:147], a[200:203], a[240:243], v[144:147]
    ds_read_b64_tr_b16 a[162:163], v38 offset:1024
    v_accvgpr_write_b32 a143, 0
    v_mfma_f32_16x16x32_bf16 v[148:151], a[200:203], a[244:247], v[148:151]
    ds_read_b64_tr_b16 a[164:165], v38 offset:8
    s_add_u32 m0, s64, 0
    v_mfma_f32_16x16x32_bf16 v[152:155], a[200:203], a[248:251], v[152:155]
    ds_read_b64_tr_b16 a[166:167], v38 offset:1032
    s_add_u32 s65, s64, 0
    v_mfma_f32_16x16x32_bf16 v[156:159], a[200:203], a[252:255], v[156:159]
    ds_read_b64_tr_b16 a[168:169], v39 offset:0
    buffer_load_dwordx4 v30, s[28:31], s65 offen offset:2048 nt lds
    v_mfma_f32_16x16x32_bf16 v[160:163], a[204:207], a[240:243], v[160:163]
    ds_read_b64_tr_b16 a[170:171], v39 offset:1024
    v_accvgpr_write_b32 a144, v14
    v_mfma_f32_16x16x32_bf16 v[164:167], a[204:207], a[244:247], v[164:167]
    ds_read_b64_tr_b16 a[172:173], v39 offset:8
    buffer_load_dwordx4 v31, s[28:31], s65 offen offset:3072 nt lds
    v_mfma_f32_16x16x32_bf16 v[168:171], a[204:207], a[248:251], v[168:171]
    ds_read_b64_tr_b16 a[174:175], v39 offset:1032
    v_accvgpr_write_b32 a145, v14
    v_mfma_f32_16x16x32_bf16 v[172:175], a[204:207], a[252:255], v[172:175]
    ds_read_b64_tr_b16 a[176:177], v40 offset:0
    s_add_u32 s65, s64, 32768
    v_mfma_f32_16x16x32_bf16 v[176:179], a[208:211], a[240:243], v[176:179]
    ds_read_b64_tr_b16 a[178:179], v40 offset:1024
    buffer_load_dwordx4 v[88:91], v34, s[32:35], s65 offen offset:2048 nt
    v_mfma_f32_16x16x32_bf16 v[180:183], a[208:211], a[244:247], v[180:183]
    ds_read_b64_tr_b16 a[180:181], v40 offset:8
    v_accvgpr_write_b32 a146, v14
    v_mfma_f32_16x16x32_bf16 v[184:187], a[208:211], a[248:251], v[184:187]
    ds_read_b64_tr_b16 a[182:183], v40 offset:1032
    s_add_u32 s65, s64, 32768
    v_mfma_f32_16x16x32_bf16 v[188:191], a[208:211], a[252:255], v[188:191]
    ds_read_b64_tr_b16 a[184:185], v41 offset:0
    buffer_load_dwordx4 v[92:95], v35, s[32:35], s65 offen offset:3072 nt
    v_mfma_f32_16x16x32_bf16 v[192:195], a[212:215], a[240:243], v[192:195]
    ds_read_b64_tr_b16 a[186:187], v41 offset:1024
    v_accvgpr_write_b32 a147, v14
    v_mfma_f32_16x16x32_bf16 v[196:199], a[212:215], a[244:247], v[196:199]
    ds_read_b64_tr_b16 a[188:189], v41 offset:8
    s_add_u32 s68, s68, 1
    v_mfma_f32_16x16x32_bf16 v[200:203], a[212:215], a[248:251], v[200:203]
    ds_read_b64_tr_b16 a[190:191], v41 offset:1032
    s_and_b32 s68, s68, 7
    v_mfma_f32_16x16x32_bf16 v[204:207], a[212:215], a[252:255], v[204:207]
    s_lshl_b32 s69, s68, 7
    v_mfma_f32_16x16x32_bf16 v[208:211], a[216:219], a[240:243], v[208:211]
    s_add_u32 s20, s4, s69
    v_mfma_f32_16x16x32_bf16 v[212:215], a[216:219], a[244:247], v[212:215]
    s_addc_u32 s21, s5, 0
    v_mfma_f32_16x16x32_bf16 v[216:219], a[216:219], a[248:251], v[216:219]
    s_lshl_b32 s69, s68, 19
    v_mfma_f32_16x16x32_bf16 v[220:223], a[216:219], a[252:255], v[220:223]
    s_add_u32 s24, s10, s69
    v_mfma_f32_16x16x32_bf16 v[224:227], a[220:223], a[240:243], v[224:227]
    s_addc_u32 s25, s11, 0
    v_mfma_f32_16x16x32_bf16 v[228:231], a[220:223], a[244:247], v[228:231]
    v_mfma_f32_16x16x32_bf16 v[232:235], a[220:223], a[248:251], v[232:235]
    v_mfma_f32_16x16x32_bf16 v[236:239], a[220:223], a[252:255], v[236:239]
    s_waitcnt lgkmcnt(0)
    v_mfma_f32_16x16x32_bf16 v[112:115], a[160:163], a[224:227], v[112:115]
    ds_read_b128 a[240:243], v37 offset:0
    s_add_u32 m0, s64, 98304
    v_mfma_f32_16x16x32_bf16 v[116:119], a[160:163], a[228:231], v[116:119]
    ds_read_b128 a[244:247], v37 offset:2048
    buffer_load_dwordx4 v240, s[24:27], s52 offen offset:0 lds
    v_mfma_f32_16x16x32_bf16 v[120:123], a[160:163], a[232:235], v[120:123]
    ds_read_b128 a[248:251], v37 offset:4096
    v_mfma_f32_16x16x32_bf16 v[124:127], a[160:163], a[236:239], v[124:127]
    ds_read_b128 a[252:255], v37 offset:6144
    v_mfma_f32_16x16x32_bf16 v[128:131], a[164:167], a[224:227], v[128:131]
    ds_read_b64_tr_b16 a[192:193], v38 offset:8192
    buffer_load_dwordx4 v240, s[24:27], s53 offen offset:1024 lds
    v_mfma_f32_16x16x32_bf16 v[132:135], a[164:167], a[228:231], v[132:135]
    ds_read_b64_tr_b16 a[194:195], v38 offset:9216
    v_mfma_f32_16x16x32_bf16 v[136:139], a[164:167], a[232:235], v[136:139]
    ds_read_b64_tr_b16 a[196:197], v38 offset:8200
    v_mfma_f32_16x16x32_bf16 v[140:143], a[164:167], a[236:239], v[140:143]
    ds_read_b64_tr_b16 a[198:199], v38 offset:9224
    buffer_load_dwordx4 v241, s[24:27], s54 offen offset:2048 lds
    v_mfma_f32_16x16x32_bf16 v[144:147], a[168:171], a[224:227], v[144:147]
    ds_read_b64_tr_b16 a[200:201], v39 offset:8192
    v_mfma_f32_16x16x32_bf16 v[148:151], a[168:171], a[228:231], v[148:151]
    ds_read_b64_tr_b16 a[202:203], v39 offset:9216
    v_mfma_f32_16x16x32_bf16 v[152:155], a[168:171], a[232:235], v[152:155]
    ds_read_b64_tr_b16 a[204:205], v39 offset:8200
    buffer_load_dwordx4 v241, s[24:27], s55 offen offset:3072 lds
    v_mfma_f32_16x16x32_bf16 v[156:159], a[168:171], a[236:239], v[156:159]
    ds_read_b64_tr_b16 a[206:207], v39 offset:9224
    v_mfma_f32_16x16x32_bf16 v[160:163], a[172:175], a[224:227], v[160:163]
    ds_read_b64_tr_b16 a[208:209], v40 offset:8192
    v_mfma_f32_16x16x32_bf16 v[164:167], a[172:175], a[228:231], v[164:167]
    ds_read_b64_tr_b16 a[210:211], v40 offset:9216
    s_add_u32 m0, s63, 131072
    v_mfma_f32_16x16x32_bf16 v[168:171], a[172:175], a[232:235], v[168:171]
    ds_read_b64_tr_b16 a[212:213], v40 offset:8200
    buffer_load_dwordx4 v46, s[20:23], s44 offen offset:0 lds
    v_mfma_f32_16x16x32_bf16 v[172:175], a[172:175], a[236:239], v[172:175]
    ds_read_b64_tr_b16 a[214:215], v40 offset:9224
    v_mfma_f32_16x16x32_bf16 v[176:179], a[176:179], a[224:227], v[176:179]
    ds_read_b64_tr_b16 a[216:217], v41 offset:8192
    v_mfma_f32_16x16x32_bf16 v[180:183], a[176:179], a[228:231], v[180:183]
    ds_read_b64_tr_b16 a[218:219], v41 offset:9216
    buffer_load_dwordx4 v47, s[20:23], s45 offen offset:1024 lds
    v_mfma_f32_16x16x32_bf16 v[184:187], a[176:179], a[232:235], v[184:187]
    ds_read_b64_tr_b16 a[220:221], v41 offset:8200
    v_mfma_f32_16x16x32_bf16 v[188:191], a[176:179], a[236:239], v[188:191]
    ds_read_b64_tr_b16 a[222:223], v41 offset:9224
    v_mfma_f32_16x16x32_bf16 v[192:195], a[180:183], a[224:227], v[192:195]
    buffer_load_dwordx4 v46, s[20:23], s46 offen offset:2048 lds
    v_mfma_f32_16x16x32_bf16 v[196:199], a[180:183], a[228:231], v[196:199]
    v_mfma_f32_16x16x32_bf16 v[200:203], a[180:183], a[232:235], v[200:203]
    v_mfma_f32_16x16x32_bf16 v[204:207], a[180:183], a[236:239], v[204:207]
    buffer_load_dwordx4 v47, s[20:23], s47 offen offset:3072 lds
    v_mfma_f32_16x16x32_bf16 v[208:211], a[184:187], a[224:227], v[208:211]
    v_mfma_f32_16x16x32_bf16 v[212:215], a[184:187], a[228:231], v[212:215]
    v_mfma_f32_16x16x32_bf16 v[216:219], a[184:187], a[232:235], v[216:219]
    s_add_u32 m0, s63, 135168
    v_mfma_f32_16x16x32_bf16 v[220:223], a[184:187], a[236:239], v[220:223]
    buffer_load_dwordx4 v46, s[20:23], s48 offen offset:0 lds
    v_mfma_f32_16x16x32_bf16 v[224:227], a[188:191], a[224:227], v[224:227]
    v_mfma_f32_16x16x32_bf16 v[228:231], a[188:191], a[228:231], v[228:231]
    v_mfma_f32_16x16x32_bf16 v[232:235], a[188:191], a[232:235], v[232:235]
    v_mfma_f32_16x16x32_bf16 v[236:239], a[188:191], a[236:239], v[236:239]
    s_waitcnt vmcnt(13) lgkmcnt(0)
    s_barrier
    v_mfma_f32_16x16x32_bf16 v[112:115], a[192:195], a[240:243], v[112:115]
    v_add_u32 v36, 0xffff8000, v36
    v_add_u32 v37, 0xffff8000, v37
    v_mfma_f32_16x16x32_bf16 v[116:119], a[192:195], a[244:247], v[116:119]
    v_add_u32 v38, 0x18000, v38
    v_add_u32 v39, 0x18000, v39
    v_mfma_f32_16x16x32_bf16 v[120:123], a[192:195], a[248:251], v[120:123]
    v_add_u32 v40, 0x18000, v40
    v_add_u32 v41, 0x18000, v41
    v_mfma_f32_16x16x32_bf16 v[124:127], a[192:195], a[252:255], v[124:127]
    ds_read_b128 a[224:227], v36 offset:0
    buffer_load_dwordx4 v47, s[20:23], s49 offen offset:1024 lds
    v_mfma_f32_16x16x32_bf16 v[128:131], a[196:199], a[240:243], v[128:131]
    ds_read_b128 a[228:231], v36 offset:2048
    v_mfma_f32_16x16x32_bf16 v[132:135], a[196:199], a[244:247], v[132:135]
    ds_read_b128 a[232:235], v36 offset:4096
    v_mfma_f32_16x16x32_bf16 v[136:139], a[196:199], a[248:251], v[136:139]
    ds_read_b128 a[236:239], v36 offset:6144
    buffer_load_dwordx4 v46, s[20:23], s50 offen offset:2048 lds
    v_mfma_f32_16x16x32_bf16 v[140:143], a[196:199], a[252:255], v[140:143]
    ds_read_b64_tr_b16 a[160:161], v38 offset:0
    v_mfma_f32_16x16x32_bf16 v[144:147], a[200:203], a[240:243], v[144:147]
    ds_read_b64_tr_b16 a[162:163], v38 offset:1024
    v_mfma_f32_16x16x32_bf16 v[148:151], a[200:203], a[244:247], v[148:151]
    ds_read_b64_tr_b16 a[164:165], v38 offset:8
    buffer_load_dwordx4 v47, s[20:23], s51 offen offset:3072 lds
    v_mfma_f32_16x16x32_bf16 v[152:155], a[200:203], a[248:251], v[152:155]
    ds_read_b64_tr_b16 a[166:167], v38 offset:1032
    v_mfma_f32_16x16x32_bf16 v[156:159], a[200:203], a[252:255], v[156:159]
    ds_read_b64_tr_b16 a[168:169], v39 offset:0
    v_mfma_f32_16x16x32_bf16 v[160:163], a[204:207], a[240:243], v[160:163]
    ds_read_b64_tr_b16 a[170:171], v39 offset:1024
    s_add_u32 s68, s68, 1
    v_mfma_f32_16x16x32_bf16 v[164:167], a[204:207], a[244:247], v[164:167]
    ds_read_b64_tr_b16 a[172:173], v39 offset:8
    s_and_b32 s68, s68, 7
    v_mfma_f32_16x16x32_bf16 v[168:171], a[204:207], a[248:251], v[168:171]
    ds_read_b64_tr_b16 a[174:175], v39 offset:1032
    s_lshl_b32 s69, s68, 7
    v_mfma_f32_16x16x32_bf16 v[172:175], a[204:207], a[252:255], v[172:175]
    ds_read_b64_tr_b16 a[176:177], v40 offset:0
    s_add_u32 s20, s4, s69
    v_mfma_f32_16x16x32_bf16 v[176:179], a[208:211], a[240:243], v[176:179]
    ds_read_b64_tr_b16 a[178:179], v40 offset:1024
    s_addc_u32 s21, s5, 0
    v_mfma_f32_16x16x32_bf16 v[180:183], a[208:211], a[244:247], v[180:183]
    ds_read_b64_tr_b16 a[180:181], v40 offset:8
    s_lshl_b32 s69, s68, 19
    v_mfma_f32_16x16x32_bf16 v[184:187], a[208:211], a[248:251], v[184:187]
    ds_read_b64_tr_b16 a[182:183], v40 offset:1032
    s_add_u32 s24, s10, s69
    v_mfma_f32_16x16x32_bf16 v[188:191], a[208:211], a[252:255], v[188:191]
    ds_read_b64_tr_b16 a[184:185], v41 offset:0
    s_addc_u32 s25, s11, 0
    v_mfma_f32_16x16x32_bf16 v[192:195], a[212:215], a[240:243], v[192:195]
    ds_read_b64_tr_b16 a[186:187], v41 offset:1024
    s_add_u32 m0, s64, 16384
    v_mfma_f32_16x16x32_bf16 v[196:199], a[212:215], a[244:247], v[196:199]
    ds_read_b64_tr_b16 a[188:189], v41 offset:8
    s_add_u32 s65, s64, 16384
    v_mfma_f32_16x16x32_bf16 v[200:203], a[212:215], a[248:251], v[200:203]
    ds_read_b64_tr_b16 a[190:191], v41 offset:1032
    buffer_load_dwordx4 v28, s[28:31], s65 offen offset:0 nt lds
    v_mfma_f32_16x16x32_bf16 v[204:207], a[212:215], a[252:255], v[204:207]
    v_mfma_f32_16x16x32_bf16 v[208:211], a[216:219], a[240:243], v[208:211]
    v_mfma_f32_16x16x32_bf16 v[212:215], a[216:219], a[244:247], v[212:215]
    buffer_load_dwordx4 v29, s[28:31], s65 offen offset:1024 nt lds
    v_mfma_f32_16x16x32_bf16 v[216:219], a[216:219], a[248:251], v[216:219]
    v_mfma_f32_16x16x32_bf16 v[220:223], a[216:219], a[252:255], v[220:223]
    v_mfma_f32_16x16x32_bf16 v[224:227], a[220:223], a[240:243], v[224:227]
    v_mfma_f32_16x16x32_bf16 v[228:231], a[220:223], a[244:247], v[228:231]
    v_mfma_f32_16x16x32_bf16 v[232:235], a[220:223], a[248:251], v[232:235]
    v_mfma_f32_16x16x32_bf16 v[236:239], a[220:223], a[252:255], v[236:239]
    s_waitcnt lgkmcnt(0)
    v_mfma_f32_16x16x32_bf16 v[112:115], a[160:163], a[224:227], v[112:115]
    ds_read_b128 a[240:243], v37 offset:0
    v_add_u32 v44, s64, v15
    v_mfma_f32_16x16x32_bf16 v[116:119], a[160:163], a[228:231], v[116:119]
    ds_read_b128 a[244:247], v37 offset:2048
    v_add_u32 v45, 0x10000, v44
    v_mfma_f32_16x16x32_bf16 v[120:123], a[160:163], a[232:235], v[120:123]
    ds_read_b128 a[248:251], v37 offset:4096
    s_add_u32 m0, s64, 16384
    v_mfma_f32_16x16x32_bf16 v[124:127], a[160:163], a[236:239], v[124:127]
    ds_read_b128 a[252:255], v37 offset:6144
    s_add_u32 s65, s64, 16384
    v_mfma_f32_16x16x32_bf16 v[128:131], a[164:167], a[224:227], v[128:131]
    ds_read_b64_tr_b16 a[192:193], v38 offset:8192
    buffer_load_dwordx4 v30, s[28:31], s65 offen offset:2048 nt lds
    v_mfma_f32_16x16x32_bf16 v[132:135], a[164:167], a[228:231], v[132:135]
    ds_read_b64_tr_b16 a[194:195], v38 offset:9216
    v_mfma_f32_16x16x32_bf16 v[136:139], a[164:167], a[232:235], v[136:139]
    ds_read_b64_tr_b16 a[196:197], v38 offset:8200
    v_mfma_f32_16x16x32_bf16 v[140:143], a[164:167], a[236:239], v[140:143]
    ds_read_b64_tr_b16 a[198:199], v38 offset:9224
    v_mfma_f32_16x16x32_bf16 v[144:147], a[168:171], a[224:227], v[144:147]
    ds_read_b64_tr_b16 a[200:201], v39 offset:8192
    v_mfma_f32_16x16x32_bf16 v[148:151], a[168:171], a[228:231], v[148:151]
    ds_read_b64_tr_b16 a[202:203], v39 offset:9216
    v_mfma_f32_16x16x32_bf16 v[152:155], a[168:171], a[232:235], v[152:155]
    ds_read_b64_tr_b16 a[204:205], v39 offset:8200
    buffer_load_dwordx4 v31, s[28:31], s65 offen offset:3072 nt lds
    v_mfma_f32_16x16x32_bf16 v[156:159], a[168:171], a[236:239], v[156:159]
    ds_read_b64_tr_b16 a[206:207], v39 offset:9224
    v_mfma_f32_16x16x32_bf16 v[160:163], a[172:175], a[224:227], v[160:163]
    ds_read_b64_tr_b16 a[208:209], v40 offset:8192
    v_mfma_f32_16x16x32_bf16 v[164:167], a[172:175], a[228:231], v[164:167]
    ds_read_b64_tr_b16 a[210:211], v40 offset:9216
    v_mfma_f32_16x16x32_bf16 v[168:171], a[172:175], a[232:235], v[168:171]
    ds_read_b64_tr_b16 a[212:213], v40 offset:8200
    v_mfma_f32_16x16x32_bf16 v[172:175], a[172:175], a[236:239], v[172:175]
    ds_read_b64_tr_b16 a[214:215], v40 offset:9224
    v_mfma_f32_16x16x32_bf16 v[176:179], a[176:179], a[224:227], v[176:179]
    ds_read_b64_tr_b16 a[216:217], v41 offset:8192
    s_add_u32 m0, s64, 65536
    v_mfma_f32_16x16x32_bf16 v[180:183], a[176:179], a[228:231], v[180:183]
    ds_read_b64_tr_b16 a[218:219], v41 offset:9216
    s_add_u32 s66, s64, 0
    v_mfma_f32_16x16x32_bf16 v[184:187], a[176:179], a[232:235], v[184:187]
    ds_read_b64_tr_b16 a[220:221], v41 offset:8200
    buffer_load_dwordx4 v32, s[32:35], s66 offen offset:0 nt lds
    v_mfma_f32_16x16x32_bf16 v[188:191], a[176:179], a[236:239], v[188:191]
    ds_read_b64_tr_b16 a[222:223], v41 offset:9224
    v_mfma_f32_16x16x32_bf16 v[192:195], a[180:183], a[224:227], v[192:195]
    v_mfma_f32_16x16x32_bf16 v[196:199], a[180:183], a[228:231], v[196:199]
    v_mfma_f32_16x16x32_bf16 v[200:203], a[180:183], a[232:235], v[200:203]
    v_mfma_f32_16x16x32_bf16 v[204:207], a[180:183], a[236:239], v[204:207]
    v_mfma_f32_16x16x32_bf16 v[208:211], a[184:187], a[224:227], v[208:211]
    buffer_load_dwordx4 v33, s[32:35], s66 offen offset:1024 nt lds
    v_mfma_f32_16x16x32_bf16 v[212:215], a[184:187], a[228:231], v[212:215]
    v_mfma_f32_16x16x32_bf16 v[216:219], a[184:187], a[232:235], v[216:219]
    v_mfma_f32_16x16x32_bf16 v[220:223], a[184:187], a[236:239], v[220:223]
    v_mfma_f32_16x16x32_bf16 v[224:227], a[188:191], a[224:227], v[224:227]
    v_mfma_f32_16x16x32_bf16 v[228:231], a[188:191], a[228:231], v[228:231]
    v_mfma_f32_16x16x32_bf16 v[232:235], a[188:191], a[232:235], v[232:235]
    v_mfma_f32_16x16x32_bf16 v[236:239], a[188:191], a[236:239], v[236:239]
    s_waitcnt vmcnt(6) lgkmcnt(0)
    s_barrier
    v_mfma_f32_16x16x32_bf16 v[112:115], a[192:195], a[240:243], v[112:115]
    v_add_u32 v36, 0x18000, v36
    v_add_u32 v37, 0x18000, v37
    v_mfma_f32_16x16x32_bf16 v[116:119], a[192:195], a[244:247], v[116:119]
    v_add_u32 v38, 0xffffc000, v38
    v_add_u32 v39, 0xffffc000, v39
    v_mfma_f32_16x16x32_bf16 v[120:123], a[192:195], a[248:251], v[120:123]
    v_add_u32 v40, 0xffffc000, v40
    v_add_u32 v41, 0xffffc000, v41
    v_mfma_f32_16x16x32_bf16 v[124:127], a[192:195], a[252:255], v[124:127]
    ds_read_b128 a[224:227], v36 offset:0
    ds_write_b128 v44, v[96:99] offset:32768
    v_mfma_f32_16x16x32_bf16 v[128:131], a[196:199], a[240:243], v[128:131]
    ds_read_b128 a[228:231], v36 offset:2048
    ds_write_b128 v44, v[100:103] offset:33792
    v_mfma_f32_16x16x32_bf16 v[132:135], a[196:199], a[244:247], v[132:135]
    ds_read_b128 a[232:235], v36 offset:4096
    ds_write_b128 v44, v[104:107] offset:34816
    v_mfma_f32_16x16x32_bf16 v[136:139], a[196:199], a[248:251], v[136:139]
    ds_read_b128 a[236:239], v36 offset:6144
    ds_write_b128 v44, v[108:111] offset:35840
    v_mfma_f32_16x16x32_bf16 v[140:143], a[196:199], a[252:255], v[140:143]
    ds_read_b64_tr_b16 a[160:161], v38 offset:0
    ds_write_b128 v45, v[80:83] offset:49152
    v_mfma_f32_16x16x32_bf16 v[144:147], a[200:203], a[240:243], v[144:147]
    ds_read_b64_tr_b16 a[162:163], v38 offset:1024
    ds_write_b128 v45, v[84:87] offset:50176
    v_mfma_f32_16x16x32_bf16 v[148:151], a[200:203], a[244:247], v[148:151]
    ds_read_b64_tr_b16 a[164:165], v38 offset:8
    ds_write_b128 v45, v[88:91] offset:51200
    v_mfma_f32_16x16x32_bf16 v[152:155], a[200:203], a[248:251], v[152:155]
    ds_read_b64_tr_b16 a[166:167], v38 offset:1032
    ds_write_b128 v45, v[92:95] offset:52224
    v_mfma_f32_16x16x32_bf16 v[156:159], a[200:203], a[252:255], v[156:159]
    ds_read_b64_tr_b16 a[168:169], v39 offset:0
    s_add_u32 m0, s64, 65536
    v_mfma_f32_16x16x32_bf16 v[160:163], a[204:207], a[240:243], v[160:163]
    ds_read_b64_tr_b16 a[170:171], v39 offset:1024
    s_add_u32 s66, s64, 0
    v_mfma_f32_16x16x32_bf16 v[164:167], a[204:207], a[244:247], v[164:167]
    ds_read_b64_tr_b16 a[172:173], v39 offset:8
    buffer_load_dwordx4 v34, s[32:35], s66 offen offset:2048 nt lds
    v_mfma_f32_16x16x32_bf16 v[168:171], a[204:207], a[248:251], v[168:171]
    ds_read_b64_tr_b16 a[174:175], v39 offset:1032
    v_mfma_f32_16x16x32_bf16 v[172:175], a[204:207], a[252:255], v[172:175]
    ds_read_b64_tr_b16 a[176:177], v40 offset:0
    v_mfma_f32_16x16x32_bf16 v[176:179], a[208:211], a[240:243], v[176:179]
    ds_read_b64_tr_b16 a[178:179], v40 offset:1024
    v_mfma_f32_16x16x32_bf16 v[180:183], a[208:211], a[244:247], v[180:183]
    ds_read_b64_tr_b16 a[180:181], v40 offset:8
    buffer_load_dwordx4 v35, s[32:35], s66 offen offset:3072 nt lds
    v_mfma_f32_16x16x32_bf16 v[184:187], a[208:211], a[248:251], v[184:187]
    ds_read_b64_tr_b16 a[182:183], v40 offset:1032
    v_mfma_f32_16x16x32_bf16 v[188:191], a[208:211], a[252:255], v[188:191]
    ds_read_b64_tr_b16 a[184:185], v41 offset:0
    v_mfma_f32_16x16x32_bf16 v[192:195], a[212:215], a[240:243], v[192:195]
    ds_read_b64_tr_b16 a[186:187], v41 offset:1024
    v_mfma_f32_16x16x32_bf16 v[196:199], a[212:215], a[244:247], v[196:199]
    ds_read_b64_tr_b16 a[188:189], v41 offset:8
    s_add_u32 m0, s64, 81920
    v_mfma_f32_16x16x32_bf16 v[200:203], a[212:215], a[248:251], v[200:203]
    ds_read_b64_tr_b16 a[190:191], v41 offset:1032
    s_add_u32 s66, s64, 16384
    v_mfma_f32_16x16x32_bf16 v[204:207], a[212:215], a[252:255], v[204:207]
    buffer_load_dwordx4 v32, s[32:35], s66 offen offset:0 nt lds
    v_mfma_f32_16x16x32_bf16 v[208:211], a[216:219], a[240:243], v[208:211]
    v_mfma_f32_16x16x32_bf16 v[212:215], a[216:219], a[244:247], v[212:215]
    v_mfma_f32_16x16x32_bf16 v[216:219], a[216:219], a[248:251], v[216:219]
    v_mfma_f32_16x16x32_bf16 v[220:223], a[216:219], a[252:255], v[220:223]
    buffer_load_dwordx4 v33, s[32:35], s66 offen offset:1024 nt lds
    v_mfma_f32_16x16x32_bf16 v[224:227], a[220:223], a[240:243], v[224:227]
    v_mfma_f32_16x16x32_bf16 v[228:231], a[220:223], a[244:247], v[228:231]
    v_mfma_f32_16x16x32_bf16 v[232:235], a[220:223], a[248:251], v[232:235]
    v_mfma_f32_16x16x32_bf16 v[236:239], a[220:223], a[252:255], v[236:239]
    s_mov_b32 s60, 0x4000
    s_mov_b32 s61, 0
    s_mov_b32 s49, 0
    s_mov_b32 s44, 0
    s_mov_b32 s45, 0x1000
    s_mov_b32 s46, 0x2000
    s_mov_b32 s47, 0x3000

    s_mov_b32 s66, s75
    s_mov_b32 s67, s75
    s_waitcnt lgkmcnt(0)
    v_and_b32 v9, 1, v2
    v_mul_u32_u24 v9, 0xaaaa, v9
    v_add_u32 v43, 0x4444, v9
    v_lshlrev_b32 v42, 7, v2
    s_cmp_eq_u32 s40, 3
    s_cbranch_scc1 L_proL
    v_mfma_f32_16x16x32_bf16 v[112:115], a[160:163], a[224:227], v[112:115]
    ds_read_b128 a[240:243], v37 offset:0
    ds_read_b128 a[244:247], v37 offset:2048
    v_mfma_f32_16x16x32_bf16 v[128:131], a[164:167], a[224:227], v[128:131]
    s_add_u32 m0, s64, 81920
    s_add_u32 s66, s64, 16384
    buffer_load_dwordx4 v34, s[32:35], s66 offen offset:2048 nt lds
    buffer_load_dwordx4 v35, s[32:35], s66 offen offset:3072 nt lds
    ds_read_b128 a[248:251], v37 offset:4096
    ds_read_b128 a[252:255], v37 offset:6144
    v_mfma_f32_16x16x32_bf16 v[144:147], a[168:171], a[224:227], v[144:147]
    ds_read_b64_tr_b16 a[192:193], v38 offset:8192
    ds_read_b64_tr_b16 a[194:195], v38 offset:9216
    v_mfma_f32_16x16x32_bf16 v[160:163], a[172:175], a[224:227], v[160:163]
    ds_read_b64_tr_b16 a[196:197], v38 offset:8200
    ds_read_b64_tr_b16 a[198:199], v38 offset:9224
    v_mfma_f32_16x16x32_bf16 v[176:179], a[176:179], a[224:227], v[176:179]
    ds_read_b64_tr_b16 a[200:201], v39 offset:8192
    ds_read_b64_tr_b16 a[202:203], v39 offset:9216
    v_mfma_f32_16x16x32_bf16 v[192:195], a[180:183], a[224:227], v[192:195]
    ds_read_b64_tr_b16 a[204:205], v39 offset:8200
    ds_read_b64_tr_b16 a[206:207], v39 offset:9224
    v_mfma_f32_16x16x32_bf16 v[208:211], a[184:187], a[224:227], v[208:211]
    ds_read_b64_tr_b16 a[208:209], v40 offset:8192
    ds_read_b64_tr_b16 a[210:211], v40 offset:9216
    v_mfma_f32_16x16x32_bf16 v[224:227], a[188:191], a[224:227], v[224:227]
    ds_read_b64_tr_b16 a[212:213], v40 offset:8200
    ds_read_b64_tr_b16 a[214:215], v40 offset:9224
    v_mfma_f32_16x16x32_bf16 v[116:119], a[160:163], a[228:231], v[116:119]
    ds_read_b64_tr_b16 a[216:217], v41 offset:8192
    ds_read_b64_tr_b16 a[218:219], v41 offset:9216
    v_mfma_f32_16x16x32_bf16 v[132:135], a[164:167], a[228:231], v[132:135]
    ds_read_b64_tr_b16 a[220:221], v41 offset:8200
    ds_read_b64_tr_b16 a[222:223], v41 offset:9224
    v_mfma_f32_16x16x32_bf16 v[148:151], a[168:171], a[228:231], v[148:151]
    v_mov_b32 v46, v254
    v_mfma_f32_16x16x32_bf16 v[164:167], a[172:175], a[228:231], v[164:167]
    v_mfma_f32_16x16x32_bf16 v[180:183], a[176:179], a[228:231], v[180:183]
    v_mfma_f32_16x16x32_bf16 v[196:199], a[180:183], a[228:231], v[196:199]
    v_mfma_f32_16x16x32_bf16 v[212:215], a[184:187], a[228:231], v[212:215]
    v_mfma_f32_16x16x32_bf16 v[228:231], a[188:191], a[228:231], v[228:231]
    s_waitcnt lgkmcnt(0)
    v_mfma_f32_16x16x32_bf16 v[112:115], a[192:195], a[240:243], v[112:115]
    v_mfma_f32_16x16x32_bf16 v[128:131], a[196:199], a[240:243], v[128:131]
    v_mfma_f32_16x16x32_bf16 v[144:147], a[200:203], a[240:243], v[144:147]
    v_mfma_f32_16x16x32_bf16 v[160:163], a[204:207], a[240:243], v[160:163]
    v_mfma_f32_16x16x32_bf16 v[176:179], a[208:211], a[240:243], v[176:179]
    v_mfma_f32_16x16x32_bf16 v[192:195], a[212:215], a[240:243], v[192:195]
    v_mfma_f32_16x16x32_bf16 v[208:211], a[216:219], a[240:243], v[208:211]
    v_mfma_f32_16x16x32_bf16 v[224:227], a[220:223], a[240:243], v[224:227]
    v_mfma_f32_16x16x32_bf16 v[120:123], a[160:163], a[232:235], v[120:123]
    v_mul_f32 v112, s75, v112
    v_mul_f32 v113, s75, v113
    v_mfma_f32_16x16x32_bf16 v[136:139], a[164:167], a[232:235], v[136:139]
    s_add_u32 m0, s64, 49152
    s_add_u32 s65, s64, 32768
    buffer_load_dwordx4 v28, s[28:31], s65 offen offset:0 nt lds
    buffer_load_dwordx4 v29, s[28:31], s65 offen offset:1024 nt lds
    v_mul_f32 v114, s75, v114
    v_mul_f32 v115, s75, v115
    v_mfma_f32_16x16x32_bf16 v[152:155], a[168:171], a[232:235], v[152:155]
    v_mul_f32 v128, s75, v128
    v_mul_f32 v129, s75, v129
    v_mfma_f32_16x16x32_bf16 v[168:171], a[172:175], a[232:235], v[168:171]
    v_mul_f32 v130, s75, v130
    v_mul_f32 v131, s75, v131
    v_mfma_f32_16x16x32_bf16 v[184:187], a[176:179], a[232:235], v[184:187]
    v_mul_f32 v144, s75, v144
    v_mul_f32 v145, s75, v145
    v_mfma_f32_16x16x32_bf16 v[200:203], a[180:183], a[232:235], v[200:203]
    v_mul_f32 v146, s75, v146
    v_mul_f32 v147, s75, v147
    v_mfma_f32_16x16x32_bf16 v[216:219], a[184:187], a[232:235], v[216:219]
    v_mul_f32 v160, s75, v160
    v_mul_f32 v161, s75, v161
    v_mfma_f32_16x16x32_bf16 v[232:235], a[188:191], a[232:235], v[232:235]
    v_mul_f32 v162, s75, v162
    v_mul_f32 v163, s75, v163
    v_mfma_f32_16x16x32_bf16 v[124:127], a[160:163], a[236:239], v[124:127]
    ds_read_b128 a[160:163], v16 offset:0
    v_mul_f32 v176, s75, v176
    v_mfma_f32_16x16x32_bf16 v[140:143], a[164:167], a[236:239], v[140:143]
    ds_read_b128 a[164:167], v17 offset:0
    v_mul_f32 v177, s75, v177
    v_mfma_f32_16x16x32_bf16 v[156:159], a[168:171], a[236:239], v[156:159]
    ds_read_b128 a[168:171], v18 offset:0
    v_mul_f32 v178, s75, v178
    v_mfma_f32_16x16x32_bf16 v[172:175], a[172:175], a[236:239], v[172:175]
    ds_read_b128 a[172:175], v19 offset:0
    v_mul_f32 v179, s75, v179
    v_mfma_f32_16x16x32_bf16 v[188:191], a[176:179], a[236:239], v[188:191]
    ds_read_b128 a[176:179], v16 offset:4096
    v_mul_f32 v192, s75, v192
    v_mfma_f32_16x16x32_bf16 v[204:207], a[180:183], a[236:239], v[204:207]
    ds_read_b128 a[180:183], v17 offset:4096
    v_mul_f32 v193, s75, v193
    v_mfma_f32_16x16x32_bf16 v[220:223], a[184:187], a[236:239], v[220:223]
    v_xor_b32 v47, 0x80, v254
    ds_read_b128 a[184:187], v18 offset:4096
    v_mul_f32 v194, s75, v194
    v_mfma_f32_16x16x32_bf16 v[236:239], a[188:191], a[236:239], v[236:239]
    ds_read_b128 a[188:191], v19 offset:4096
    v_mul_f32 v195, s75, v195
    v_mul_f32 v208, s75, v208
    v_mul_f32 v209, s75, v209
    v_mul_f32 v210, s75, v210
    v_mfma_f32_16x16x32_bf16 v[116:119], a[192:195], a[244:247], v[116:119]
    v_mul_f32 v211, s75, v211
    v_mul_f32 v224, s75, v224
    v_mul_f32 v225, s75, v225
    v_mul_f32 v226, s75, v226
    v_mul_f32 v227, s75, v227
    v_mfma_f32_16x16x32_bf16 v[132:135], a[196:199], a[244:247], v[132:135]
    v_cvt_pk_bf16_f32 v48, v112, v113
    v_cvt_pk_bf16_f32 v49, v114, v115
    v_cvt_pk_bf16_f32 v50, v128, v129
    v_cvt_pk_bf16_f32 v51, v130, v131
    v_cvt_pk_bf16_f32 v52, v144, v145
    v_mfma_f32_16x16x32_bf16 v[148:151], a[200:203], a[244:247], v[148:151]
    v_cvt_pk_bf16_f32 v53, v146, v147
    v_cvt_pk_bf16_f32 v54, v160, v161
    v_cvt_pk_bf16_f32 v55, v162, v163
    v_cvt_pk_bf16_f32 v56, v176, v177
    v_cvt_pk_bf16_f32 v57, v178, v179
    v_mfma_f32_16x16x32_bf16 v[164:167], a[204:207], a[244:247], v[164:167]
    v_cvt_pk_bf16_f32 v58, v192, v193
    v_cvt_pk_bf16_f32 v59, v194, v195
    s_add_u32 m0, s64, 49152
    s_add_u32 s65, s64, 32768
    buffer_load_dwordx4 v30, s[28:31], s65 offen offset:2048 nt lds
    buffer_load_dwordx4 v31, s[28:31], s65 offen offset:3072 nt lds
    v_cvt_pk_bf16_f32 v60, v208, v209
    v_cvt_pk_bf16_f32 v61, v210, v211
    v_cvt_pk_bf16_f32 v62, v224, v225
    v_mfma_f32_16x16x32_bf16 v[180:183], a[208:211], a[244:247], v[180:183]
    v_cvt_pk_bf16_f32 v63, v226, v227
    v_mul_f32 v116, s75, v116
    v_mul_f32 v117, s75, v117
    v_mul_f32 v118, s75, v118
    v_mul_f32 v119, s75, v119
    v_mfma_f32_16x16x32_bf16 v[196:199], a[212:215], a[244:247], v[196:199]
    s_waitcnt lgkmcnt(0)
    v_mul_f32 v132, s75, v132
    v_mul_f32 v133, s75, v133
    v_mul_f32 v134, s75, v134
    v_mul_f32 v135, s75, v135
    v_mfma_f32_16x16x32_bf16 v[212:215], a[216:219], a[244:247], v[212:215]
    v_mul_f32 v148, s75, v148
    v_mul_f32 v149, s75, v149
    v_mul_f32 v150, s75, v150
    v_mul_f32 v151, s75, v151
    v_mul_f32 v164, s75, v164
    v_mfma_f32_16x16x32_bf16 v[228:231], a[220:223], a[244:247], v[228:231]
    v_mul_f32 v165, s75, v165
    v_mul_f32 v166, s75, v166
    v_mul_f32 v167, s75, v167
    v_mul_f32 v180, s75, v180
    v_mul_f32 v181, s75, v181
    v_mfma_f32_16x16x32_bf16 v[120:123], a[192:195], a[248:251], v[120:123]
    v_mov_b32 v9, 0
    v_mul_f32 v182, s75, v182
    v_mul_f32 v183, s75, v183
    v_mul_f32 v196, s75, v196
    v_mul_f32 v197, s75, v197
    v_mul_f32 v198, s75, v198
    v_mfma_f32_16x16x32_bf16 v[136:139], a[196:199], a[248:251], v[136:139]
    v_mul_f32 v199, s75, v199
    v_mul_f32 v212, s75, v212
    v_mul_f32 v213, s75, v213
    v_mul_f32 v214, s75, v214
    v_mul_f32 v215, s75, v215
    v_mfma_f32_16x16x32_bf16 v[152:155], a[200:203], a[248:251], v[152:155]
    v_mul_f32 v228, s75, v228
    v_mul_f32 v229, s75, v229
    v_mul_f32 v230, s75, v230
    v_mul_f32 v231, s75, v231
    v_cvt_pk_bf16_f32 v64, v116, v117
    v_mfma_f32_16x16x32_bf16 v[168:171], a[204:207], a[248:251], v[168:171]
    v_cvt_pk_bf16_f32 v65, v118, v119
    v_cvt_pk_bf16_f32 v66, v132, v133
    v_cvt_pk_bf16_f32 v67, v134, v135
    v_cvt_pk_bf16_f32 v68, v148, v149
    v_cvt_pk_bf16_f32 v69, v150, v151
    v_mfma_f32_16x16x32_bf16 v[184:187], a[208:211], a[248:251], v[184:187]
    v_cvt_pk_bf16_f32 v70, v164, v165
    v_cvt_pk_bf16_f32 v71, v166, v167
    v_cvt_pk_bf16_f32 v72, v180, v181
    v_cvt_pk_bf16_f32 v73, v182, v183
    v_cvt_pk_bf16_f32 v74, v196, v197
    v_mfma_f32_16x16x32_bf16 v[200:203], a[212:215], a[248:251], v[200:203]
    v_cvt_pk_bf16_f32 v75, v198, v199
    v_cvt_pk_bf16_f32 v76, v212, v213
    v_cvt_pk_bf16_f32 v77, v214, v215
    v_cvt_pk_bf16_f32 v78, v228, v229
    v_cvt_pk_bf16_f32 v79, v230, v231
    v_mfma_f32_16x16x32_bf16 v[216:219], a[216:219], a[248:251], v[216:219]
    v_mul_f32 v120, s75, v120
    v_mul_f32 v121, s75, v121
    v_mul_f32 v122, s75, v122
    v_mul_f32 v123, s75, v123
    v_mul_f32 v136, s75, v136
    v_mfma_f32_16x16x32_bf16 v[232:235], a[220:223], a[248:251], v[232:235]
    v_mul_f32 v137, s75, v137
    v_mul_f32 v138, s75, v138
    v_mul_f32 v139, s75, v139
    v_mul_f32 v152, s75, v152
    v_mul_f32 v153, s75, v153
    v_mfma_f32_16x16x32_bf16 v[124:127], a[192:195], a[252:255], v[124:127]
    v_mul_f32 v154, s75, v154
    v_mul_f32 v155, s75, v155
    v_mul_f32 v168, s75, v168
    v_mul_f32 v169, s75, v169
    v_mul_f32 v170, s75, v170
    v_mfma_f32_16x16x32_bf16 v[140:143], a[196:199], a[252:255], v[140:143]
    v_mul_f32 v171, s75, v171
    v_mul_f32 v184, s75, v184
    v_mul_f32 v185, s75, v185
    buffer_load_dwordx2 v[44:45], v9, s[88:91], 0 offen sc1
    v_mul_f32 v186, s75, v186
    v_mul_f32 v187, s75, v187
    v_mfma_f32_16x16x32_bf16 v[156:159], a[200:203], a[252:255], v[156:159]
    v_mul_f32 v200, s75, v200
    v_mul_f32 v201, s75, v201
    v_mul_f32 v202, s75, v202
    v_mul_f32 v203, s75, v203
    v_mul_f32 v216, s75, v216
    v_mfma_f32_16x16x32_bf16 v[172:175], a[204:207], a[252:255], v[172:175]
    v_mul_f32 v217, s75, v217
    v_mul_f32 v218, s75, v218
    v_mul_f32 v219, s75, v219
    v_mul_f32 v232, s75, v232
    v_mul_f32 v233, s75, v233
    v_mfma_f32_16x16x32_bf16 v[188:191], a[208:211], a[252:255], v[188:191]
    v_mul_f32 v234, s75, v234
    v_mul_f32 v235, s75, v235
    v_cvt_pk_bf16_f32 v80, v120, v121
    v_cvt_pk_bf16_f32 v81, v122, v123
    v_cvt_pk_bf16_f32 v82, v136, v137
    v_mfma_f32_16x16x32_bf16 v[204:207], a[212:215], a[252:255], v[204:207]
    v_cvt_pk_bf16_f32 v83, v138, v139
    v_cvt_pk_bf16_f32 v84, v152, v153
    v_cvt_pk_bf16_f32 v85, v154, v155
    v_cvt_pk_bf16_f32 v86, v168, v169
    v_cvt_pk_bf16_f32 v87, v170, v171
    v_mfma_f32_16x16x32_bf16 v[220:223], a[216:219], a[252:255], v[220:223]
    v_cvt_pk_bf16_f32 v88, v184, v185
    v_cvt_pk_bf16_f32 v89, v186, v187
    v_cvt_pk_bf16_f32 v90, v200, v201
    v_cvt_pk_bf16_f32 v91, v202, v203
    v_cvt_pk_bf16_f32 v92, v216, v217
    v_mfma_f32_16x16x32_bf16 v[236:239], a[220:223], a[252:255], v[236:239]
    v_cvt_pk_bf16_f32 v93, v218, v219
    v_cvt_pk_bf16_f32 v94, v232, v233
    v_cvt_pk_bf16_f32 v95, v234, v235
    v_mul_f32 v124, s75, v124
    v_mul_f32 v125, s75, v125
    v_mfma_f32_16x16x32_bf16 v[112:115], a[160:163], v[48:51], 0
    v_mul_f32 v126, s75, v126
    v_mul_f32 v127, s75, v127
    v_mul_f32 v140, s75, v140
    v_mul_f32 v141, s75, v141
    v_mul_f32 v142, s75, v142
    v_mfma_f32_16x16x32_bf16 v[112:115], a[164:167], v[52:55], v[112:115]
    v_mul_f32 v143, s75, v143
    v_mul_f32 v156, s75, v156
    v_mul_f32 v157, s75, v157
    v_mul_f32 v158, s75, v158
    v_mul_f32 v159, s75, v159
    v_mfma_f32_16x16x32_bf16 v[112:115], a[168:171], v[56:59], v[112:115]
    v_mul_f32 v172, s75, v172
    v_mul_f32 v173, s75, v173
    v_mul_f32 v174, s75, v174
    v_mul_f32 v175, s75, v175
    v_mul_f32 v188, s75, v188
    v_mfma_f32_16x16x32_bf16 v[112:115], a[172:175], v[60:63], v[112:115]
    s_lshl_b32 s3, s40, 8
    s_add_u32 s3, s3, 155648
    v_lshl_add_u32 v37, v2, 2, s3
    v_mul_f32 v189, s75, v189
    v_mul_f32 v190, s75, v190
    v_mul_f32 v191, s75, v191
    v_mul_f32 v204, s75, v204
    v_mul_f32 v205, s75, v205
    v_mfma_f32_16x16x32_bf16 v[128:131], a[176:179], v[48:51], 0
    v_mul_f32 v206, s75, v206
    v_mul_f32 v207, s75, v207
    v_max3_f32 v10, v112, v113, v114
    v_mul_f32 v220, s75, v220
    v_mul_f32 v221, s75, v221
    v_mfma_f32_16x16x32_bf16 v[128:131], a[180:183], v[52:55], v[128:131]
    v_mul_f32 v222, s75, v222
    v_mul_f32 v223, s75, v223
    v_mul_f32 v236, s75, v236
    v_mul_f32 v237, s75, v237
    v_mul_f32 v238, s75, v238
    v_mfma_f32_16x16x32_bf16 v[128:131], a[184:187], v[56:59], v[128:131]
    v_mul_f32 v239, s75, v239
    v_cvt_pk_bf16_f32 v96, v124, v125
    v_cvt_pk_bf16_f32 v97, v126, v127
    v_cvt_pk_bf16_f32 v98, v140, v141
    v_cvt_pk_bf16_f32 v99, v142, v143
    v_mfma_f32_16x16x32_bf16 v[128:131], a[188:191], v[60:63], v[128:131]
    v_cvt_pk_bf16_f32 v100, v156, v157
    v_cvt_pk_bf16_f32 v101, v158, v159
    v_cvt_pk_bf16_f32 v102, v172, v173
    v_cvt_pk_bf16_f32 v103, v174, v175
    v_cvt_pk_bf16_f32 v104, v188, v189
    v_mfma_f32_16x16x32_bf16 v[116:119], a[160:163], v[64:67], 0
    v_cvt_pk_bf16_f32 v105, v190, v191
    v_cvt_pk_bf16_f32 v106, v204, v205
    v_max3_f32 v224, v115, v128, v129
    v_max3_f32 v10, v10, v130, v131
    v_max_f32 v10, v10, v224
    v_mfma_f32_16x16x32_bf16 v[116:119], a[164:167], v[68:71], v[116:119]
    v_mov_b32 v224, v10
    v_cvt_pk_bf16_f32 v107, v206, v207
    v_cvt_pk_bf16_f32 v108, v220, v221
    v_permlane16_swap_b32 v10, v224
    v_max_f32 v10, v10, v224
    v_mfma_f32_16x16x32_bf16 v[116:119], a[168:171], v[72:75], v[116:119]
    v_mov_b32 v224, v10
    v_cvt_pk_bf16_f32 v109, v222, v223
    v_cvt_pk_bf16_f32 v110, v236, v237
    v_permlane32_swap_b32 v10, v224
    v_max_f32 v10, v10, v224
    v_mfma_f32_16x16x32_bf16 v[116:119], a[172:175], v[76:79], v[116:119]
    v_sub_f32 v112, v112, v10
    v_sub_f32 v113, v113, v10
    v_sub_f32 v114, v114, v10
    v_sub_f32 v115, v115, v10
    v_sub_f32 v128, v128, v10
    v_mfma_f32_16x16x32_bf16 v[132:135], a[176:179], v[64:67], 0
    v_sub_f32 v129, v129, v10
    v_sub_f32 v130, v130, v10
    v_sub_f32 v131, v131, v10
    v_mov_b32 v39, 156416
    v_sub_f32 v176, 0, v10
    v_sub_f32 v177, 0, v10
    v_mfma_f32_16x16x32_bf16 v[132:135], a[180:183], v[68:71], v[132:135]
    v_sub_f32 v178, 0, v10
    v_sub_f32 v179, 0, v10
    v_exp_f32 v112, v112
    v_exp_f32 v113, v113
    v_mfma_f32_16x16x32_bf16 v[132:135], a[184:187], v[72:75], v[132:135]
    v_exp_f32 v114, v114
    v_exp_f32 v115, v115
    v_exp_f32 v128, v128
    v_mfma_f32_16x16x32_bf16 v[132:135], a[188:191], v[76:79], v[132:135]
    v_exp_f32 v129, v129
    v_exp_f32 v130, v130
    v_exp_f32 v131, v131
    v_mfma_f32_16x16x32_bf16 v[120:123], a[160:163], v[80:83], 0
    v_max3_f32 v11, v116, v117, v118
    v_cvt_pk_bf16_f32 v111, v238, v239
    v_cvt_pk_bf16_f32 v144, v112, v113
    v_cvt_pk_bf16_f32 v145, v114, v115
    v_max3_f32 v228, v119, v132, v133
    v_mfma_f32_16x16x32_bf16 v[120:123], a[164:167], v[84:87], v[120:123]
    v_max3_f32 v11, v11, v134, v135
    v_max_f32 v11, v11, v228
    v_mov_b32 v228, v11
    v_cvt_pk_bf16_f32 v146, v128, v129
    v_cvt_pk_bf16_f32 v147, v130, v131
    v_mfma_f32_16x16x32_bf16 v[120:123], a[168:171], v[88:91], v[120:123]
    v_permlane16_swap_b32 v11, v228
    v_max_f32 v11, v11, v228
    v_mov_b32 v228, v11
    v_mfma_f32_16x16x32_bf16 v[120:123], a[172:175], v[92:95], v[120:123]
    v_mfma_f32_16x16x32_bf16 v[136:139], a[176:179], v[80:83], 0
    v_permlane32_swap_b32 v11, v228
    v_max_f32 v11, v11, v228
    v_sub_f32 v116, v116, v11
    v_sub_f32 v117, v117, v11
    v_sub_f32 v118, v118, v11
    v_mfma_f32_16x16x32_bf16 v[136:139], a[180:183], v[84:87], v[136:139]
    v_sub_f32 v119, v119, v11
    v_sub_f32 v132, v132, v11
    v_sub_f32 v133, v133, v11
    v_sub_f32 v134, v134, v11
    v_sub_f32 v135, v135, v11
    v_mfma_f32_16x16x32_bf16 v[136:139], a[184:187], v[88:91], v[136:139]
    v_sub_f32 v180, 0, v11
    v_sub_f32 v181, 0, v11
    v_sub_f32 v182, 0, v11
    v_sub_f32 v183, 0, v11
    v_exp_f32 v116, v116
    v_mfma_f32_16x16x32_bf16 v[136:139], a[188:191], v[92:95], v[136:139]
    v_exp_f32 v117, v117
    v_exp_f32 v118, v118
    v_exp_f32 v119, v119
    v_mfma_f32_16x16x32_bf16 v[124:127], a[160:163], v[96:99], 0
    v_exp_f32 v132, v132
    v_exp_f32 v133, v133
    s_lshl_b32 s3, s93, 20
    s_add_u32 s20, s12, s3
    s_addc_u32 s21, s13, 0
    s_mov_b32 s22, 0x100000
    s_lshr_b32 s3, s2, 3
    s_lshl_b32 s3, s3, 1
    s_add_u32 s3, s3, s40
    s_and_b32 s65, s3, 32
    s_add_u32 s3, s3, s65
    s_lshl_b32 s3, s3, 13
    s_cmp_eq_u32 s40, 2
    s_cselect_b32 s92, 0x400000, s3
    v_exp_f32 v134, v134
    v_mfma_f32_16x16x32_bf16 v[124:127], a[164:167], v[100:103], v[124:127]
    v_exp_f32 v135, v135
    v_max3_f32 v12, v120, v121, v122
    v_max3_f32 v232, v123, v136, v137
    v_max3_f32 v12, v12, v138, v139
    v_mfma_f32_16x16x32_bf16 v[124:127], a[168:171], v[104:107], v[124:127]
    v_max_f32 v12, v12, v232
    v_mov_b32 v232, v12
    ds_read_b128 a[160:163], v16 offset:8192
    ds_read_b128 a[164:167], v17 offset:8192
    v_permlane16_swap_b32 v12, v232
    v_mfma_f32_16x16x32_bf16 v[124:127], a[172:175], v[108:111], v[124:127]
    v_max_f32 v12, v12, v232
    v_mov_b32 v232, v12
    ds_read_b128 a[168:171], v18 offset:8192
    ds_read_b128 a[172:175], v19 offset:8192
    v_permlane32_swap_b32 v12, v232
    v_mfma_f32_16x16x32_bf16 v[140:143], a[176:179], v[96:99], 0
    v_max_f32 v12, v12, v232
    v_sub_f32 v120, v120, v12
    v_sub_f32 v121, v121, v12
    v_sub_f32 v122, v122, v12
    v_sub_f32 v123, v123, v12
    v_mfma_f32_16x16x32_bf16 v[140:143], a[180:183], v[100:103], v[140:143]
    v_sub_f32 v136, v136, v12
    v_sub_f32 v137, v137, v12
    v_sub_f32 v138, v138, v12
    v_sub_f32 v139, v139, v12
    v_sub_f32 v184, 0, v12
    v_mfma_f32_16x16x32_bf16 v[140:143], a[184:187], v[104:107], v[140:143]
    v_sub_f32 v185, 0, v12
    v_sub_f32 v186, 0, v12
    v_sub_f32 v187, 0, v12
    v_exp_f32 v120, v120
    v_mfma_f32_16x16x32_bf16 v[140:143], a[188:191], v[108:111], v[140:143]
    v_exp_f32 v121, v121
    v_exp_f32 v122, v122
    v_exp_f32 v123, v123
    v_exp_f32 v136, v136
    v_exp_f32 v137, v137
    v_exp_f32 v138, v138
    v_exp_f32 v139, v139
    ds_read_b128 a[176:179], v16 offset:12288
    ds_read_b128 a[180:183], v17 offset:12288
    ds_read_b128 a[184:187], v18 offset:12288
    ds_read_b128 a[188:191], v19 offset:12288
    v_max3_f32 v13, v124, v125, v126
    v_max3_f32 v236, v127, v140, v141
    v_max3_f32 v13, v13, v142, v143
    v_max_f32 v13, v13, v236
    v_mov_b32 v236, v13
    v_cvt_pk_bf16_f32 v152, v116, v117
    v_cvt_pk_bf16_f32 v153, v118, v119
    v_permlane16_swap_b32 v13, v236
    v_max_f32 v13, v13, v236
    v_mov_b32 v236, v13
    v_cvt_pk_bf16_f32 v154, v132, v133
    v_cvt_pk_bf16_f32 v155, v134, v135
    v_permlane32_swap_b32 v13, v236
    v_max_f32 v13, v13, v236
    v_sub_f32 v124, v124, v13
    v_sub_f32 v125, v125, v13
    v_sub_f32 v126, v126, v13
    v_sub_f32 v127, v127, v13
    v_sub_f32 v140, v140, v13
    v_sub_f32 v141, v141, v13
    v_sub_f32 v142, v142, v13
    v_sub_f32 v143, v143, v13
    v_sub_f32 v188, 0, v13
    v_sub_f32 v189, 0, v13
    v_sub_f32 v190, 0, v13
    v_sub_f32 v191, 0, v13
    v_exp_f32 v124, v124
    v_exp_f32 v125, v125
    v_exp_f32 v126, v126
    v_cvt_pk_bf16_f32 v160, v120, v121
    v_cvt_pk_bf16_f32 v161, v122, v123
    v_cvt_pk_bf16_f32 v162, v136, v137
    v_cvt_pk_bf16_f32 v163, v138, v139
    v_cvt_pk_bf16_f32 v168, v124, v125
L_rolesC:
    v_mov_b32 v36, 0
    s_mov_b64 s[50:51], -1
    s_mov_b32 s43, 12
    s_mov_b32 s48, s92
    s_waitcnt vmcnt(0) lgkmcnt(0)
    s_barrier
.p2align 6
L_loopC:
    s_waitcnt lgkmcnt(0)
    v_mfma_f32_16x16x32_bf16 v[112:115], a[160:163], v[48:51], v[176:179]
    ds_write_b32 v37, v36
    v_add_u32 v36, 1, v36
    v_mfma_f32_16x16x32_bf16 v[112:115], a[164:167], v[52:55], v[112:115]
    v_exp_f32 v127, v127
    v_mfma_f32_16x16x32_bf16 v[112:115], a[168:171], v[56:59], v[112:115]
    ds_read_b64_tr_b16 a[192:193], v20 offset:0
    v_cvt_pk_bf16_f32 v169, v126, v127
    v_mfma_f32_16x16x32_bf16 v[112:115], a[172:175], v[60:63], v[112:115]
    v_exp_f32 v140, v140
    v_mfma_f32_16x16x32_bf16 v[128:131], a[176:179], v[48:51], v[176:179]
    ds_read_b64_tr_b16 a[194:195], v20 offset:4096
    ds_read_b64_tr_b16 a[196:197], v21 offset:0
    v_mfma_f32_16x16x32_bf16 v[128:131], a[180:183], v[52:55], v[128:131]
    v_exp_f32 v141, v141
    v_mfma_f32_16x16x32_bf16 v[128:131], a[184:187], v[56:59], v[128:131]
    ds_read_b64_tr_b16 a[198:199], v21 offset:4096
    v_cvt_pk_bf16_f32 v170, v140, v141
    v_mfma_f32_16x16x32_bf16 v[128:131], a[188:191], v[60:63], v[128:131]
    v_exp_f32 v142, v142
    v_mfma_f32_16x16x32_bf16 v[116:119], a[160:163], v[64:67], v[180:183]
    ds_read_b64_tr_b16 a[200:201], v22 offset:0
    ds_read_b64_tr_b16 a[202:203], v22 offset:4096
    v_mfma_f32_16x16x32_bf16 v[116:119], a[164:167], v[68:71], v[116:119]
    v_exp_f32 v143, v143
    v_mfma_f32_16x16x32_bf16 v[116:119], a[168:171], v[72:75], v[116:119]
    ds_read_b64_tr_b16 a[204:205], v23 offset:0
    v_cvt_pk_bf16_f32 v171, v142, v143
    v_mfma_f32_16x16x32_bf16 v[116:119], a[172:175], v[76:79], v[116:119]
    v_exp_f32 v112, v112
    v_mfma_f32_16x16x32_bf16 v[132:135], a[176:179], v[64:67], v[180:183]
    ds_read_b64_tr_b16 a[206:207], v23 offset:4096
    ds_read_b64_tr_b16 a[208:209], v24 offset:0
    v_mfma_f32_16x16x32_bf16 v[132:135], a[180:183], v[68:71], v[132:135]
    v_exp_f32 v113, v113
    v_mfma_f32_16x16x32_bf16 v[132:135], a[184:187], v[72:75], v[132:135]
    ds_read_b64_tr_b16 a[210:211], v24 offset:4096
    v_cvt_pk_bf16_f32 v148, v112, v113
    v_mfma_f32_16x16x32_bf16 v[132:135], a[188:191], v[76:79], v[132:135]
    v_exp_f32 v114, v114
    v_mfma_f32_16x16x32_bf16 v[120:123], a[160:163], v[80:83], v[184:187]
    ds_read_b64_tr_b16 a[212:213], v25 offset:0
    ds_read_b64_tr_b16 a[214:215], v25 offset:4096
    v_mfma_f32_16x16x32_bf16 v[120:123], a[164:167], v[84:87], v[120:123]
    v_exp_f32 v115, v115
    v_mfma_f32_16x16x32_bf16 v[120:123], a[168:171], v[88:91], v[120:123]
    ds_read_b64_tr_b16 a[216:217], v26 offset:0
    v_cvt_pk_bf16_f32 v149, v114, v115
    v_mfma_f32_16x16x32_bf16 v[120:123], a[172:175], v[92:95], v[120:123]
    v_exp_f32 v128, v128
    v_mfma_f32_16x16x32_bf16 v[136:139], a[176:179], v[80:83], v[184:187]
    ds_read_b64_tr_b16 a[218:219], v26 offset:4096
    ds_read_b64_tr_b16 a[220:221], v27 offset:0
    v_mfma_f32_16x16x32_bf16 v[136:139], a[180:183], v[84:87], v[136:139]
    v_exp_f32 v129, v129
    v_mfma_f32_16x16x32_bf16 v[136:139], a[184:187], v[88:91], v[136:139]
    ds_read_b64_tr_b16 a[222:223], v27 offset:4096
    v_cvt_pk_bf16_f32 v150, v128, v129
    v_mfma_f32_16x16x32_bf16 v[136:139], a[188:191], v[92:95], v[136:139]
    v_exp_f32 v130, v130
    v_mfma_f32_16x16x32_bf16 v[124:127], a[160:163], v[96:99], v[188:191]
    ds_read_b32 v38, v39
    v_xor_b32 v16, s60, v16
    v_mfma_f32_16x16x32_bf16 v[124:127], a[164:167], v[100:103], v[124:127]
    v_exp_f32 v131, v131
    v_mfma_f32_16x16x32_bf16 v[124:127], a[168:171], v[104:107], v[124:127]
    v_cvt_pk_bf16_f32 v151, v130, v131
    v_xor_b32 v17, s60, v17
    v_mfma_f32_16x16x32_bf16 v[124:127], a[172:175], v[108:111], v[124:127]
    v_exp_f32 v116, v116
    v_mfma_f32_16x16x32_bf16 v[140:143], a[176:179], v[96:99], v[188:191]
    v_xor_b32 v18, s60, v18
    v_xor_b32 v19, s60, v19
    v_mfma_f32_16x16x32_bf16 v[140:143], a[180:183], v[100:103], v[140:143]
    v_exp_f32 v117, v117
    v_mfma_f32_16x16x32_bf16 v[140:143], a[184:187], v[104:107], v[140:143]
    v_cvt_pk_bf16_f32 v156, v116, v117
    v_mfma_f32_16x16x32_bf16 v[140:143], a[188:191], v[108:111], v[140:143]
    s_waitcnt lgkmcnt(0)
    v_mfma_f32_16x16x32_bf16 a[0:3], a[192:195], v[144:147], a[0:3]
    v_exp_f32 v118, v118
    v_mfma_f32_16x16x32_bf16 a[16:19], a[196:199], v[144:147], a[16:19]
    v_cmp_gt_u32 vcc, v36, v38
    v_mfma_f32_16x16x32_bf16 a[32:35], a[200:203], v[144:147], a[32:35]
    v_exp_f32 v119, v119
    v_mfma_f32_16x16x32_bf16 a[48:51], a[204:207], v[144:147], a[48:51]
    s_cbranch_vccnz L_waitC0
L_retC0:
    v_cvt_pk_bf16_f32 v157, v118, v119
    v_mfma_f32_16x16x32_bf16 a[64:67], a[208:211], v[144:147], a[64:67]
    v_exp_f32 v132, v132
    v_mfma_f32_16x16x32_bf16 a[80:83], a[212:215], v[144:147], a[80:83]
    ds_read_b128 a[160:163], v16 offset:0
    v_mfma_f32_16x16x32_bf16 a[96:99], a[216:219], v[144:147], a[96:99]
    v_exp_f32 v133, v133
    v_mfma_f32_16x16x32_bf16 a[112:115], a[220:223], v[144:147], a[112:115]
    ds_read_b128 a[164:167], v17 offset:0
    v_cvt_pk_bf16_f32 v158, v132, v133
    v_mfma_f32_16x16x32_bf16 a[4:7], a[192:195], v[152:155], a[4:7]
    v_exp_f32 v134, v134
    v_mfma_f32_16x16x32_bf16 a[20:23], a[196:199], v[152:155], a[20:23]
    ds_read_b128 a[168:171], v18 offset:0
    v_mfma_f32_16x16x32_bf16 a[36:39], a[200:203], v[152:155], a[36:39]
    v_exp_f32 v135, v135
    v_mfma_f32_16x16x32_bf16 a[52:55], a[204:207], v[152:155], a[52:55]
    ds_read_b128 a[172:175], v19 offset:0
    v_cvt_pk_bf16_f32 v159, v134, v135
    v_mfma_f32_16x16x32_bf16 a[68:71], a[208:211], v[152:155], a[68:71]
    v_exp_f32 v120, v120
    v_mfma_f32_16x16x32_bf16 a[84:87], a[212:215], v[152:155], a[84:87]
    ds_read_b128 a[176:179], v16 offset:4096
    v_mfma_f32_16x16x32_bf16 a[100:103], a[216:219], v[152:155], a[100:103]
    v_exp_f32 v121, v121
    v_mfma_f32_16x16x32_bf16 a[116:119], a[220:223], v[152:155], a[116:119]
    ds_read_b128 a[180:183], v17 offset:4096
    v_cvt_pk_bf16_f32 v164, v120, v121
    v_smfmac_f32_16x16x64_bf16 a[128:131], a[144:147], v[144:151], v43
    v_exp_f32 v122, v122
    v_mfma_f32_16x16x32_bf16 a[8:11], a[192:195], v[160:163], a[8:11]
    ds_read_b128 a[184:187], v18 offset:4096
    v_mfma_f32_16x16x32_bf16 a[24:27], a[196:199], v[160:163], a[24:27]
    v_exp_f32 v123, v123
    v_mfma_f32_16x16x32_bf16 a[40:43], a[200:203], v[160:163], a[40:43]
    ds_read_b128 a[188:191], v19 offset:4096
    v_cvt_pk_bf16_f32 v165, v122, v123
    v_mfma_f32_16x16x32_bf16 a[56:59], a[204:207], v[160:163], a[56:59]
    v_exp_f32 v136, v136
    v_mfma_f32_16x16x32_bf16 a[72:75], a[208:211], v[160:163], a[72:75]
    s_cmp_eq_u32 s61, s43
    s_cbranch_scc1 L_eventC
L_evretC:
    v_mfma_f32_16x16x32_bf16 a[88:91], a[212:215], v[160:163], a[88:91]
    v_exp_f32 v137, v137
    v_mfma_f32_16x16x32_bf16 a[104:107], a[216:219], v[160:163], a[104:107]
    v_cvt_pk_bf16_f32 v166, v136, v137
    v_mfma_f32_16x16x32_bf16 a[120:123], a[220:223], v[160:163], a[120:123]
    v_exp_f32 v138, v138
    v_smfmac_f32_16x16x64_bf16 a[132:135], a[144:147], v[152:159], v43
    v_mfma_f32_16x16x32_bf16 a[12:15], a[192:195], v[168:171], a[12:15]
    v_exp_f32 v139, v139
    v_mfma_f32_16x16x32_bf16 a[28:31], a[196:199], v[168:171], a[28:31]
    v_cvt_pk_bf16_f32 v167, v138, v139
    v_mfma_f32_16x16x32_bf16 a[44:47], a[200:203], v[168:171], a[44:47]
    v_exp_f32 v124, v124
    v_mfma_f32_16x16x32_bf16 a[60:63], a[204:207], v[168:171], a[60:63]
    v_mfma_f32_16x16x32_bf16 a[76:79], a[208:211], v[168:171], a[76:79]
    v_exp_f32 v125, v125
    v_mfma_f32_16x16x32_bf16 a[92:95], a[212:215], v[168:171], a[92:95]
    v_cvt_pk_bf16_f32 v172, v124, v125
    v_mfma_f32_16x16x32_bf16 a[108:111], a[216:219], v[168:171], a[108:111]
    v_exp_f32 v126, v126
    v_mfma_f32_16x16x32_bf16 a[124:127], a[220:223], v[168:171], a[124:127]
    s_waitcnt lgkmcnt(0)
    v_mfma_f32_16x16x32_bf16 v[112:115], a[160:163], v[48:51], v[176:179]
    ds_write_b32 v37, v36
    v_add_u32 v36, 1, v36
    v_mfma_f32_16x16x32_bf16 v[112:115], a[164:167], v[52:55], v[112:115]
    v_exp_f32 v127, v127
    v_mfma_f32_16x16x32_bf16 v[112:115], a[168:171], v[56:59], v[112:115]
    ds_read_b64_tr_b16 a[192:193], v20 offset:8192
    v_cvt_pk_bf16_f32 v173, v126, v127
    v_mfma_f32_16x16x32_bf16 v[112:115], a[172:175], v[60:63], v[112:115]
    v_exp_f32 v140, v140
    v_mfma_f32_16x16x32_bf16 v[128:131], a[176:179], v[48:51], v[176:179]
    ds_read_b64_tr_b16 a[194:195], v20 offset:12288
    ds_read_b64_tr_b16 a[196:197], v21 offset:8192
    v_mfma_f32_16x16x32_bf16 v[128:131], a[180:183], v[52:55], v[128:131]
    v_exp_f32 v141, v141
    v_mfma_f32_16x16x32_bf16 v[128:131], a[184:187], v[56:59], v[128:131]
    ds_read_b64_tr_b16 a[198:199], v21 offset:12288
    v_cvt_pk_bf16_f32 v174, v140, v141
    v_mfma_f32_16x16x32_bf16 v[128:131], a[188:191], v[60:63], v[128:131]
    v_exp_f32 v142, v142
    v_mfma_f32_16x16x32_bf16 v[116:119], a[160:163], v[64:67], v[180:183]
    ds_read_b64_tr_b16 a[200:201], v22 offset:8192
    ds_read_b64_tr_b16 a[202:203], v22 offset:12288
    v_mfma_f32_16x16x32_bf16 v[116:119], a[164:167], v[68:71], v[116:119]
    v_exp_f32 v143, v143
    v_mfma_f32_16x16x32_bf16 v[116:119], a[168:171], v[72:75], v[116:119]
    ds_read_b64_tr_b16 a[204:205], v23 offset:8192
    v_cvt_pk_bf16_f32 v175, v142, v143
    v_mfma_f32_16x16x32_bf16 v[116:119], a[172:175], v[76:79], v[116:119]
    v_exp_f32 v112, v112
    v_mfma_f32_16x16x32_bf16 v[132:135], a[176:179], v[64:67], v[180:183]
    ds_read_b64_tr_b16 a[206:207], v23 offset:12288
    ds_read_b64_tr_b16 a[208:209], v24 offset:8192
    v_mfma_f32_16x16x32_bf16 v[132:135], a[180:183], v[68:71], v[132:135]
    v_exp_f32 v113, v113
    v_mfma_f32_16x16x32_bf16 v[132:135], a[184:187], v[72:75], v[132:135]
    ds_read_b64_tr_b16 a[210:211], v24 offset:12288
    v_cvt_pk_bf16_f32 v144, v112, v113
    v_mfma_f32_16x16x32_bf16 v[132:135], a[188:191], v[76:79], v[132:135]
    v_exp_f32 v114, v114
    v_mfma_f32_16x16x32_bf16 v[120:123], a[160:163], v[80:83], v[184:187]
    ds_read_b64_tr_b16 a[212:213], v25 offset:8192
    ds_read_b64_tr_b16 a[214:215], v25 offset:12288
    v_mfma_f32_16x16x32_bf16 v[120:123], a[164:167], v[84:87], v[120:123]
    v_exp_f32 v115, v115
    v_mfma_f32_16x16x32_bf16 v[120:123], a[168:171], v[88:91], v[120:123]
    ds_read_b64_tr_b16 a[216:217], v26 offset:8192
    v_cvt_pk_bf16_f32 v145, v114, v115
    v_mfma_f32_16x16x32_bf16 v[120:123], a[172:175], v[92:95], v[120:123]
    v_exp_f32 v128, v128
    v_mfma_f32_16x16x32_bf16 v[136:139], a[176:179], v[80:83], v[184:187]
    ds_read_b64_tr_b16 a[218:219], v26 offset:12288
    ds_read_b64_tr_b16 a[220:221], v27 offset:8192
    v_mfma_f32_16x16x32_bf16 v[136:139], a[180:183], v[84:87], v[136:139]
    v_exp_f32 v129, v129
    v_mfma_f32_16x16x32_bf16 v[136:139], a[184:187], v[88:91], v[136:139]
    ds_read_b64_tr_b16 a[222:223], v27 offset:12288
    v_cvt_pk_bf16_f32 v146, v128, v129
    v_mfma_f32_16x16x32_bf16 v[136:139], a[188:191], v[92:95], v[136:139]
    v_exp_f32 v130, v130
    v_mfma_f32_16x16x32_bf16 v[124:127], a[160:163], v[96:99], v[188:191]
    ds_read_b32 v38, v39
    v_xor_b32 v20, s60, v20
    v_mfma_f32_16x16x32_bf16 v[124:127], a[164:167], v[100:103], v[124:127]
    v_exp_f32 v131, v131
    v_mfma_f32_16x16x32_bf16 v[124:127], a[168:171], v[104:107], v[124:127]
    v_cvt_pk_bf16_f32 v147, v130, v131
    v_xor_b32 v21, s60, v21
    v_mfma_f32_16x16x32_bf16 v[124:127], a[172:175], v[108:111], v[124:127]
    v_exp_f32 v116, v116
    v_mfma_f32_16x16x32_bf16 v[140:143], a[176:179], v[96:99], v[188:191]
    v_xor_b32 v22, s60, v22
    v_xor_b32 v23, s60, v23
    v_mfma_f32_16x16x32_bf16 v[140:143], a[180:183], v[100:103], v[140:143]
    v_exp_f32 v117, v117
    v_mfma_f32_16x16x32_bf16 v[140:143], a[184:187], v[104:107], v[140:143]
    v_cvt_pk_bf16_f32 v152, v116, v117
    v_xor_b32 v24, s60, v24
    v_mfma_f32_16x16x32_bf16 v[140:143], a[188:191], v[108:111], v[140:143]
    v_xor_b32 v25, s60, v25
    s_waitcnt lgkmcnt(0)
    v_mfma_f32_16x16x32_bf16 a[0:3], a[192:195], v[148:151], a[0:3]
    v_exp_f32 v118, v118
    v_mfma_f32_16x16x32_bf16 a[16:19], a[196:199], v[148:151], a[16:19]
    v_cmp_gt_u32 vcc, v36, v38
    v_xor_b32 v26, s60, v26
    v_mfma_f32_16x16x32_bf16 a[32:35], a[200:203], v[148:151], a[32:35]
    v_exp_f32 v119, v119
    v_mfma_f32_16x16x32_bf16 a[48:51], a[204:207], v[148:151], a[48:51]
    s_cbranch_vccnz L_waitC1
L_retC1:
    v_cvt_pk_bf16_f32 v153, v118, v119
    v_mfma_f32_16x16x32_bf16 a[64:67], a[208:211], v[148:151], a[64:67]
    v_exp_f32 v132, v132
    v_mfma_f32_16x16x32_bf16 a[80:83], a[212:215], v[148:151], a[80:83]
    ds_read_b128 a[160:163], v16 offset:8192
    v_xor_b32 v27, s60, v27
    v_mfma_f32_16x16x32_bf16 a[96:99], a[216:219], v[148:151], a[96:99]
    v_exp_f32 v133, v133
    v_mfma_f32_16x16x32_bf16 a[112:115], a[220:223], v[148:151], a[112:115]
    ds_read_b128 a[164:167], v17 offset:8192
    v_cvt_pk_bf16_f32 v154, v132, v133
    v_smfmac_f32_16x16x64_bf16 a[136:139], a[144:147], v[160:167], v43
    v_exp_f32 v134, v134
    v_mfma_f32_16x16x32_bf16 a[4:7], a[192:195], v[156:159], a[4:7]
    ds_read_b128 a[168:171], v18 offset:8192
    s_add_u32 s61, s61, 1
    v_mfma_f32_16x16x32_bf16 a[20:23], a[196:199], v[156:159], a[20:23]
    v_exp_f32 v135, v135
    v_mfma_f32_16x16x32_bf16 a[36:39], a[200:203], v[156:159], a[36:39]
    ds_read_b128 a[172:175], v19 offset:8192
    v_cvt_pk_bf16_f32 v155, v134, v135
    v_mfma_f32_16x16x32_bf16 a[52:55], a[204:207], v[156:159], a[52:55]
    v_exp_f32 v120, v120
    v_mfma_f32_16x16x32_bf16 a[68:71], a[208:211], v[156:159], a[68:71]
    ds_read_b128 a[176:179], v16 offset:12288
    s_xor_b32 s60, s60, 0xc000
    v_mfma_f32_16x16x32_bf16 a[84:87], a[212:215], v[156:159], a[84:87]
    v_exp_f32 v121, v121
    v_mfma_f32_16x16x32_bf16 a[100:103], a[216:219], v[156:159], a[100:103]
    ds_read_b128 a[180:183], v17 offset:12288
    v_cvt_pk_bf16_f32 v160, v120, v121
    v_mfma_f32_16x16x32_bf16 a[116:119], a[220:223], v[156:159], a[116:119]
    v_exp_f32 v122, v122
    v_smfmac_f32_16x16x64_bf16 a[140:143], a[144:147], v[168:175], v43
    ds_read_b128 a[184:187], v18 offset:12288
    s_cmp_lt_u32 s61, 13
    v_mfma_f32_16x16x32_bf16 a[8:11], a[192:195], v[164:167], a[8:11]
    v_exp_f32 v123, v123
    v_mfma_f32_16x16x32_bf16 a[24:27], a[196:199], v[164:167], a[24:27]
    ds_read_b128 a[188:191], v19 offset:12288
    v_cvt_pk_bf16_f32 v161, v122, v123
    v_mfma_f32_16x16x32_bf16 a[40:43], a[200:203], v[164:167], a[40:43]
    v_exp_f32 v136, v136
    v_mfma_f32_16x16x32_bf16 a[56:59], a[204:207], v[164:167], a[56:59]
    v_mfma_f32_16x16x32_bf16 a[72:75], a[208:211], v[164:167], a[72:75]
    v_exp_f32 v137, v137
    v_mfma_f32_16x16x32_bf16 a[88:91], a[212:215], v[164:167], a[88:91]
    v_cvt_pk_bf16_f32 v162, v136, v137
    v_mfma_f32_16x16x32_bf16 a[104:107], a[216:219], v[164:167], a[104:107]
    v_exp_f32 v138, v138
    v_mfma_f32_16x16x32_bf16 a[120:123], a[220:223], v[164:167], a[120:123]
    v_mfma_f32_16x16x32_bf16 a[12:15], a[192:195], v[172:175], a[12:15]
    v_exp_f32 v139, v139
    v_mfma_f32_16x16x32_bf16 a[28:31], a[196:199], v[172:175], a[28:31]
    v_cvt_pk_bf16_f32 v163, v138, v139
    v_mfma_f32_16x16x32_bf16 a[44:47], a[200:203], v[172:175], a[44:47]
    v_exp_f32 v124, v124
    v_mfma_f32_16x16x32_bf16 a[60:63], a[204:207], v[172:175], a[60:63]
    v_mfma_f32_16x16x32_bf16 a[76:79], a[208:211], v[172:175], a[76:79]
    v_exp_f32 v125, v125
    v_mfma_f32_16x16x32_bf16 a[92:95], a[212:215], v[172:175], a[92:95]
    v_cvt_pk_bf16_f32 v168, v124, v125
    v_mfma_f32_16x16x32_bf16 a[108:111], a[216:219], v[172:175], a[108:111]
    v_exp_f32 v126, v126
    v_mfma_f32_16x16x32_bf16 a[124:127], a[220:223], v[172:175], a[124:127]
    s_cbranch_scc1 L_loopC
    v_xor_b32 v20, 0x4000, v20
    v_xor_b32 v21, 0x4000, v21
    v_xor_b32 v22, 0x4000, v22
    v_xor_b32 v23, 0x4000, v23
    v_xor_b32 v24, 0x4000, v24
    v_xor_b32 v25, 0x4000, v25
    v_xor_b32 v26, 0x4000, v26
    v_xor_b32 v27, 0x4000, v27
    v_xor_b32 v16, 0x4000, v16
    v_xor_b32 v17, 0x4000, v17
    v_xor_b32 v18, 0x4000, v18
    v_xor_b32 v19, 0x4000, v19
    s_waitcnt lgkmcnt(0)
    v_mfma_f32_16x16x32_bf16 v[112:115], a[160:163], v[48:51], v[176:179]
    ds_write_b32 v37, v36
    v_add_u32 v36, 1, v36
    v_mfma_f32_16x16x32_bf16 v[112:115], a[164:167], v[52:55], v[112:115]
    ds_read_b64_tr_b16 a[192:193], v20 offset:16384
    ds_read_b64_tr_b16 a[194:195], v20 offset:20480
    v_exp_f32 v127, v127
    v_mfma_f32_16x16x32_bf16 v[112:115], a[168:171], v[56:59], v[112:115]
    ds_read_b64_tr_b16 a[196:197], v21 offset:16384
    ds_read_b64_tr_b16 a[198:199], v21 offset:20480
    ds_read_b32 v38, v39
    v_cvt_pk_bf16_f32 v169, v126, v127
    v_mfma_f32_16x16x32_bf16 v[112:115], a[172:175], v[60:63], v[112:115]
    v_exp_f32 v140, v140
    v_mfma_f32_16x16x32_bf16 v[128:131], a[176:179], v[48:51], v[176:179]
    v_mfma_f32_16x16x32_bf16 v[128:131], a[180:183], v[52:55], v[128:131]
    v_exp_f32 v141, v141
    v_mfma_f32_16x16x32_bf16 v[128:131], a[184:187], v[56:59], v[128:131]
    v_cvt_pk_bf16_f32 v170, v140, v141
    v_mfma_f32_16x16x32_bf16 v[128:131], a[188:191], v[60:63], v[128:131]
    v_exp_f32 v142, v142
    v_mfma_f32_16x16x32_bf16 v[116:119], a[160:163], v[64:67], v[180:183]
    v_mfma_f32_16x16x32_bf16 v[116:119], a[164:167], v[68:71], v[116:119]
    v_exp_f32 v143, v143
    v_mfma_f32_16x16x32_bf16 v[116:119], a[168:171], v[72:75], v[116:119]
    v_cvt_pk_bf16_f32 v171, v142, v143
    v_mfma_f32_16x16x32_bf16 v[116:119], a[172:175], v[76:79], v[116:119]
    v_exp_f32 v112, v112
    v_mfma_f32_16x16x32_bf16 v[132:135], a[176:179], v[64:67], v[180:183]
    buffer_load_dword v41, v42, s[20:23], s48 offen
    v_exp_f32 v113, v113
    v_mfma_f32_16x16x32_bf16 v[132:135], a[180:183], v[68:71], v[132:135]
    v_cvt_pk_bf16_f32 v148, v112, v113
    v_exp_f32 v114, v114
    v_mfma_f32_16x16x32_bf16 v[132:135], a[184:187], v[72:75], v[132:135]
    v_exp_f32 v115, v115
    v_mfma_f32_16x16x32_bf16 v[132:135], a[188:191], v[76:79], v[132:135]
    v_cvt_pk_bf16_f32 v149, v114, v115
    v_exp_f32 v128, v128
    v_mfma_f32_16x16x32_bf16 v[120:123], a[160:163], v[80:83], v[184:187]
    v_exp_f32 v129, v129
    v_mfma_f32_16x16x32_bf16 v[120:123], a[164:167], v[84:87], v[120:123]
    v_cvt_pk_bf16_f32 v150, v128, v129
    v_exp_f32 v130, v130
    v_mfma_f32_16x16x32_bf16 v[120:123], a[168:171], v[88:91], v[120:123]
    v_mfma_f32_16x16x32_bf16 v[120:123], a[172:175], v[92:95], v[120:123]
    v_exp_f32 v131, v131
    v_mfma_f32_16x16x32_bf16 v[136:139], a[176:179], v[80:83], v[184:187]
    v_cvt_pk_bf16_f32 v151, v130, v131
    v_exp_f32 v116, v116
    v_mfma_f32_16x16x32_bf16 v[136:139], a[180:183], v[84:87], v[136:139]
    v_exp_f32 v117, v117
    v_mfma_f32_16x16x32_bf16 v[136:139], a[184:187], v[88:91], v[136:139]
    v_cvt_pk_bf16_f32 v156, v116, v117
    v_exp_f32 v118, v118
    v_mfma_f32_16x16x32_bf16 v[136:139], a[188:191], v[92:95], v[136:139]
    v_exp_f32 v119, v119
    v_mfma_f32_16x16x32_bf16 v[124:127], a[160:163], v[96:99], v[188:191]
    v_cvt_pk_bf16_f32 v157, v118, v119
    v_exp_f32 v132, v132
    v_mfma_f32_16x16x32_bf16 v[124:127], a[164:167], v[100:103], v[124:127]
    v_mfma_f32_16x16x32_bf16 v[124:127], a[168:171], v[104:107], v[124:127]
    v_exp_f32 v133, v133
    v_mfma_f32_16x16x32_bf16 v[124:127], a[172:175], v[108:111], v[124:127]
    v_cvt_pk_bf16_f32 v158, v132, v133
    v_exp_f32 v134, v134
    v_mfma_f32_16x16x32_bf16 v[140:143], a[176:179], v[96:99], v[188:191]
    v_exp_f32 v135, v135
    v_mfma_f32_16x16x32_bf16 v[140:143], a[180:183], v[100:103], v[140:143]
    v_cvt_pk_bf16_f32 v159, v134, v135
    v_exp_f32 v120, v120
    v_mfma_f32_16x16x32_bf16 v[140:143], a[184:187], v[104:107], v[140:143]
    v_exp_f32 v121, v121
    v_mfma_f32_16x16x32_bf16 v[140:143], a[188:191], v[108:111], v[140:143]
    v_cvt_pk_bf16_f32 v164, v120, v121
    v_exp_f32 v122, v122
    s_waitcnt lgkmcnt(0)
    v_mfma_f32_16x16x32_bf16 a[0:3], a[192:195], v[144:147], a[0:3]
    v_exp_f32 v123, v123
    v_cmp_gt_u32 vcc, v36, v38
    v_mfma_f32_16x16x32_bf16 a[16:19], a[196:199], v[144:147], a[16:19]
    s_cbranch_vccnz L_waitC26
L_retC26:
    ds_read_b128 a[160:163], v16 offset:49152
    ds_read_b128 a[164:167], v17 offset:49152
    ds_read_b128 a[168:171], v18 offset:49152
    v_cvt_pk_bf16_f32 v165, v122, v123
    v_mfma_f32_16x16x32_bf16 a[4:7], a[192:195], v[152:155], a[4:7]
    ds_read_b128 a[172:175], v19 offset:49152
    ds_read_b128 a[176:179], v16 offset:53248
    ds_read_b128 a[180:183], v17 offset:53248
    v_exp_f32 v136, v136
    v_mfma_f32_16x16x32_bf16 a[20:23], a[196:199], v[152:155], a[20:23]
    ds_read_b128 a[184:187], v18 offset:53248
    ds_read_b128 a[188:191], v19 offset:53248
    v_exp_f32 v137, v137
    v_smfmac_f32_16x16x64_bf16 a[128:131], a[144:147], v[144:151], v43
    v_cvt_pk_bf16_f32 v166, v136, v137
    v_exp_f32 v138, v138
    v_mfma_f32_16x16x32_bf16 a[8:11], a[192:195], v[160:163], a[8:11]
    v_exp_f32 v139, v139
    v_mfma_f32_16x16x32_bf16 a[24:27], a[196:199], v[160:163], a[24:27]
    v_cvt_pk_bf16_f32 v167, v138, v139
    v_exp_f32 v124, v124
    v_smfmac_f32_16x16x64_bf16 a[132:135], a[144:147], v[152:159], v43
    v_exp_f32 v125, v125
    v_mfma_f32_16x16x32_bf16 a[12:15], a[192:195], v[168:171], a[12:15]
    v_cvt_pk_bf16_f32 v172, v124, v125
    v_mfma_f32_16x16x32_bf16 a[28:31], a[196:199], v[168:171], a[28:31]
    v_exp_f32 v126, v126
    s_waitcnt lgkmcnt(0)
    v_mfma_f32_16x16x32_bf16 v[112:115], a[160:163], v[48:51], v[176:179]
    ds_write_b32 v37, v36
    v_add_u32 v36, 1, v36
    v_mfma_f32_16x16x32_bf16 v[112:115], a[164:167], v[52:55], v[112:115]
    ds_read_b64_tr_b16 a[192:193], v20 offset:24576
    ds_read_b64_tr_b16 a[194:195], v20 offset:28672
    v_exp_f32 v127, v127
    v_mfma_f32_16x16x32_bf16 v[112:115], a[168:171], v[56:59], v[112:115]
    ds_read_b64_tr_b16 a[196:197], v21 offset:24576
    ds_read_b64_tr_b16 a[198:199], v21 offset:28672
    ds_read_b32 v38, v39
    v_cvt_pk_bf16_f32 v173, v126, v127
    v_mfma_f32_16x16x32_bf16 v[112:115], a[172:175], v[60:63], v[112:115]
    v_exp_f32 v140, v140
    v_mfma_f32_16x16x32_bf16 v[128:131], a[176:179], v[48:51], v[176:179]
    v_mfma_f32_16x16x32_bf16 v[128:131], a[180:183], v[52:55], v[128:131]
    v_exp_f32 v141, v141
    v_mfma_f32_16x16x32_bf16 v[128:131], a[184:187], v[56:59], v[128:131]
    v_cvt_pk_bf16_f32 v174, v140, v141
    v_mfma_f32_16x16x32_bf16 v[128:131], a[188:191], v[60:63], v[128:131]
    v_exp_f32 v142, v142
    v_mfma_f32_16x16x32_bf16 v[116:119], a[160:163], v[64:67], v[180:183]
    v_mfma_f32_16x16x32_bf16 v[116:119], a[164:167], v[68:71], v[116:119]
    v_exp_f32 v143, v143
    v_mfma_f32_16x16x32_bf16 v[116:119], a[168:171], v[72:75], v[116:119]
    v_cvt_pk_bf16_f32 v175, v142, v143
    v_mfma_f32_16x16x32_bf16 v[116:119], a[172:175], v[76:79], v[116:119]
    v_exp_f32 v112, v112
    v_mfma_f32_16x16x32_bf16 v[132:135], a[176:179], v[64:67], v[180:183]
    v_exp_f32 v113, v113
    v_mfma_f32_16x16x32_bf16 v[132:135], a[180:183], v[68:71], v[132:135]
    v_cvt_pk_bf16_f32 v192, v112, v113
    v_exp_f32 v114, v114
    v_mfma_f32_16x16x32_bf16 v[132:135], a[184:187], v[72:75], v[132:135]
    v_exp_f32 v115, v115
    v_mfma_f32_16x16x32_bf16 v[132:135], a[188:191], v[76:79], v[132:135]
    v_cvt_pk_bf16_f32 v193, v114, v115
    v_exp_f32 v128, v128
    v_mfma_f32_16x16x32_bf16 v[120:123], a[160:163], v[80:83], v[184:187]
    v_exp_f32 v129, v129
    v_mfma_f32_16x16x32_bf16 v[120:123], a[164:167], v[84:87], v[120:123]
    v_cvt_pk_bf16_f32 v194, v128, v129
    v_exp_f32 v130, v130
    v_mfma_f32_16x16x32_bf16 v[120:123], a[168:171], v[88:91], v[120:123]
    v_mfma_f32_16x16x32_bf16 v[120:123], a[172:175], v[92:95], v[120:123]
    v_exp_f32 v131, v131
    v_mfma_f32_16x16x32_bf16 v[136:139], a[176:179], v[80:83], v[184:187]
    v_cvt_pk_bf16_f32 v195, v130, v131
    v_exp_f32 v116, v116
    v_mfma_f32_16x16x32_bf16 v[136:139], a[180:183], v[84:87], v[136:139]
    v_exp_f32 v117, v117
    v_mfma_f32_16x16x32_bf16 v[136:139], a[184:187], v[88:91], v[136:139]
    v_cvt_pk_bf16_f32 v200, v116, v117
    v_exp_f32 v118, v118
    v_mfma_f32_16x16x32_bf16 v[136:139], a[188:191], v[92:95], v[136:139]
    v_exp_f32 v119, v119
    v_mfma_f32_16x16x32_bf16 v[124:127], a[160:163], v[96:99], v[188:191]
    v_cvt_pk_bf16_f32 v201, v118, v119
    v_exp_f32 v132, v132
    v_mfma_f32_16x16x32_bf16 v[124:127], a[164:167], v[100:103], v[124:127]
    v_mfma_f32_16x16x32_bf16 v[124:127], a[168:171], v[104:107], v[124:127]
    v_exp_f32 v133, v133
    v_mfma_f32_16x16x32_bf16 v[124:127], a[172:175], v[108:111], v[124:127]
    v_cvt_pk_bf16_f32 v202, v132, v133
    v_exp_f32 v134, v134
    v_mfma_f32_16x16x32_bf16 v[140:143], a[176:179], v[96:99], v[188:191]
    v_exp_f32 v135, v135
    v_mfma_f32_16x16x32_bf16 v[140:143], a[180:183], v[100:103], v[140:143]
    v_cvt_pk_bf16_f32 v203, v134, v135
    v_exp_f32 v120, v120
    v_mfma_f32_16x16x32_bf16 v[140:143], a[184:187], v[104:107], v[140:143]
    v_exp_f32 v121, v121
    v_mfma_f32_16x16x32_bf16 v[140:143], a[188:191], v[108:111], v[140:143]
    v_cvt_pk_bf16_f32 v208, v120, v121
    v_exp_f32 v122, v122
    s_waitcnt lgkmcnt(0)
    v_mfma_f32_16x16x32_bf16 a[0:3], a[192:195], v[148:151], a[0:3]
    v_exp_f32 v123, v123
    v_cmp_gt_u32 vcc, v36, v38
    v_mfma_f32_16x16x32_bf16 a[16:19], a[196:199], v[148:151], a[16:19]
    s_cbranch_vccnz L_waitC27
L_retC27:
    ds_read_b128 a[160:163], v16 offset:57344
    ds_read_b128 a[164:167], v17 offset:57344
    ds_read_b128 a[168:171], v18 offset:57344
    v_cvt_pk_bf16_f32 v209, v122, v123
    v_smfmac_f32_16x16x64_bf16 a[136:139], a[144:147], v[160:167], v43
    ds_read_b128 a[172:175], v19 offset:57344
    ds_read_b128 a[176:179], v16 offset:61440
    ds_read_b128 a[180:183], v17 offset:61440
    v_exp_f32 v136, v136
    v_mfma_f32_16x16x32_bf16 a[4:7], a[192:195], v[156:159], a[4:7]
    ds_read_b128 a[184:187], v18 offset:61440
    ds_read_b128 a[188:191], v19 offset:61440
    v_exp_f32 v137, v137
    v_mfma_f32_16x16x32_bf16 a[20:23], a[196:199], v[156:159], a[20:23]
    v_cvt_pk_bf16_f32 v210, v136, v137
    v_exp_f32 v138, v138
    v_smfmac_f32_16x16x64_bf16 a[140:143], a[144:147], v[168:175], v43
    v_exp_f32 v139, v139
    v_mfma_f32_16x16x32_bf16 a[8:11], a[192:195], v[164:167], a[8:11]
    v_cvt_pk_bf16_f32 v211, v138, v139
    v_exp_f32 v124, v124
    v_mfma_f32_16x16x32_bf16 a[24:27], a[196:199], v[164:167], a[24:27]
    v_exp_f32 v125, v125
    v_mfma_f32_16x16x32_bf16 a[12:15], a[192:195], v[172:175], a[12:15]
    v_cvt_pk_bf16_f32 v216, v124, v125
    v_mfma_f32_16x16x32_bf16 a[28:31], a[196:199], v[172:175], a[28:31]
    v_exp_f32 v126, v126
    s_waitcnt lgkmcnt(0)
    v_mfma_f32_16x16x32_bf16 v[112:115], a[160:163], v[48:51], v[176:179]
    ds_write_b32 v37, v36
    v_add_u32 v36, 1, v36
    v_mfma_f32_16x16x32_bf16 v[112:115], a[164:167], v[52:55], v[112:115]
    ds_read_b64_tr_b16 a[192:193], v20 offset:49152
    ds_read_b64_tr_b16 a[194:195], v20 offset:53248
    v_exp_f32 v127, v127
    v_mfma_f32_16x16x32_bf16 v[112:115], a[168:171], v[56:59], v[112:115]
    ds_read_b64_tr_b16 a[196:197], v21 offset:49152
    ds_read_b64_tr_b16 a[198:199], v21 offset:53248
    ds_read_b32 v38, v39
    v_cvt_pk_bf16_f32 v217, v126, v127
    v_mfma_f32_16x16x32_bf16 v[112:115], a[172:175], v[60:63], v[112:115]
    v_exp_f32 v140, v140
    v_mfma_f32_16x16x32_bf16 v[128:131], a[176:179], v[48:51], v[176:179]
    v_mfma_f32_16x16x32_bf16 v[128:131], a[180:183], v[52:55], v[128:131]
    v_exp_f32 v141, v141
    v_mfma_f32_16x16x32_bf16 v[128:131], a[184:187], v[56:59], v[128:131]
    v_cvt_pk_bf16_f32 v218, v140, v141
    v_mfma_f32_16x16x32_bf16 v[128:131], a[188:191], v[60:63], v[128:131]
    v_exp_f32 v142, v142
    v_mfma_f32_16x16x32_bf16 v[116:119], a[160:163], v[64:67], v[180:183]
    v_mfma_f32_16x16x32_bf16 v[116:119], a[164:167], v[68:71], v[116:119]
    v_exp_f32 v143, v143
    v_mfma_f32_16x16x32_bf16 v[116:119], a[168:171], v[72:75], v[116:119]
    v_cvt_pk_bf16_f32 v219, v142, v143
    v_mfma_f32_16x16x32_bf16 v[116:119], a[172:175], v[76:79], v[116:119]
    v_exp_f32 v112, v112
    v_mfma_f32_16x16x32_bf16 v[132:135], a[176:179], v[64:67], v[180:183]
    v_exp_f32 v113, v113
    v_mfma_f32_16x16x32_bf16 v[132:135], a[180:183], v[68:71], v[132:135]
    v_cvt_pk_bf16_f32 v196, v112, v113
    v_exp_f32 v114, v114
    v_mfma_f32_16x16x32_bf16 v[132:135], a[184:187], v[72:75], v[132:135]
    v_exp_f32 v115, v115
    v_mfma_f32_16x16x32_bf16 v[132:135], a[188:191], v[76:79], v[132:135]
    v_cvt_pk_bf16_f32 v197, v114, v115
    v_exp_f32 v128, v128
    v_mfma_f32_16x16x32_bf16 v[120:123], a[160:163], v[80:83], v[184:187]
    v_exp_f32 v129, v129
    v_mfma_f32_16x16x32_bf16 v[120:123], a[164:167], v[84:87], v[120:123]
    v_cvt_pk_bf16_f32 v198, v128, v129
    v_exp_f32 v130, v130
    v_mfma_f32_16x16x32_bf16 v[120:123], a[168:171], v[88:91], v[120:123]
    v_mfma_f32_16x16x32_bf16 v[120:123], a[172:175], v[92:95], v[120:123]
    v_exp_f32 v131, v131
    v_mfma_f32_16x16x32_bf16 v[136:139], a[176:179], v[80:83], v[184:187]
    v_cvt_pk_bf16_f32 v199, v130, v131
    v_exp_f32 v116, v116
    v_mfma_f32_16x16x32_bf16 v[136:139], a[180:183], v[84:87], v[136:139]
    v_exp_f32 v117, v117
    v_mfma_f32_16x16x32_bf16 v[136:139], a[184:187], v[88:91], v[136:139]
    v_cvt_pk_bf16_f32 v204, v116, v117
    v_exp_f32 v118, v118
    v_mfma_f32_16x16x32_bf16 v[136:139], a[188:191], v[92:95], v[136:139]
    v_exp_f32 v119, v119
    v_mfma_f32_16x16x32_bf16 v[124:127], a[160:163], v[96:99], v[188:191]
    v_cvt_pk_bf16_f32 v205, v118, v119
    v_exp_f32 v132, v132
    v_mfma_f32_16x16x32_bf16 v[124:127], a[164:167], v[100:103], v[124:127]
    v_mfma_f32_16x16x32_bf16 v[124:127], a[168:171], v[104:107], v[124:127]
    v_exp_f32 v133, v133
    v_mfma_f32_16x16x32_bf16 v[124:127], a[172:175], v[108:111], v[124:127]
    v_cvt_pk_bf16_f32 v206, v132, v133
    v_exp_f32 v134, v134
    v_mfma_f32_16x16x32_bf16 v[140:143], a[176:179], v[96:99], v[188:191]
    v_exp_f32 v135, v135
    v_mfma_f32_16x16x32_bf16 v[140:143], a[180:183], v[100:103], v[140:143]
    v_cvt_pk_bf16_f32 v207, v134, v135
    v_exp_f32 v120, v120
    v_mfma_f32_16x16x32_bf16 v[140:143], a[184:187], v[104:107], v[140:143]
    v_exp_f32 v121, v121
    v_mfma_f32_16x16x32_bf16 v[140:143], a[188:191], v[108:111], v[140:143]
    v_cvt_pk_bf16_f32 v212, v120, v121
    v_exp_f32 v122, v122
    s_waitcnt lgkmcnt(0)
    v_mfma_f32_16x16x32_bf16 a[0:3], a[192:195], v[192:195], a[0:3]
    v_exp_f32 v123, v123
    v_cmp_gt_u32 vcc, v36, v38
    v_mfma_f32_16x16x32_bf16 a[16:19], a[196:199], v[192:195], a[16:19]
    s_cbranch_vccnz L_waitC28
L_retC28:
    ds_read_b128 a[160:163], v16 offset:32768
    ds_read_b128 a[164:167], v17 offset:32768
    ds_read_b128 a[168:171], v18 offset:32768
    v_cvt_pk_bf16_f32 v213, v122, v123
    v_mfma_f32_16x16x32_bf16 a[4:7], a[192:195], v[200:203], a[4:7]
    ds_read_b128 a[172:175], v19 offset:32768
    ds_read_b128 a[176:179], v16 offset:36864
    ds_read_b128 a[180:183], v17 offset:36864
    v_exp_f32 v136, v136
    v_mfma_f32_16x16x32_bf16 a[20:23], a[196:199], v[200:203], a[20:23]
    ds_read_b128 a[184:187], v18 offset:36864
    ds_read_b128 a[188:191], v19 offset:36864
    v_exp_f32 v137, v137
    v_smfmac_f32_16x16x64_bf16 a[128:131], a[144:147], v[192:199], v43
    v_cvt_pk_bf16_f32 v214, v136, v137
    v_exp_f32 v138, v138
    v_mfma_f32_16x16x32_bf16 a[8:11], a[192:195], v[208:211], a[8:11]
    v_exp_f32 v139, v139
    v_mfma_f32_16x16x32_bf16 a[24:27], a[196:199], v[208:211], a[24:27]
    v_cvt_pk_bf16_f32 v215, v138, v139
    v_exp_f32 v124, v124
    v_smfmac_f32_16x16x64_bf16 a[132:135], a[144:147], v[200:207], v43
    v_exp_f32 v125, v125
    v_mfma_f32_16x16x32_bf16 a[12:15], a[192:195], v[216:219], a[12:15]
    v_cvt_pk_bf16_f32 v220, v124, v125
    v_mfma_f32_16x16x32_bf16 a[28:31], a[196:199], v[216:219], a[28:31]
    v_exp_f32 v126, v126
    s_waitcnt lgkmcnt(0)
    v_mfma_f32_16x16x32_bf16 v[112:115], a[160:163], v[48:51], v[176:179]
    ds_write_b32 v37, v36
    v_add_u32 v36, 1, v36
    v_mfma_f32_16x16x32_bf16 v[112:115], a[164:167], v[52:55], v[112:115]
    ds_read_b64_tr_b16 a[192:193], v20 offset:57344
    ds_read_b64_tr_b16 a[194:195], v20 offset:61440
    v_exp_f32 v127, v127
    v_mfma_f32_16x16x32_bf16 v[112:115], a[168:171], v[56:59], v[112:115]
    ds_read_b64_tr_b16 a[196:197], v21 offset:57344
    ds_read_b64_tr_b16 a[198:199], v21 offset:61440
    ds_read_b32 v38, v39
    v_cvt_pk_bf16_f32 v221, v126, v127
    v_mfma_f32_16x16x32_bf16 v[112:115], a[172:175], v[60:63], v[112:115]
    v_exp_f32 v140, v140
    v_mfma_f32_16x16x32_bf16 v[128:131], a[176:179], v[48:51], v[176:179]
    v_mfma_f32_16x16x32_bf16 v[128:131], a[180:183], v[52:55], v[128:131]
    v_exp_f32 v141, v141
    v_mfma_f32_16x16x32_bf16 v[128:131], a[184:187], v[56:59], v[128:131]
    v_cvt_pk_bf16_f32 v222, v140, v141
    v_mfma_f32_16x16x32_bf16 v[128:131], a[188:191], v[60:63], v[128:131]
    v_exp_f32 v142, v142
    v_mfma_f32_16x16x32_bf16 v[116:119], a[160:163], v[64:67], v[180:183]
    v_mfma_f32_16x16x32_bf16 v[116:119], a[164:167], v[68:71], v[116:119]
    v_exp_f32 v143, v143
    v_mfma_f32_16x16x32_bf16 v[116:119], a[168:171], v[72:75], v[116:119]
    v_cvt_pk_bf16_f32 v223, v142, v143
    v_mfma_f32_16x16x32_bf16 v[116:119], a[172:175], v[76:79], v[116:119]
    v_exp_f32 v112, v112
    v_mfma_f32_16x16x32_bf16 v[132:135], a[176:179], v[64:67], v[180:183]
    v_exp_f32 v113, v113
    v_mfma_f32_16x16x32_bf16 v[132:135], a[180:183], v[68:71], v[132:135]
    v_cvt_pk_bf16_f32 v224, v112, v113
    v_exp_f32 v114, v114
    v_mfma_f32_16x16x32_bf16 v[132:135], a[184:187], v[72:75], v[132:135]
    v_exp_f32 v115, v115
    v_mfma_f32_16x16x32_bf16 v[132:135], a[188:191], v[76:79], v[132:135]
    v_cvt_pk_bf16_f32 v225, v114, v115
    v_exp_f32 v128, v128
    v_mfma_f32_16x16x32_bf16 v[120:123], a[160:163], v[80:83], v[184:187]
    v_exp_f32 v129, v129
    v_mfma_f32_16x16x32_bf16 v[120:123], a[164:167], v[84:87], v[120:123]
    v_cvt_pk_bf16_f32 v226, v128, v129
    v_exp_f32 v130, v130
    v_mfma_f32_16x16x32_bf16 v[120:123], a[168:171], v[88:91], v[120:123]
    v_mfma_f32_16x16x32_bf16 v[120:123], a[172:175], v[92:95], v[120:123]
    v_exp_f32 v131, v131
    v_mfma_f32_16x16x32_bf16 v[136:139], a[176:179], v[80:83], v[184:187]
    v_cvt_pk_bf16_f32 v227, v130, v131
    v_exp_f32 v116, v116
    v_mfma_f32_16x16x32_bf16 v[136:139], a[180:183], v[84:87], v[136:139]
    v_exp_f32 v117, v117
    v_mfma_f32_16x16x32_bf16 v[136:139], a[184:187], v[88:91], v[136:139]
    v_cvt_pk_bf16_f32 v232, v116, v117
    v_exp_f32 v118, v118
    v_mfma_f32_16x16x32_bf16 v[136:139], a[188:191], v[92:95], v[136:139]
    v_exp_f32 v119, v119
    v_mfma_f32_16x16x32_bf16 v[124:127], a[160:163], v[96:99], v[188:191]
    v_cvt_pk_bf16_f32 v233, v118, v119
    v_exp_f32 v132, v132
    v_mfma_f32_16x16x32_bf16 v[124:127], a[164:167], v[100:103], v[124:127]
    v_mfma_f32_16x16x32_bf16 v[124:127], a[168:171], v[104:107], v[124:127]
    v_exp_f32 v133, v133
    v_mfma_f32_16x16x32_bf16 v[124:127], a[172:175], v[108:111], v[124:127]
    v_cvt_pk_bf16_f32 v234, v132, v133
    v_exp_f32 v134, v134
    v_mfma_f32_16x16x32_bf16 v[140:143], a[176:179], v[96:99], v[188:191]
    v_exp_f32 v135, v135
    v_mfma_f32_16x16x32_bf16 v[140:143], a[180:183], v[100:103], v[140:143]
    v_cvt_pk_bf16_f32 v235, v134, v135
    v_exp_f32 v120, v120
    v_mfma_f32_16x16x32_bf16 v[140:143], a[184:187], v[104:107], v[140:143]
    v_exp_f32 v121, v121
    v_mfma_f32_16x16x32_bf16 v[140:143], a[188:191], v[108:111], v[140:143]
    v_cvt_pk_bf16_f32 v240, v120, v121
    v_exp_f32 v122, v122
    s_waitcnt lgkmcnt(0)
    v_mfma_f32_16x16x32_bf16 a[0:3], a[192:195], v[196:199], a[0:3]
    v_exp_f32 v123, v123
    v_cmp_gt_u32 vcc, v36, v38
    v_mfma_f32_16x16x32_bf16 a[16:19], a[196:199], v[196:199], a[16:19]
    s_cbranch_vccnz L_waitC29
L_retC29:
    ds_read_b128 a[160:163], v16 offset:40960
    ds_read_b128 a[164:167], v17 offset:40960
    ds_read_b128 a[168:171], v18 offset:40960
    v_cvt_pk_bf16_f32 v241, v122, v123
    v_smfmac_f32_16x16x64_bf16 a[136:139], a[144:147], v[208:215], v43
    ds_read_b128 a[172:175], v19 offset:40960
    ds_read_b128 a[176:179], v16 offset:45056
    ds_read_b128 a[180:183], v17 offset:45056
    v_exp_f32 v136, v136
    v_mfma_f32_16x16x32_bf16 a[4:7], a[192:195], v[204:207], a[4:7]
    ds_read_b128 a[184:187], v18 offset:45056
    ds_read_b128 a[188:191], v19 offset:45056
    v_exp_f32 v137, v137
    v_mfma_f32_16x16x32_bf16 a[20:23], a[196:199], v[204:207], a[20:23]
    v_cvt_pk_bf16_f32 v242, v136, v137
    v_exp_f32 v138, v138
    v_smfmac_f32_16x16x64_bf16 a[140:143], a[144:147], v[216:223], v43
    v_exp_f32 v139, v139
    v_mfma_f32_16x16x32_bf16 a[8:11], a[192:195], v[212:215], a[8:11]
    v_cvt_pk_bf16_f32 v243, v138, v139
    v_exp_f32 v124, v124
    v_mfma_f32_16x16x32_bf16 a[24:27], a[196:199], v[212:215], a[24:27]
    v_exp_f32 v125, v125
    v_mfma_f32_16x16x32_bf16 a[12:15], a[192:195], v[220:223], a[12:15]
    v_cvt_pk_bf16_f32 v248, v124, v125
    v_mfma_f32_16x16x32_bf16 a[28:31], a[196:199], v[220:223], a[28:31]
    v_exp_f32 v126, v126
    s_waitcnt lgkmcnt(0)
    v_mfma_f32_16x16x32_bf16 v[112:115], a[160:163], v[48:51], v[176:179]
    ds_write_b32 v37, v36
    v_add_u32 v36, 1, v36
    v_mfma_f32_16x16x32_bf16 v[112:115], a[164:167], v[52:55], v[112:115]
    ds_read_b64_tr_b16 a[192:193], v20 offset:32768
    ds_read_b64_tr_b16 a[194:195], v20 offset:36864
    v_exp_f32 v127, v127
    v_mfma_f32_16x16x32_bf16 v[112:115], a[168:171], v[56:59], v[112:115]
    ds_read_b64_tr_b16 a[196:197], v21 offset:32768
    ds_read_b64_tr_b16 a[198:199], v21 offset:36864
    ds_read_b32 v38, v39
    v_cvt_pk_bf16_f32 v249, v126, v127
    v_mfma_f32_16x16x32_bf16 v[112:115], a[172:175], v[60:63], v[112:115]
    v_exp_f32 v140, v140
    v_mfma_f32_16x16x32_bf16 v[128:131], a[176:179], v[48:51], v[176:179]
    v_mfma_f32_16x16x32_bf16 v[128:131], a[180:183], v[52:55], v[128:131]
    v_exp_f32 v141, v141
    v_mfma_f32_16x16x32_bf16 v[128:131], a[184:187], v[56:59], v[128:131]
    v_cvt_pk_bf16_f32 v250, v140, v141
    v_mfma_f32_16x16x32_bf16 v[128:131], a[188:191], v[60:63], v[128:131]
    v_exp_f32 v142, v142
    v_mfma_f32_16x16x32_bf16 v[116:119], a[160:163], v[64:67], v[180:183]
    v_mfma_f32_16x16x32_bf16 v[116:119], a[164:167], v[68:71], v[116:119]
    v_exp_f32 v143, v143
    v_mfma_f32_16x16x32_bf16 v[116:119], a[168:171], v[72:75], v[116:119]
    v_cvt_pk_bf16_f32 v251, v142, v143
    v_mfma_f32_16x16x32_bf16 v[116:119], a[172:175], v[76:79], v[116:119]
    v_exp_f32 v112, v112
    v_mfma_f32_16x16x32_bf16 v[132:135], a[176:179], v[64:67], v[180:183]
    v_exp_f32 v113, v113
    v_mfma_f32_16x16x32_bf16 v[132:135], a[180:183], v[68:71], v[132:135]
    v_cvt_pk_bf16_f32 v228, v112, v113
    v_exp_f32 v114, v114
    v_mfma_f32_16x16x32_bf16 v[132:135], a[184:187], v[72:75], v[132:135]
    v_exp_f32 v115, v115
    v_mfma_f32_16x16x32_bf16 v[132:135], a[188:191], v[76:79], v[132:135]
    v_cvt_pk_bf16_f32 v229, v114, v115
    v_exp_f32 v128, v128
    v_mfma_f32_16x16x32_bf16 v[120:123], a[160:163], v[80:83], v[184:187]
    v_exp_f32 v129, v129
    v_mfma_f32_16x16x32_bf16 v[120:123], a[164:167], v[84:87], v[120:123]
    v_cvt_pk_bf16_f32 v230, v128, v129
    v_exp_f32 v130, v130
    v_mfma_f32_16x16x32_bf16 v[120:123], a[168:171], v[88:91], v[120:123]
    v_mfma_f32_16x16x32_bf16 v[120:123], a[172:175], v[92:95], v[120:123]
    v_exp_f32 v131, v131
    v_mfma_f32_16x16x32_bf16 v[136:139], a[176:179], v[80:83], v[184:187]
    v_cvt_pk_bf16_f32 v231, v130, v131
    v_exp_f32 v116, v116
    v_mfma_f32_16x16x32_bf16 v[136:139], a[180:183], v[84:87], v[136:139]
    v_exp_f32 v117, v117
    v_mfma_f32_16x16x32_bf16 v[136:139], a[184:187], v[88:91], v[136:139]
    v_cvt_pk_bf16_f32 v236, v116, v117
    v_exp_f32 v118, v118
    v_mfma_f32_16x16x32_bf16 v[136:139], a[188:191], v[92:95], v[136:139]
    v_exp_f32 v119, v119
    v_mfma_f32_16x16x32_bf16 v[124:127], a[160:163], v[96:99], v[188:191]
    v_cvt_pk_bf16_f32 v237, v118, v119
    v_exp_f32 v132, v132
    v_mfma_f32_16x16x32_bf16 v[124:127], a[164:167], v[100:103], v[124:127]
    v_mfma_f32_16x16x32_bf16 v[124:127], a[168:171], v[104:107], v[124:127]
    v_exp_f32 v133, v133
    v_mfma_f32_16x16x32_bf16 v[124:127], a[172:175], v[108:111], v[124:127]
    v_cvt_pk_bf16_f32 v238, v132, v133
    v_exp_f32 v134, v134
    v_mfma_f32_16x16x32_bf16 v[140:143], a[176:179], v[96:99], v[188:191]
    v_exp_f32 v135, v135
    v_mfma_f32_16x16x32_bf16 v[140:143], a[180:183], v[100:103], v[140:143]
    v_cvt_pk_bf16_f32 v239, v134, v135
    v_exp_f32 v120, v120
    v_mfma_f32_16x16x32_bf16 v[140:143], a[184:187], v[104:107], v[140:143]
    v_exp_f32 v121, v121
    v_mfma_f32_16x16x32_bf16 v[140:143], a[188:191], v[108:111], v[140:143]
    v_cvt_pk_bf16_f32 v244, v120, v121
    v_exp_f32 v122, v122
    s_waitcnt lgkmcnt(0)
    v_mfma_f32_16x16x32_bf16 a[0:3], a[192:195], v[224:227], a[0:3]
    v_exp_f32 v123, v123
    v_cmp_gt_u32 vcc, v36, v38
    v_mfma_f32_16x16x32_bf16 a[16:19], a[196:199], v[224:227], a[16:19]
    s_cbranch_vccnz L_waitC30
L_retC30:
    v_cvt_pk_bf16_f32 v245, v122, v123
    v_mfma_f32_16x16x32_bf16 a[4:7], a[192:195], v[232:235], a[4:7]
    v_exp_f32 v136, v136
    v_mfma_f32_16x16x32_bf16 a[20:23], a[196:199], v[232:235], a[20:23]
    v_exp_f32 v137, v137
    v_smfmac_f32_16x16x64_bf16 a[128:131], a[144:147], v[224:231], v43
    v_cvt_pk_bf16_f32 v246, v136, v137
    v_exp_f32 v138, v138
    v_mfma_f32_16x16x32_bf16 a[8:11], a[192:195], v[240:243], a[8:11]
    v_exp_f32 v139, v139
    v_mfma_f32_16x16x32_bf16 a[24:27], a[196:199], v[240:243], a[24:27]
    v_cvt_pk_bf16_f32 v247, v138, v139
    v_exp_f32 v124, v124
    v_smfmac_f32_16x16x64_bf16 a[132:135], a[144:147], v[232:239], v43
    v_exp_f32 v125, v125
    v_mfma_f32_16x16x32_bf16 a[12:15], a[192:195], v[248:251], a[12:15]
    v_cvt_pk_bf16_f32 v252, v124, v125
    v_mfma_f32_16x16x32_bf16 a[28:31], a[196:199], v[248:251], a[28:31]
    v_exp_f32 v126, v126
    s_branch L_tail
L_waitC26:
    ds_read_b32 v38, v39
    s_waitcnt lgkmcnt(0)
    v_cmp_gt_u32 vcc, v36, v38
    s_add_u32 s49, s49, 1
    s_cmp_ge_u32 s49, 0x80000
    s_cbranch_scc1 L_end
    s_cbranch_vccnz L_waitC26
    s_branch L_retC26
L_waitC27:
    ds_read_b32 v38, v39
    s_waitcnt lgkmcnt(0)
    v_cmp_gt_u32 vcc, v36, v38
    s_add_u32 s49, s49, 1
    s_cmp_ge_u32 s49, 0x80000
    s_cbranch_scc1 L_end
    s_cbranch_vccnz L_waitC27
    s_branch L_retC27
L_waitC28:
    ds_read_b32 v38, v39
    s_waitcnt lgkmcnt(0)
    v_cmp_gt_u32 vcc, v36, v38
    s_add_u32 s49, s49, 1
    s_cmp_ge_u32 s49, 0x80000
    s_cbranch_scc1 L_end
    s_cbranch_vccnz L_waitC28
    s_branch L_retC28
L_waitC29:
    ds_read_b32 v38, v39
    s_waitcnt lgkmcnt(0)
    v_cmp_gt_u32 vcc, v36, v38
    s_add_u32 s49, s49, 1
    s_cmp_ge_u32 s49, 0x80000
    s_cbranch_scc1 L_end
    s_cbranch_vccnz L_waitC29
    s_branch L_retC29
L_waitC30:
    ds_read_b32 v38, v39
    s_waitcnt lgkmcnt(0)
    v_cmp_gt_u32 vcc, v36, v38
    s_add_u32 s49, s49, 1
    s_cmp_ge_u32 s49, 0x80000
    s_cbranch_scc1 L_end
    s_cbranch_vccnz L_waitC30
    s_branch L_retC30
L_waitC0:
    ds_read_b32 v38, v39
    s_waitcnt lgkmcnt(0)
    v_cmp_gt_u32 vcc, v36, v38
    s_add_u32 s49, s49, 1
    s_cmp_ge_u32 s49, 0x80000
    s_cbranch_scc1 L_end
    s_cbranch_vccnz L_waitC0
    s_branch L_retC0
L_waitL0:
    ds_read_b32 v40, v37
    s_waitcnt lgkmcnt(0)
    v_add_u32 v9, 1, v40
    v_cmp_gt_i32 vcc, v36, v9
    s_add_u32 s49, s49, 1
    s_cmp_ge_u32 s49, 0x80000
    s_cbranch_scc1 L_end
    s_cbranch_vccnz L_waitL0
    s_branch L_retL0
L_waitC1:
    ds_read_b32 v38, v39
    s_waitcnt lgkmcnt(0)
    v_cmp_gt_u32 vcc, v36, v38
    s_add_u32 s49, s49, 1
    s_cmp_ge_u32 s49, 0x80000
    s_cbranch_scc1 L_end
    s_cbranch_vccnz L_waitC1
    s_branch L_retC1
L_waitL1:
    ds_read_b32 v40, v37
    s_waitcnt lgkmcnt(0)
    v_add_u32 v9, 1, v40
    v_cmp_gt_i32 vcc, v36, v9
    s_add_u32 s49, s49, 1
    s_cmp_ge_u32 s49, 0x80000
    s_cbranch_scc1 L_end
    s_cbranch_vccnz L_waitL1
    s_branch L_retL1
L_eventC:
    buffer_load_dword v41, v42, s[20:23], s48 offen
    s_mov_b32 s43, 13
    s_add_u32 s48, s48, 0x40000
    s_branch L_evretC
L_proL:
    v_mfma_f32_16x16x32_bf16 v[112:115], a[160:163], a[224:227], v[112:115]
    ds_read_b128 a[240:243], v37 offset:0
    ds_read_b128 a[244:247], v37 offset:2048
    v_mfma_f32_16x16x32_bf16 v[128:131], a[164:167], a[224:227], v[128:131]
    s_add_u32 m0, s64, 81920
    s_add_u32 s66, s64, 16384
    buffer_load_dwordx4 v34, s[32:35], s66 offen offset:2048 nt lds
    buffer_load_dwordx4 v35, s[32:35], s66 offen offset:3072 nt lds
    ds_read_b128 a[248:251], v37 offset:4096
    ds_read_b64_tr_b16 a[192:193], v38 offset:8192
    v_mfma_f32_16x16x32_bf16 v[144:147], a[168:171], a[224:227], v[144:147]
    ds_read_b64_tr_b16 a[194:195], v38 offset:9216
    ds_read_b64_tr_b16 a[196:197], v38 offset:8200
    v_mfma_f32_16x16x32_bf16 v[160:163], a[172:175], a[224:227], v[160:163]
    ds_read_b64_tr_b16 a[198:199], v38 offset:9224
    ds_read_b64_tr_b16 a[200:201], v39 offset:8192
    v_mfma_f32_16x16x32_bf16 v[176:179], a[176:179], a[224:227], v[176:179]
    ds_read_b64_tr_b16 a[202:203], v39 offset:9216
    ds_read_b64_tr_b16 a[204:205], v39 offset:8200
    v_mfma_f32_16x16x32_bf16 v[192:195], a[180:183], a[224:227], v[192:195]
    ds_read_b64_tr_b16 a[206:207], v39 offset:9224
    ds_read_b64_tr_b16 a[208:209], v40 offset:8192
    v_mfma_f32_16x16x32_bf16 v[208:211], a[184:187], a[224:227], v[208:211]
    ds_read_b64_tr_b16 a[210:211], v40 offset:9216
    ds_read_b64_tr_b16 a[212:213], v40 offset:8200
    v_mfma_f32_16x16x32_bf16 v[224:227], a[188:191], a[224:227], v[224:227]
    ds_read_b64_tr_b16 a[214:215], v40 offset:9224
    ds_read_b64_tr_b16 a[216:217], v41 offset:8192
    v_mfma_f32_16x16x32_bf16 v[116:119], a[160:163], a[228:231], v[116:119]
    ds_read_b64_tr_b16 a[218:219], v41 offset:9216
    ds_read_b64_tr_b16 a[220:221], v41 offset:8200
    v_mfma_f32_16x16x32_bf16 v[132:135], a[164:167], a[228:231], v[132:135]
    ds_read_b64_tr_b16 a[222:223], v41 offset:9224
    v_mfma_f32_16x16x32_bf16 v[148:151], a[168:171], a[228:231], v[148:151]
    v_mov_b32 v46, v254
    v_mfma_f32_16x16x32_bf16 v[164:167], a[172:175], a[228:231], v[164:167]
    v_mfma_f32_16x16x32_bf16 v[180:183], a[176:179], a[228:231], v[180:183]
    v_mfma_f32_16x16x32_bf16 v[196:199], a[180:183], a[228:231], v[196:199]
    v_mfma_f32_16x16x32_bf16 v[212:215], a[184:187], a[228:231], v[212:215]
    v_mfma_f32_16x16x32_bf16 v[228:231], a[188:191], a[228:231], v[228:231]
    s_waitcnt lgkmcnt(0)
    v_mfma_f32_16x16x32_bf16 v[112:115], a[192:195], a[240:243], v[112:115]
    v_mfma_f32_16x16x32_bf16 v[128:131], a[196:199], a[240:243], v[128:131]
    v_xor_b32 v47, 0x80, v254
    v_mfma_f32_16x16x32_bf16 v[144:147], a[200:203], a[240:243], v[144:147]
    v_mfma_f32_16x16x32_bf16 v[160:163], a[204:207], a[240:243], v[160:163]
    v_mfma_f32_16x16x32_bf16 v[176:179], a[208:211], a[240:243], v[176:179]
    v_mfma_f32_16x16x32_bf16 v[192:195], a[212:215], a[240:243], v[192:195]
    s_add_u32 m0, s64, 49152
    s_add_u32 s65, s64, 32768
    buffer_load_dwordx4 v28, s[28:31], s65 offen offset:0 nt lds
    buffer_load_dwordx4 v29, s[28:31], s65 offen offset:1024 nt lds
    v_mfma_f32_16x16x32_bf16 v[208:211], a[216:219], a[240:243], v[208:211]
    v_mfma_f32_16x16x32_bf16 v[224:227], a[220:223], a[240:243], v[224:227]
    v_mfma_f32_16x16x32_bf16 v[120:123], a[160:163], a[232:235], v[120:123]
    ds_read_b128 a[160:163], v16 offset:0
    v_mov_b32 v9, 0
    v_mul_f32 v112, s75, v112
    v_mfma_f32_16x16x32_bf16 v[136:139], a[164:167], a[232:235], v[136:139]
    ds_read_b128 a[164:167], v17 offset:0
    v_mul_f32 v113, s75, v113
    v_mfma_f32_16x16x32_bf16 v[152:155], a[168:171], a[232:235], v[152:155]
    ds_read_b128 a[168:171], v18 offset:0
    v_mul_f32 v114, s75, v114
    v_mfma_f32_16x16x32_bf16 v[168:171], a[172:175], a[232:235], v[168:171]
    buffer_load_dwordx2 v[44:45], v9, s[88:91], 0 offen sc1
    ds_read_b128 a[172:175], v19 offset:0
    v_mul_f32 v115, s75, v115
    v_mfma_f32_16x16x32_bf16 v[184:187], a[176:179], a[232:235], v[184:187]
    ds_read_b128 a[176:179], v16 offset:4096
    v_mul_f32 v128, s75, v128
    v_mfma_f32_16x16x32_bf16 v[200:203], a[180:183], a[232:235], v[200:203]
    ds_read_b128 a[180:183], v17 offset:4096
    v_mul_f32 v129, s75, v129
    v_add_u32 v96, 0, v28
    v_mfma_f32_16x16x32_bf16 v[216:219], a[184:187], a[232:235], v[216:219]
    ds_read_b128 a[184:187], v18 offset:4096
    v_mul_f32 v130, s75, v130
    v_mfma_f32_16x16x32_bf16 v[232:235], a[188:191], a[232:235], v[232:235]
    ds_read_b128 a[188:191], v19 offset:4096
    v_mul_f32 v131, s75, v131
    v_mfma_f32_16x16x32_bf16 v[116:119], a[192:195], a[244:247], v[116:119]
    v_mul_f32 v144, s75, v144
    v_add_u32 v104, 0, v32
    v_mul_f32 v145, s75, v145
    v_mfma_f32_16x16x32_bf16 v[132:135], a[196:199], a[244:247], v[132:135]
    v_mul_f32 v146, s75, v146
    v_mul_f32 v147, s75, v147
    v_mfma_f32_16x16x32_bf16 v[148:151], a[200:203], a[244:247], v[148:151]
    v_mul_f32 v160, s75, v160
    v_mul_f32 v161, s75, v161
    v_mfma_f32_16x16x32_bf16 v[164:167], a[204:207], a[244:247], v[164:167]
    v_add_u32 v97, 0, v29
    v_mul_f32 v162, s75, v162
    v_mul_f32 v163, s75, v163
    v_mfma_f32_16x16x32_bf16 v[180:183], a[208:211], a[244:247], v[180:183]
    v_mul_f32 v176, s75, v176
    v_mul_f32 v177, s75, v177
    v_mfma_f32_16x16x32_bf16 v[196:199], a[212:215], a[244:247], v[196:199]
    v_mul_f32 v178, s75, v178
    v_mul_f32 v179, s75, v179
    v_add_u32 v105, 0, v33
    v_mfma_f32_16x16x32_bf16 v[212:215], a[216:219], a[244:247], v[212:215]
    v_mul_f32 v192, s75, v192
    v_mul_f32 v193, s75, v193
    v_mfma_f32_16x16x32_bf16 v[228:231], a[220:223], a[244:247], v[228:231]
    v_mul_f32 v194, s75, v194
    v_mul_f32 v195, s75, v195
    v_mul_f32 v208, s75, v208
    v_mul_f32 v209, s75, v209
    v_add_u32 v98, 0, v30
    v_mul_f32 v210, s75, v210
    s_add_u32 m0, s64, 49152
    s_add_u32 s65, s64, 32768
    buffer_load_dwordx4 v30, s[28:31], s65 offen offset:2048 nt lds
    buffer_load_dwordx4 v31, s[28:31], s65 offen offset:3072 nt lds
    v_mfma_f32_16x16x32_bf16 v[120:123], a[192:195], a[248:251], v[120:123]
    v_mul_f32 v211, s75, v211
    s_waitcnt lgkmcnt(0)
    v_mul_f32 v224, s75, v224
    v_mul_f32 v225, s75, v225
    v_mul_f32 v226, s75, v226
    v_mfma_f32_16x16x32_bf16 v[136:139], a[196:199], a[248:251], v[136:139]
    v_add_u32 v106, 0, v32
    v_mul_f32 v227, s75, v227
    v_cvt_pk_bf16_f32 v48, v112, v113
    v_cvt_pk_bf16_f32 v49, v114, v115
    v_cvt_pk_bf16_f32 v50, v128, v129
    v_cvt_pk_bf16_f32 v51, v130, v131
    v_mfma_f32_16x16x32_bf16 v[152:155], a[200:203], a[248:251], v[152:155]
    v_cvt_pk_bf16_f32 v52, v144, v145
    v_cvt_pk_bf16_f32 v53, v146, v147
    v_add_u32 v99, 0, v31
    v_cvt_pk_bf16_f32 v54, v160, v161
    v_cvt_pk_bf16_f32 v55, v162, v163
    v_cvt_pk_bf16_f32 v56, v176, v177
    v_mfma_f32_16x16x32_bf16 v[168:171], a[204:207], a[248:251], v[168:171]
    v_cvt_pk_bf16_f32 v57, v178, v179
    v_cvt_pk_bf16_f32 v58, v192, v193
    v_cvt_pk_bf16_f32 v59, v194, v195
    v_cvt_pk_bf16_f32 v60, v208, v209
    v_add_u32 v107, 0, v33
    v_cvt_pk_bf16_f32 v61, v210, v211
    v_mfma_f32_16x16x32_bf16 v[184:187], a[208:211], a[248:251], v[184:187]
    v_cvt_pk_bf16_f32 v62, v224, v225
    v_cvt_pk_bf16_f32 v63, v226, v227
    v_mul_f32 v116, s75, v116
    v_mul_f32 v117, s75, v117
    v_mul_f32 v118, s75, v118
    v_mfma_f32_16x16x32_bf16 v[200:203], a[212:215], a[248:251], v[200:203]
    v_add_u32 v100, 4096, v28
    v_mul_f32 v119, s75, v119
    v_mul_f32 v132, s75, v132
    v_mul_f32 v133, s75, v133
    v_mul_f32 v134, s75, v134
    v_mul_f32 v135, s75, v135
    v_mfma_f32_16x16x32_bf16 v[216:219], a[216:219], a[248:251], v[216:219]
    v_mul_f32 v148, s75, v148
    v_mul_f32 v149, s75, v149
    v_add_u32 v108, 4096, v32
    v_mul_f32 v150, s75, v150
    v_mul_f32 v151, s75, v151
    v_mul_f32 v164, s75, v164
    v_mfma_f32_16x16x32_bf16 v[232:235], a[220:223], a[248:251], v[232:235]
    v_mul_f32 v165, s75, v165
    v_mul_f32 v166, s75, v166
    v_mul_f32 v167, s75, v167
    v_mul_f32 v180, s75, v180
    v_add_u32 v101, 4096, v29
    v_mul_f32 v181, s75, v181
    v_mfma_f32_16x16x32_bf16 v[112:115], a[160:163], v[48:51], 0
    v_mul_f32 v182, s75, v182
    v_mul_f32 v183, s75, v183
    v_mul_f32 v196, s75, v196
    v_mul_f32 v197, s75, v197
    v_mul_f32 v198, s75, v198
    v_mfma_f32_16x16x32_bf16 v[112:115], a[164:167], v[52:55], v[112:115]
    v_add_u32 v109, 4096, v33
    v_mul_f32 v199, s75, v199
    v_mul_f32 v212, s75, v212
    v_mul_f32 v213, s75, v213
    v_mul_f32 v214, s75, v214
    v_mul_f32 v215, s75, v215
    v_mfma_f32_16x16x32_bf16 v[112:115], a[168:171], v[56:59], v[112:115]
    v_mul_f32 v228, s75, v228
    v_mul_f32 v229, s75, v229
    v_add_u32 v102, 4096, v30
    v_mul_f32 v230, s75, v230
    v_mul_f32 v231, s75, v231
    v_cvt_pk_bf16_f32 v64, v116, v117
    v_mfma_f32_16x16x32_bf16 v[112:115], a[172:175], v[60:63], v[112:115]
    v_cvt_pk_bf16_f32 v65, v118, v119
    v_cvt_pk_bf16_f32 v66, v132, v133
    v_cvt_pk_bf16_f32 v67, v134, v135
    v_cvt_pk_bf16_f32 v68, v148, v149
    v_add_u32 v110, 4096, v32
    v_cvt_pk_bf16_f32 v69, v150, v151
    v_mfma_f32_16x16x32_bf16 v[128:131], a[176:179], v[48:51], 0
    v_cvt_pk_bf16_f32 v70, v164, v165
    v_cvt_pk_bf16_f32 v71, v166, v167
    v_max3_f32 v10, v112, v113, v114
    v_cvt_pk_bf16_f32 v72, v180, v181
    v_cvt_pk_bf16_f32 v73, v182, v183
    v_mfma_f32_16x16x32_bf16 v[128:131], a[180:183], v[52:55], v[128:131]
    v_add_u32 v103, 4096, v31
    v_cvt_pk_bf16_f32 v74, v196, v197
    v_cvt_pk_bf16_f32 v75, v198, v199
    v_cvt_pk_bf16_f32 v76, v212, v213
    v_cvt_pk_bf16_f32 v77, v214, v215
    v_cvt_pk_bf16_f32 v78, v228, v229
    v_mfma_f32_16x16x32_bf16 v[128:131], a[184:187], v[56:59], v[128:131]
    v_cvt_pk_bf16_f32 v79, v230, v231
    v_mul_f32 v120, s75, v120
    v_add_u32 v111, 4096, v33
    v_mul_f32 v121, s75, v121
    v_mul_f32 v122, s75, v122
    v_mul_f32 v123, s75, v123
    v_mfma_f32_16x16x32_bf16 v[128:131], a[188:191], v[60:63], v[128:131]
    v_mul_f32 v136, s75, v136
    v_mul_f32 v137, s75, v137
    v_mul_f32 v138, s75, v138
    v_mul_f32 v139, s75, v139
    v_min_u32 v13, 2, v6
    v_mul_f32 v152, s75, v152
    v_mfma_f32_16x16x32_bf16 v[116:119], a[160:163], v[64:67], 0
    v_mul_f32 v153, s75, v153
    v_mul_f32 v154, s75, v154
    v_max3_f32 v224, v115, v128, v129
    v_max3_f32 v10, v10, v130, v131
    v_max_f32 v10, v10, v224
    v_mfma_f32_16x16x32_bf16 v[116:119], a[164:167], v[68:71], v[116:119]
    v_lshlrev_b32 v13, 8, v13
    v_mov_b32 v224, v10
    v_mul_f32 v155, s75, v155
    v_mul_f32 v168, s75, v168
    v_permlane16_swap_b32 v10, v224
    v_max_f32 v10, v10, v224
    v_mfma_f32_16x16x32_bf16 v[116:119], a[168:171], v[72:75], v[116:119]
    v_mov_b32 v224, v10
    v_mul_f32 v169, s75, v169
    v_add_u32 v37, 155648, v13
    v_mul_f32 v170, s75, v170
    v_permlane32_swap_b32 v10, v224
    v_max_f32 v10, v10, v224
    v_mfma_f32_16x16x32_bf16 v[116:119], a[172:175], v[76:79], v[116:119]
    v_sub_f32 v112, v112, v10
    v_sub_f32 v113, v113, v10
    v_sub_f32 v114, v114, v10
    v_sub_f32 v115, v115, v10
    v_lshlrev_b32 v13, 2, v2
    v_sub_f32 v128, v128, v10
    v_mfma_f32_16x16x32_bf16 v[132:135], a[176:179], v[64:67], 0
    v_sub_f32 v129, v129, v10
    v_sub_f32 v130, v130, v10
    v_sub_f32 v131, v131, v10
    v_sub_f32 v176, 0, v10
    v_sub_f32 v177, 0, v10
    v_mfma_f32_16x16x32_bf16 v[132:135], a[180:183], v[68:71], v[132:135]
    v_add_u32 v39, 156416, v13
    v_sub_f32 v178, 0, v10
    v_sub_f32 v179, 0, v10
    v_exp_f32 v112, v112
    v_exp_f32 v113, v113
    v_mfma_f32_16x16x32_bf16 v[132:135], a[184:187], v[72:75], v[132:135]
    v_exp_f32 v114, v114
    v_exp_f32 v115, v115
    v_exp_f32 v128, v128
    v_add_u32 v13, 155648, v13
    v_mfma_f32_16x16x32_bf16 v[132:135], a[188:191], v[76:79], v[132:135]
    v_exp_f32 v129, v129
    v_exp_f32 v130, v130
    v_exp_f32 v131, v131
    v_max3_f32 v11, v116, v117, v118
    v_mul_f32 v171, s75, v171
    v_mul_f32 v184, s75, v184
    v_mul_f32 v185, s75, v185
    v_mov_b32 v36, -1
    v_mul_f32 v186, s75, v186
    v_max3_f32 v228, v119, v132, v133
    v_max3_f32 v11, v11, v134, v135
    v_max_f32 v11, v11, v228
    v_mov_b32 v228, v11
    v_mul_f32 v187, s75, v187
    v_mul_f32 v200, s75, v200
    v_permlane16_swap_b32 v11, v228
    v_mov_b32 v40, -1
    v_max_f32 v11, v11, v228
    v_mov_b32 v228, v11
    v_mul_f32 v201, s75, v201
    v_mul_f32 v202, s75, v202
    v_permlane32_swap_b32 v11, v228
    v_max_f32 v11, v11, v228
    v_sub_f32 v116, v116, v11
    v_sub_f32 v117, v117, v11
    ds_write_b32 v13, v36 offset:0
    v_sub_f32 v118, v118, v11
    v_sub_f32 v119, v119, v11
    v_sub_f32 v132, v132, v11
    v_sub_f32 v133, v133, v11
    v_sub_f32 v134, v134, v11
    v_sub_f32 v135, v135, v11
    v_sub_f32 v180, 0, v11
    v_sub_f32 v181, 0, v11
    ds_write_b32 v13, v36 offset:256
    v_sub_f32 v182, 0, v11
    v_sub_f32 v183, 0, v11
    v_exp_f32 v116, v116
    v_exp_f32 v117, v117
    v_exp_f32 v118, v118
    v_exp_f32 v119, v119
    v_exp_f32 v132, v132
    v_exp_f32 v133, v133
    ds_write_b32 v13, v36 offset:512
    v_exp_f32 v134, v134
    v_exp_f32 v135, v135
    v_mul_f32 v203, s75, v203
    v_mul_f32 v216, s75, v216
    v_mul_f32 v217, s75, v217
    v_mul_f32 v218, s75, v218
    v_mul_f32 v219, s75, v219
    v_mul_f32 v232, s75, v232
    v_mov_b32 v38, 0
    v_mul_f32 v233, s75, v233
    v_mul_f32 v234, s75, v234
    v_mul_f32 v235, s75, v235
    v_cvt_pk_bf16_f32 v80, v120, v121
    v_cvt_pk_bf16_f32 v81, v122, v123
    v_cvt_pk_bf16_f32 v82, v136, v137
    v_cvt_pk_bf16_f32 v83, v138, v139
    v_cvt_pk_bf16_f32 v84, v152, v153
    ds_write_b32 v13, v38 offset:1024
    v_cvt_pk_bf16_f32 v85, v154, v155
    v_mfma_f32_16x16x32_bf16 v[120:123], a[160:163], v[80:83], 0
    v_cvt_pk_bf16_f32 v86, v168, v169
    v_cvt_pk_bf16_f32 v87, v170, v171
    v_cvt_pk_bf16_f32 v88, v184, v185
    v_cvt_pk_bf16_f32 v89, v186, v187
    v_cvt_pk_bf16_f32 v90, v200, v201
    v_mfma_f32_16x16x32_bf16 v[120:123], a[164:167], v[84:87], v[120:123]
    v_mov_b32 v38, 3
    v_cvt_pk_bf16_f32 v91, v202, v203
    v_cvt_pk_bf16_f32 v92, v216, v217
    v_cvt_pk_bf16_f32 v93, v218, v219
    v_cvt_pk_bf16_f32 v94, v232, v233
    v_cvt_pk_bf16_f32 v95, v234, v235
    v_mfma_f32_16x16x32_bf16 v[120:123], a[168:171], v[88:91], v[120:123]
    ds_read_b128 a[160:163], v16 offset:8192
    ds_read_b128 a[164:167], v17 offset:8192
    ds_write_b32 v39, v38
    ds_read_b128 a[168:171], v18 offset:8192
    v_cvt_pk_bf16_f32 v144, v112, v113
    v_cvt_pk_bf16_f32 v145, v114, v115
    v_mfma_f32_16x16x32_bf16 v[120:123], a[172:175], v[92:95], v[120:123]
    ds_read_b128 a[172:175], v19 offset:8192
    v_cvt_pk_bf16_f32 v146, v128, v129
    v_cvt_pk_bf16_f32 v147, v130, v131
    v_cvt_pk_bf16_f32 v152, v116, v117
    v_mov_b32 v38, 3
    v_cvt_pk_bf16_f32 v153, v118, v119
    v_mfma_f32_16x16x32_bf16 v[136:139], a[176:179], v[80:83], 0
    ds_read_b128 a[176:179], v16 offset:12288
    v_cvt_pk_bf16_f32 v154, v132, v133
    v_max3_f32 v12, v120, v121, v122
    v_cvt_pk_bf16_f32 v155, v134, v135
    v_mfma_f32_16x16x32_bf16 v[136:139], a[180:183], v[84:87], v[136:139]
    ds_read_b128 a[180:183], v17 offset:12288
    v_mfma_f32_16x16x32_bf16 v[136:139], a[184:187], v[88:91], v[136:139]
    ds_read_b128 a[184:187], v18 offset:12288
    v_mfma_f32_16x16x32_bf16 v[136:139], a[188:191], v[92:95], v[136:139]
    ds_read_b128 a[188:191], v19 offset:12288
    s_nop 0
    s_nop 0
    s_nop 0
    s_nop 0
    s_nop 0
    s_nop 0
    s_nop 0
    v_max3_f32 v232, v123, v136, v137
    v_max3_f32 v12, v12, v138, v139
    v_max_f32 v12, v12, v232
    v_mov_b32 v232, v12
    s_nop 0
    s_nop 0
    v_permlane16_swap_b32 v12, v232
    v_max_f32 v12, v12, v232
    v_mov_b32 v232, v12
    s_nop 0
    s_nop 0
    v_permlane32_swap_b32 v12, v232
    v_max_f32 v12, v12, v232
    v_sub_f32 v120, v120, v12
    v_sub_f32 v121, v121, v12
    v_sub_f32 v122, v122, v12
    v_sub_f32 v123, v123, v12
    v_sub_f32 v136, v136, v12
    v_sub_f32 v137, v137, v12
    v_sub_f32 v138, v138, v12
    v_sub_f32 v139, v139, v12
    v_sub_f32 v184, 0, v12
    v_sub_f32 v185, 0, v12
    v_sub_f32 v186, 0, v12
    v_sub_f32 v187, 0, v12
    v_exp_f32 v120, v120
    v_exp_f32 v121, v121
    v_exp_f32 v122, v122
    v_exp_f32 v123, v123
    v_exp_f32 v136, v136
    v_exp_f32 v137, v137
    v_exp_f32 v138, v138
    v_exp_f32 v139, v139
    v_cvt_pk_bf16_f32 v160, v120, v121
    v_cvt_pk_bf16_f32 v161, v122, v123
    v_cvt_pk_bf16_f32 v162, v136, v137
    v_cvt_pk_bf16_f32 v163, v138, v139
L_loader:
    s_mov_b64 s[50:51], 0
    s_mov_b32 s56, 0x10000
    s_mov_b32 s57, 0xc000
    s_mov_b32 s58, 0
    s_mov_b32 s59, 98304

    s_waitcnt vmcnt(0) lgkmcnt(0)
    s_barrier
    v_add_u32 v168, 0, v46
    v_add_u32 v169, 3072, v47
    v_add_u32 v170, 6144, v46
    v_add_u32 v171, 9216, v47
    v_add_u32 v172, 16384, v46
    v_add_u32 v173, 19456, v47
    v_add_u32 v174, 22528, v46
    v_add_u32 v175, 25600, v47
.p2align 6
L_loopL:
    s_waitcnt vmcnt(32) lgkmcnt(0)
    v_mfma_f32_16x16x32_bf16 v[112:115], a[160:163], v[48:51], v[176:179]
    ds_write_b32 v39, v38
    v_add_u32 v38, 1, v38
    v_cmp_gt_i32 vcc, v36, v40
    v_add_u32 v36, 1, v36
    v_mfma_f32_16x16x32_bf16 v[112:115], a[164:167], v[52:55], v[112:115]
    s_cbranch_vccnz L_waitL0
L_retL0:
    v_mfma_f32_16x16x32_bf16 v[112:115], a[168:171], v[56:59], v[112:115]
    ds_read_b64_tr_b16 a[192:193], v20 offset:0
    ds_read_b64_tr_b16 a[194:195], v20 offset:4096
    s_add_u32 m0, s58, 0
    v_mfma_f32_16x16x32_bf16 v[112:115], a[172:175], v[60:63], v[112:115]
    ds_read_b64_tr_b16 a[196:197], v21 offset:0
    ds_read_b64_tr_b16 a[198:199], v21 offset:4096
    v_mfma_f32_16x16x32_bf16 v[128:131], a[176:179], v[48:51], v[176:179]
    ds_read_b64_tr_b16 a[200:201], v22 offset:0
    ds_read_b64_tr_b16 a[202:203], v22 offset:4096
    buffer_load_dwordx4 v96, s[28:31], s56 offen offset:0 nt lds
    v_mfma_f32_16x16x32_bf16 v[128:131], a[180:183], v[52:55], v[128:131]
    ds_read_b64_tr_b16 a[204:205], v23 offset:0
    ds_read_b64_tr_b16 a[206:207], v23 offset:4096
    v_mfma_f32_16x16x32_bf16 v[128:131], a[184:187], v[56:59], v[128:131]
    ds_read_b64_tr_b16 a[208:209], v24 offset:0
    ds_read_b64_tr_b16 a[210:211], v24 offset:4096
    buffer_load_dwordx4 v97, s[28:31], s56 offen offset:1024 nt lds
    v_mfma_f32_16x16x32_bf16 v[128:131], a[188:191], v[60:63], v[128:131]
    ds_read_b64_tr_b16 a[212:213], v25 offset:0
    ds_read_b64_tr_b16 a[214:215], v25 offset:4096
    v_mfma_f32_16x16x32_bf16 v[116:119], a[160:163], v[64:67], v[180:183]
    ds_read_b64_tr_b16 a[216:217], v26 offset:0
    ds_read_b64_tr_b16 a[218:219], v26 offset:4096
    buffer_load_dwordx4 v98, s[28:31], s56 offen offset:2048 nt lds
    v_mfma_f32_16x16x32_bf16 v[116:119], a[164:167], v[68:71], v[116:119]
    ds_read_b64_tr_b16 a[220:221], v27 offset:0
    ds_read_b64_tr_b16 a[222:223], v27 offset:4096
    v_mfma_f32_16x16x32_bf16 v[116:119], a[168:171], v[72:75], v[116:119]
    buffer_load_dwordx4 v99, s[28:31], s56 offen offset:3072 nt lds
    v_mfma_f32_16x16x32_bf16 v[116:119], a[172:175], v[76:79], v[116:119]
    v_exp_f32 v112, v112
    v_mfma_f32_16x16x32_bf16 v[132:135], a[176:179], v[64:67], v[180:183]
    s_add_u32 m0, s58, 4096
    v_exp_f32 v113, v113
    v_mfma_f32_16x16x32_bf16 v[132:135], a[180:183], v[68:71], v[132:135]
    v_cvt_pk_bf16_f32 v148, v112, v113
    v_xor_b32 v16, s60, v16
    v_xor_b32 v17, s60, v17
    v_mfma_f32_16x16x32_bf16 v[132:135], a[184:187], v[72:75], v[132:135]
    buffer_load_dwordx4 v100, s[28:31], s56 offen offset:0 nt lds
    v_exp_f32 v114, v114
    v_mfma_f32_16x16x32_bf16 v[132:135], a[188:191], v[76:79], v[132:135]
    v_exp_f32 v115, v115
    v_xor_b32 v18, s60, v18
    v_mfma_f32_16x16x32_bf16 v[120:123], a[160:163], v[80:83], v[184:187]
    buffer_load_dwordx4 v101, s[28:31], s56 offen offset:1024 nt lds
    v_cvt_pk_bf16_f32 v149, v114, v115
    v_xor_b32 v19, s60, v19
    v_mfma_f32_16x16x32_bf16 v[120:123], a[164:167], v[84:87], v[120:123]
    v_exp_f32 v128, v128
    v_mfma_f32_16x16x32_bf16 v[120:123], a[168:171], v[88:91], v[120:123]
    buffer_load_dwordx4 v102, s[28:31], s56 offen offset:2048 nt lds
    v_mfma_f32_16x16x32_bf16 v[120:123], a[172:175], v[92:95], v[120:123]
    v_exp_f32 v129, v129
    v_mfma_f32_16x16x32_bf16 v[136:139], a[176:179], v[80:83], v[184:187]
    buffer_load_dwordx4 v103, s[28:31], s56 offen offset:3072 nt lds
    v_cvt_pk_bf16_f32 v150, v128, v129
    v_exp_f32 v130, v130
    v_mfma_f32_16x16x32_bf16 v[136:139], a[180:183], v[84:87], v[136:139]
    v_mfma_f32_16x16x32_bf16 v[136:139], a[184:187], v[88:91], v[136:139]
    s_add_u32 s56, s56, 0x2000
    v_exp_f32 v131, v131
    v_mfma_f32_16x16x32_bf16 v[136:139], a[188:191], v[92:95], v[136:139]
    v_cvt_pk_bf16_f32 v151, v130, v131
    v_exp_f32 v116, v116
    s_waitcnt lgkmcnt(0)
    v_mfma_f32_16x16x32_bf16 a[0:3], a[192:195], v[144:147], a[0:3]
    v_mfma_f32_16x16x32_bf16 a[16:19], a[196:199], v[144:147], a[16:19]
    ds_read_b128 a[160:163], v16 offset:0
    s_add_u32 m0, s59, 0
    v_exp_f32 v117, v117
    v_mfma_f32_16x16x32_bf16 a[32:35], a[200:203], v[144:147], a[32:35]
    ds_read_b128 a[164:167], v17 offset:0
    v_cvt_pk_bf16_f32 v156, v116, v117
    v_mfma_f32_16x16x32_bf16 a[48:51], a[204:207], v[144:147], a[48:51]
    ds_read_b128 a[168:171], v18 offset:0
    buffer_load_dwordx4 v104, s[32:35], s57 offen offset:0 nt lds
    v_exp_f32 v118, v118
    v_mfma_f32_16x16x32_bf16 a[64:67], a[208:211], v[144:147], a[64:67]
    ds_read_b128 a[172:175], v19 offset:0
    v_exp_f32 v119, v119
    v_mfma_f32_16x16x32_bf16 a[80:83], a[212:215], v[144:147], a[80:83]
    ds_read_b128 a[176:179], v16 offset:4096
    buffer_load_dwordx4 v105, s[32:35], s57 offen offset:1024 nt lds
    v_cvt_pk_bf16_f32 v157, v118, v119
    v_mfma_f32_16x16x32_bf16 a[96:99], a[216:219], v[144:147], a[96:99]
    ds_read_b128 a[180:183], v17 offset:4096
    v_exp_f32 v132, v132
    v_mfma_f32_16x16x32_bf16 a[112:115], a[220:223], v[144:147], a[112:115]
    ds_read_b128 a[184:187], v18 offset:4096
    buffer_load_dwordx4 v106, s[32:35], s57 offen offset:2048 nt lds
    v_exp_f32 v133, v133
    v_mfma_f32_16x16x32_bf16 a[4:7], a[192:195], v[152:155], a[4:7]
    ds_read_b128 a[188:191], v19 offset:4096
    v_cvt_pk_bf16_f32 v158, v132, v133
    v_mfma_f32_16x16x32_bf16 a[20:23], a[196:199], v[152:155], a[20:23]
    ds_read_b32 v40, v37
    buffer_load_dwordx4 v107, s[32:35], s57 offen offset:3072 nt lds
    v_exp_f32 v134, v134
    v_mfma_f32_16x16x32_bf16 a[36:39], a[200:203], v[152:155], a[36:39]
    v_mfma_f32_16x16x32_bf16 a[52:55], a[204:207], v[152:155], a[52:55]
    s_add_u32 m0, s59, 4096
    v_exp_f32 v135, v135
    v_mfma_f32_16x16x32_bf16 a[68:71], a[208:211], v[152:155], a[68:71]
    v_cvt_pk_bf16_f32 v159, v134, v135
    v_exp_f32 v120, v120
    v_mfma_f32_16x16x32_bf16 a[84:87], a[212:215], v[152:155], a[84:87]
    buffer_load_dwordx4 v108, s[32:35], s57 offen offset:0 nt lds
    v_mfma_f32_16x16x32_bf16 a[100:103], a[216:219], v[152:155], a[100:103]
    v_exp_f32 v121, v121
    v_mfma_f32_16x16x32_bf16 a[116:119], a[220:223], v[152:155], a[116:119]
    buffer_load_dwordx4 v109, s[32:35], s57 offen offset:1024 nt lds
    v_cvt_pk_bf16_f32 v164, v120, v121
    v_exp_f32 v122, v122
    v_smfmac_f32_16x16x64_bf16 a[128:131], a[144:147], v[144:151], v43
    v_mfma_f32_16x16x32_bf16 a[8:11], a[192:195], v[160:163], a[8:11]
    buffer_load_dwordx4 v110, s[32:35], s57 offen offset:2048 nt lds
    v_exp_f32 v123, v123
    v_mfma_f32_16x16x32_bf16 a[24:27], a[196:199], v[160:163], a[24:27]
    v_cvt_pk_bf16_f32 v165, v122, v123
    v_mfma_f32_16x16x32_bf16 a[40:43], a[200:203], v[160:163], a[40:43]
    buffer_load_dwordx4 v111, s[32:35], s57 offen offset:3072 nt lds
    v_exp_f32 v136, v136
    v_mfma_f32_16x16x32_bf16 a[56:59], a[204:207], v[160:163], a[56:59]
    v_exp_f32 v137, v137
    v_mfma_f32_16x16x32_bf16 a[72:75], a[208:211], v[160:163], a[72:75]
    s_add_u32 s57, s57, 0x2000
    v_cvt_pk_bf16_f32 v166, v136, v137
    v_mfma_f32_16x16x32_bf16 a[88:91], a[212:215], v[160:163], a[88:91]
    v_exp_f32 v138, v138
    v_mfma_f32_16x16x32_bf16 a[104:107], a[216:219], v[160:163], a[104:107]
    v_mfma_f32_16x16x32_bf16 a[120:123], a[220:223], v[160:163], a[120:123]
    v_exp_f32 v139, v139
    v_smfmac_f32_16x16x64_bf16 a[132:135], a[144:147], v[152:159], v43
    v_cvt_pk_bf16_f32 v167, v138, v139
    s_waitcnt vmcnt(32) lgkmcnt(0)
    v_mfma_f32_16x16x32_bf16 v[112:115], a[160:163], v[48:51], v[176:179]
    ds_write_b32 v39, v38
    v_add_u32 v38, 1, v38
    v_cmp_gt_i32 vcc, v36, v40
    v_add_u32 v36, 1, v36
    v_mfma_f32_16x16x32_bf16 v[112:115], a[164:167], v[52:55], v[112:115]
    s_cbranch_vccnz L_waitL1
L_retL1:
    v_mfma_f32_16x16x32_bf16 v[112:115], a[168:171], v[56:59], v[112:115]
    ds_read_b64_tr_b16 a[192:193], v20 offset:8192
    ds_read_b64_tr_b16 a[194:195], v20 offset:12288
    s_add_u32 m0, s58, 8192
    v_mfma_f32_16x16x32_bf16 v[112:115], a[172:175], v[60:63], v[112:115]
    ds_read_b64_tr_b16 a[196:197], v21 offset:8192
    ds_read_b64_tr_b16 a[198:199], v21 offset:12288
    v_mfma_f32_16x16x32_bf16 v[128:131], a[176:179], v[48:51], v[176:179]
    ds_read_b64_tr_b16 a[200:201], v22 offset:8192
    ds_read_b64_tr_b16 a[202:203], v22 offset:12288
    buffer_load_dwordx4 v96, s[28:31], s56 offen offset:0 nt lds
    v_mfma_f32_16x16x32_bf16 v[128:131], a[180:183], v[52:55], v[128:131]
    ds_read_b64_tr_b16 a[204:205], v23 offset:8192
    ds_read_b64_tr_b16 a[206:207], v23 offset:12288
    v_mfma_f32_16x16x32_bf16 v[128:131], a[184:187], v[56:59], v[128:131]
    ds_read_b64_tr_b16 a[208:209], v24 offset:8192
    ds_read_b64_tr_b16 a[210:211], v24 offset:12288
    buffer_load_dwordx4 v97, s[28:31], s56 offen offset:1024 nt lds
    v_mfma_f32_16x16x32_bf16 v[128:131], a[188:191], v[60:63], v[128:131]
    ds_read_b64_tr_b16 a[212:213], v25 offset:8192
    ds_read_b64_tr_b16 a[214:215], v25 offset:12288
    v_mfma_f32_16x16x32_bf16 v[116:119], a[160:163], v[64:67], v[180:183]
    ds_read_b64_tr_b16 a[216:217], v26 offset:8192
    ds_read_b64_tr_b16 a[218:219], v26 offset:12288
    buffer_load_dwordx4 v98, s[28:31], s56 offen offset:2048 nt lds
    v_mfma_f32_16x16x32_bf16 v[116:119], a[164:167], v[68:71], v[116:119]
    ds_read_b64_tr_b16 a[220:221], v27 offset:8192
    ds_read_b64_tr_b16 a[222:223], v27 offset:12288
    v_mfma_f32_16x16x32_bf16 v[116:119], a[168:171], v[72:75], v[116:119]
    buffer_load_dwordx4 v99, s[28:31], s56 offen offset:3072 nt lds
    v_mfma_f32_16x16x32_bf16 v[116:119], a[172:175], v[76:79], v[116:119]
    v_exp_f32 v112, v112
    v_mfma_f32_16x16x32_bf16 v[132:135], a[176:179], v[64:67], v[180:183]
    s_add_u32 m0, s58, 12288
    v_exp_f32 v113, v113
    v_mfma_f32_16x16x32_bf16 v[132:135], a[180:183], v[68:71], v[132:135]
    v_cvt_pk_bf16_f32 v144, v112, v113
    v_mfma_f32_16x16x32_bf16 v[132:135], a[184:187], v[72:75], v[132:135]
    buffer_load_dwordx4 v100, s[28:31], s56 offen offset:0 nt lds
    v_exp_f32 v114, v114
    v_mfma_f32_16x16x32_bf16 v[132:135], a[188:191], v[76:79], v[132:135]
    v_exp_f32 v115, v115
    v_mfma_f32_16x16x32_bf16 v[120:123], a[160:163], v[80:83], v[184:187]
    buffer_load_dwordx4 v101, s[28:31], s56 offen offset:1024 nt lds
    v_cvt_pk_bf16_f32 v145, v114, v115
    v_mfma_f32_16x16x32_bf16 v[120:123], a[164:167], v[84:87], v[120:123]
    v_exp_f32 v128, v128
    v_mfma_f32_16x16x32_bf16 v[120:123], a[168:171], v[88:91], v[120:123]
    buffer_load_dwordx4 v102, s[28:31], s56 offen offset:2048 nt lds
    v_exp_f32 v129, v129
    v_mfma_f32_16x16x32_bf16 v[120:123], a[172:175], v[92:95], v[120:123]
    v_cvt_pk_bf16_f32 v146, v128, v129
    v_mfma_f32_16x16x32_bf16 v[136:139], a[176:179], v[80:83], v[184:187]
    buffer_load_dwordx4 v103, s[28:31], s56 offen offset:3072 nt lds
    v_exp_f32 v130, v130
    v_mfma_f32_16x16x32_bf16 v[136:139], a[180:183], v[84:87], v[136:139]
    v_exp_f32 v131, v131
    v_mfma_f32_16x16x32_bf16 v[136:139], a[184:187], v[88:91], v[136:139]
    s_add_u32 s56, s56, 0x2000
    v_cvt_pk_bf16_f32 v147, v130, v131
    v_mfma_f32_16x16x32_bf16 v[136:139], a[188:191], v[92:95], v[136:139]
    v_exp_f32 v116, v116
    s_waitcnt lgkmcnt(0)
    v_mfma_f32_16x16x32_bf16 a[0:3], a[192:195], v[148:151], a[0:3]
    s_add_u32 m0, s59, 8192
    v_mfma_f32_16x16x32_bf16 a[16:19], a[196:199], v[148:151], a[16:19]
    ds_read_b128 a[160:163], v16 offset:8192
    v_exp_f32 v117, v117
    v_mfma_f32_16x16x32_bf16 a[32:35], a[200:203], v[148:151], a[32:35]
    buffer_load_dwordx4 v104, s[32:35], s57 offen offset:0 nt lds
    v_cvt_pk_bf16_f32 v152, v116, v117
    v_exp_f32 v118, v118
    v_mfma_f32_16x16x32_bf16 a[48:51], a[204:207], v[148:151], a[48:51]
    ds_read_b128 a[164:167], v17 offset:8192
    v_xor_b32 v20, s60, v20
    v_xor_b32 v21, s60, v21
    v_mfma_f32_16x16x32_bf16 a[64:67], a[208:211], v[148:151], a[64:67]
    ds_read_b128 a[168:171], v18 offset:8192
    buffer_load_dwordx4 v105, s[32:35], s57 offen offset:1024 nt lds
    v_exp_f32 v119, v119
    v_mfma_f32_16x16x32_bf16 a[80:83], a[212:215], v[148:151], a[80:83]
    v_cvt_pk_bf16_f32 v153, v118, v119
    v_exp_f32 v132, v132
    v_mfma_f32_16x16x32_bf16 a[96:99], a[216:219], v[148:151], a[96:99]
    ds_read_b128 a[172:175], v19 offset:8192
    buffer_load_dwordx4 v106, s[32:35], s57 offen offset:2048 nt lds
    v_xor_b32 v22, s60, v22
    v_mfma_f32_16x16x32_bf16 a[112:115], a[220:223], v[148:151], a[112:115]
    ds_read_b128 a[176:179], v16 offset:12288
    v_exp_f32 v133, v133
    v_smfmac_f32_16x16x64_bf16 a[136:139], a[144:147], v[160:167], v43
    buffer_load_dwordx4 v107, s[32:35], s57 offen offset:3072 nt lds
    v_cvt_pk_bf16_f32 v154, v132, v133
    v_exp_f32 v134, v134
    v_mfma_f32_16x16x32_bf16 a[4:7], a[192:195], v[156:159], a[4:7]
    ds_read_b128 a[180:183], v17 offset:12288
    v_xor_b32 v23, s60, v23
    v_xor_b32 v24, s60, v24
    v_mfma_f32_16x16x32_bf16 a[20:23], a[196:199], v[156:159], a[20:23]
    ds_read_b128 a[184:187], v18 offset:12288
    s_add_u32 m0, s59, 12288
    v_exp_f32 v135, v135
    v_mfma_f32_16x16x32_bf16 a[36:39], a[200:203], v[156:159], a[36:39]
    ds_read_b128 a[188:191], v19 offset:12288
    v_cvt_pk_bf16_f32 v155, v134, v135
    v_xor_b32 v25, s60, v25
    v_mfma_f32_16x16x32_bf16 a[52:55], a[204:207], v[156:159], a[52:55]
    ds_read_b32 v40, v37
    buffer_load_dwordx4 v108, s[32:35], s57 offen offset:0 nt lds
    v_exp_f32 v120, v120
    v_mfma_f32_16x16x32_bf16 a[68:71], a[208:211], v[156:159], a[68:71]
    v_exp_f32 v121, v121
    v_xor_b32 v26, s60, v26
    v_mfma_f32_16x16x32_bf16 a[84:87], a[212:215], v[156:159], a[84:87]
    buffer_load_dwordx4 v109, s[32:35], s57 offen offset:1024 nt lds
    v_cvt_pk_bf16_f32 v160, v120, v121
    v_xor_b32 v27, s60, v27
    v_mfma_f32_16x16x32_bf16 a[100:103], a[216:219], v[156:159], a[100:103]
    v_exp_f32 v122, v122
    v_mfma_f32_16x16x32_bf16 a[116:119], a[220:223], v[156:159], a[116:119]
    buffer_load_dwordx4 v110, s[32:35], s57 offen offset:2048 nt lds
    v_exp_f32 v123, v123
    v_mfma_f32_16x16x32_bf16 a[8:11], a[192:195], v[164:167], a[8:11]
    v_cvt_pk_bf16_f32 v161, v122, v123
    v_mfma_f32_16x16x32_bf16 a[24:27], a[196:199], v[164:167], a[24:27]
    buffer_load_dwordx4 v111, s[32:35], s57 offen offset:3072 nt lds
    v_exp_f32 v136, v136
    v_mfma_f32_16x16x32_bf16 a[40:43], a[200:203], v[164:167], a[40:43]
    v_exp_f32 v137, v137
    v_mfma_f32_16x16x32_bf16 a[56:59], a[204:207], v[164:167], a[56:59]
    s_add_u32 s57, s57, 0x2000
    v_cvt_pk_bf16_f32 v162, v136, v137
    v_mfma_f32_16x16x32_bf16 a[72:75], a[208:211], v[164:167], a[72:75]
    v_exp_f32 v138, v138
    v_mfma_f32_16x16x32_bf16 a[88:91], a[212:215], v[164:167], a[88:91]
    v_mfma_f32_16x16x32_bf16 a[104:107], a[216:219], v[164:167], a[104:107]
    v_exp_f32 v139, v139
    v_mfma_f32_16x16x32_bf16 a[120:123], a[220:223], v[164:167], a[120:123]
    v_cvt_pk_bf16_f32 v163, v138, v139
    s_add_u32 s61, s61, 1
    s_xor_b32 s58, s58, s60
    s_xor_b32 s60, s60, 0xc000
    s_xor_b32 s59, s59, s60
    s_cmp_lt_u32 s61, 12
    s_cbranch_scc1 L_loopL
    s_waitcnt vmcnt(32) lgkmcnt(0)
    v_mfma_f32_16x16x32_bf16 v[112:115], a[160:163], v[48:51], v[176:179]
    ds_write_b32 v39, v38
    v_add_u32 v38, 1, v38
    v_cmp_gt_i32 vcc, v36, v40
    v_add_u32 v36, 1, v36
    v_mfma_f32_16x16x32_bf16 v[112:115], a[164:167], v[52:55], v[112:115]
    s_cbranch_vccnz L_waitL24
L_retL24:
    v_mfma_f32_16x16x32_bf16 v[112:115], a[168:171], v[56:59], v[112:115]
    ds_read_b64_tr_b16 a[192:193], v20 offset:0
    ds_read_b64_tr_b16 a[194:195], v20 offset:4096
    s_mov_b32 s57, 245760
    v_mfma_f32_16x16x32_bf16 v[112:115], a[172:175], v[60:63], v[112:115]
    ds_read_b64_tr_b16 a[196:197], v21 offset:0
    ds_read_b64_tr_b16 a[198:199], v21 offset:4096
    v_mfma_f32_16x16x32_bf16 v[128:131], a[176:179], v[48:51], v[176:179]
    ds_read_b64_tr_b16 a[200:201], v22 offset:0
    ds_read_b64_tr_b16 a[202:203], v22 offset:4096
    v_mfma_f32_16x16x32_bf16 v[128:131], a[180:183], v[52:55], v[128:131]
    ds_read_b64_tr_b16 a[204:205], v23 offset:0
    ds_read_b64_tr_b16 a[206:207], v23 offset:4096
    v_mfma_f32_16x16x32_bf16 v[128:131], a[184:187], v[56:59], v[128:131]
    ds_read_b64_tr_b16 a[208:209], v24 offset:0
    ds_read_b64_tr_b16 a[210:211], v24 offset:4096
    s_mov_b32 m0, 98304
    v_mfma_f32_16x16x32_bf16 v[128:131], a[188:191], v[60:63], v[128:131]
    ds_read_b64_tr_b16 a[212:213], v25 offset:0
    ds_read_b64_tr_b16 a[214:215], v25 offset:4096
    v_mfma_f32_16x16x32_bf16 v[116:119], a[160:163], v[64:67], v[180:183]
    ds_read_b64_tr_b16 a[216:217], v26 offset:0
    ds_read_b64_tr_b16 a[218:219], v26 offset:4096
    v_mfma_f32_16x16x32_bf16 v[116:119], a[164:167], v[68:71], v[116:119]
    ds_read_b64_tr_b16 a[220:221], v27 offset:0
    ds_read_b64_tr_b16 a[222:223], v27 offset:4096
    v_mfma_f32_16x16x32_bf16 v[116:119], a[168:171], v[72:75], v[116:119]
    buffer_load_dwordx4 v104, s[32:35], s57 offen offset:0 nt lds
    v_mfma_f32_16x16x32_bf16 v[116:119], a[172:175], v[76:79], v[116:119]
    v_exp_f32 v112, v112
    v_mfma_f32_16x16x32_bf16 v[132:135], a[176:179], v[64:67], v[180:183]
    v_exp_f32 v113, v113
    v_xor_b32 v16, s60, v16
    v_mfma_f32_16x16x32_bf16 v[132:135], a[180:183], v[68:71], v[132:135]
    v_cvt_pk_bf16_f32 v148, v112, v113
    v_xor_b32 v17, s60, v17
    v_xor_b32 v18, s60, v18
    v_mfma_f32_16x16x32_bf16 v[132:135], a[184:187], v[72:75], v[132:135]
    buffer_load_dwordx4 v105, s[32:35], s57 offen offset:1024 nt lds
    v_exp_f32 v114, v114
    v_mfma_f32_16x16x32_bf16 v[132:135], a[188:191], v[76:79], v[132:135]
    v_exp_f32 v115, v115
    v_xor_b32 v19, s60, v19
    v_mfma_f32_16x16x32_bf16 v[120:123], a[160:163], v[80:83], v[184:187]
    v_cvt_pk_bf16_f32 v149, v114, v115
    v_mfma_f32_16x16x32_bf16 v[120:123], a[164:167], v[84:87], v[120:123]
    v_exp_f32 v128, v128
    v_mfma_f32_16x16x32_bf16 v[120:123], a[168:171], v[88:91], v[120:123]
    buffer_load_dwordx4 v106, s[32:35], s57 offen offset:2048 nt lds
    v_mfma_f32_16x16x32_bf16 v[120:123], a[172:175], v[92:95], v[120:123]
    v_exp_f32 v129, v129
    v_mfma_f32_16x16x32_bf16 v[136:139], a[176:179], v[80:83], v[184:187]
    v_cvt_pk_bf16_f32 v150, v128, v129
    v_exp_f32 v130, v130
    v_mfma_f32_16x16x32_bf16 v[136:139], a[180:183], v[84:87], v[136:139]
    v_mfma_f32_16x16x32_bf16 v[136:139], a[184:187], v[88:91], v[136:139]
    buffer_load_dwordx4 v107, s[32:35], s57 offen offset:3072 nt lds
    v_exp_f32 v131, v131
    v_mfma_f32_16x16x32_bf16 v[136:139], a[188:191], v[92:95], v[136:139]
    v_cvt_pk_bf16_f32 v151, v130, v131
    v_exp_f32 v116, v116
    s_waitcnt lgkmcnt(0)
    v_mfma_f32_16x16x32_bf16 a[0:3], a[192:195], v[144:147], a[0:3]
    v_mfma_f32_16x16x32_bf16 a[16:19], a[196:199], v[144:147], a[16:19]
    ds_read_b128 a[160:163], v16 offset:0
    v_exp_f32 v117, v117
    v_mfma_f32_16x16x32_bf16 a[32:35], a[200:203], v[144:147], a[32:35]
    ds_read_b128 a[164:167], v17 offset:0
    v_cvt_pk_bf16_f32 v156, v116, v117
    v_mfma_f32_16x16x32_bf16 a[48:51], a[204:207], v[144:147], a[48:51]
    ds_read_b128 a[168:171], v18 offset:0
    s_mov_b32 m0, 102400
    v_exp_f32 v118, v118
    v_mfma_f32_16x16x32_bf16 a[64:67], a[208:211], v[144:147], a[64:67]
    ds_read_b128 a[172:175], v19 offset:0
    v_exp_f32 v119, v119
    v_mfma_f32_16x16x32_bf16 a[80:83], a[212:215], v[144:147], a[80:83]
    ds_read_b128 a[176:179], v16 offset:4096
    v_cvt_pk_bf16_f32 v157, v118, v119
    v_mfma_f32_16x16x32_bf16 a[96:99], a[216:219], v[144:147], a[96:99]
    ds_read_b128 a[180:183], v17 offset:4096
    v_exp_f32 v132, v132
    v_mfma_f32_16x16x32_bf16 a[112:115], a[220:223], v[144:147], a[112:115]
    ds_read_b128 a[184:187], v18 offset:4096
    buffer_load_dwordx4 v108, s[32:35], s57 offen offset:0 nt lds
    v_exp_f32 v133, v133
    v_mfma_f32_16x16x32_bf16 a[4:7], a[192:195], v[152:155], a[4:7]
    ds_read_b128 a[188:191], v19 offset:4096
    v_cvt_pk_bf16_f32 v158, v132, v133
    v_mfma_f32_16x16x32_bf16 a[20:23], a[196:199], v[152:155], a[20:23]
    ds_read_b32 v40, v37
    v_exp_f32 v134, v134
    v_mfma_f32_16x16x32_bf16 a[36:39], a[200:203], v[152:155], a[36:39]
    v_mfma_f32_16x16x32_bf16 a[52:55], a[204:207], v[152:155], a[52:55]
    buffer_load_dwordx4 v109, s[32:35], s57 offen offset:1024 nt lds
    v_exp_f32 v135, v135
    v_mfma_f32_16x16x32_bf16 a[68:71], a[208:211], v[152:155], a[68:71]
    v_cvt_pk_bf16_f32 v159, v134, v135
    v_exp_f32 v120, v120
    v_mfma_f32_16x16x32_bf16 a[84:87], a[212:215], v[152:155], a[84:87]
    v_mfma_f32_16x16x32_bf16 a[100:103], a[216:219], v[152:155], a[100:103]
    v_exp_f32 v121, v121
    v_mfma_f32_16x16x32_bf16 a[116:119], a[220:223], v[152:155], a[116:119]
    buffer_load_dwordx4 v110, s[32:35], s57 offen offset:2048 nt lds
    v_cvt_pk_bf16_f32 v164, v120, v121
    v_exp_f32 v122, v122
    v_smfmac_f32_16x16x64_bf16 a[128:131], a[144:147], v[144:151], v43
    v_mfma_f32_16x16x32_bf16 a[8:11], a[192:195], v[160:163], a[8:11]
    v_exp_f32 v123, v123
    v_mfma_f32_16x16x32_bf16 a[24:27], a[196:199], v[160:163], a[24:27]
    v_cvt_pk_bf16_f32 v165, v122, v123
    v_mfma_f32_16x16x32_bf16 a[40:43], a[200:203], v[160:163], a[40:43]
    buffer_load_dwordx4 v111, s[32:35], s57 offen offset:3072 nt lds
    v_exp_f32 v136, v136
    v_mfma_f32_16x16x32_bf16 a[56:59], a[204:207], v[160:163], a[56:59]
    v_exp_f32 v137, v137
    v_mfma_f32_16x16x32_bf16 a[72:75], a[208:211], v[160:163], a[72:75]
    v_cvt_pk_bf16_f32 v166, v136, v137
    v_mfma_f32_16x16x32_bf16 a[88:91], a[212:215], v[160:163], a[88:91]
    v_exp_f32 v138, v138
    v_mfma_f32_16x16x32_bf16 a[104:107], a[216:219], v[160:163], a[104:107]
    v_mfma_f32_16x16x32_bf16 a[120:123], a[220:223], v[160:163], a[120:123]
    v_exp_f32 v139, v139
    v_smfmac_f32_16x16x64_bf16 a[132:135], a[144:147], v[152:159], v43
    v_cvt_pk_bf16_f32 v167, v138, v139
    s_waitcnt vmcnt(24) lgkmcnt(0)
    v_mfma_f32_16x16x32_bf16 v[112:115], a[160:163], v[48:51], v[176:179]
    ds_write_b32 v39, v38
    v_add_u32 v38, 1, v38
    v_cmp_gt_i32 vcc, v36, v40
    v_add_u32 v36, 1, v36
    v_mfma_f32_16x16x32_bf16 v[112:115], a[164:167], v[52:55], v[112:115]
    s_cbranch_vccnz L_waitL25
L_retL25:
    v_mfma_f32_16x16x32_bf16 v[112:115], a[168:171], v[56:59], v[112:115]
    ds_read_b64_tr_b16 a[192:193], v20 offset:8192
    ds_read_b64_tr_b16 a[194:195], v20 offset:12288
    s_mov_b32 s57, 253952
    v_mfma_f32_16x16x32_bf16 v[112:115], a[172:175], v[60:63], v[112:115]
    ds_read_b64_tr_b16 a[196:197], v21 offset:8192
    ds_read_b64_tr_b16 a[198:199], v21 offset:12288
    v_mfma_f32_16x16x32_bf16 v[128:131], a[176:179], v[48:51], v[176:179]
    ds_read_b64_tr_b16 a[200:201], v22 offset:8192
    ds_read_b64_tr_b16 a[202:203], v22 offset:12288
    v_mfma_f32_16x16x32_bf16 v[128:131], a[180:183], v[52:55], v[128:131]
    ds_read_b64_tr_b16 a[204:205], v23 offset:8192
    ds_read_b64_tr_b16 a[206:207], v23 offset:12288
    v_mfma_f32_16x16x32_bf16 v[128:131], a[184:187], v[56:59], v[128:131]
    ds_read_b64_tr_b16 a[208:209], v24 offset:8192
    ds_read_b64_tr_b16 a[210:211], v24 offset:12288
    s_mov_b32 m0, 106496
    v_mfma_f32_16x16x32_bf16 v[128:131], a[188:191], v[60:63], v[128:131]
    ds_read_b64_tr_b16 a[212:213], v25 offset:8192
    ds_read_b64_tr_b16 a[214:215], v25 offset:12288
    v_mfma_f32_16x16x32_bf16 v[116:119], a[160:163], v[64:67], v[180:183]
    ds_read_b64_tr_b16 a[216:217], v26 offset:8192
    ds_read_b64_tr_b16 a[218:219], v26 offset:12288
    v_mfma_f32_16x16x32_bf16 v[116:119], a[164:167], v[68:71], v[116:119]
    ds_read_b64_tr_b16 a[220:221], v27 offset:8192
    ds_read_b64_tr_b16 a[222:223], v27 offset:12288
    v_mfma_f32_16x16x32_bf16 v[116:119], a[168:171], v[72:75], v[116:119]
    buffer_load_dwordx4 v104, s[32:35], s57 offen offset:0 nt lds
    v_mfma_f32_16x16x32_bf16 v[116:119], a[172:175], v[76:79], v[116:119]
    v_exp_f32 v112, v112
    v_mfma_f32_16x16x32_bf16 v[132:135], a[176:179], v[64:67], v[180:183]
    v_exp_f32 v113, v113
    v_mfma_f32_16x16x32_bf16 v[132:135], a[180:183], v[68:71], v[132:135]
    v_cvt_pk_bf16_f32 v144, v112, v113
    v_mfma_f32_16x16x32_bf16 v[132:135], a[184:187], v[72:75], v[132:135]
    buffer_load_dwordx4 v105, s[32:35], s57 offen offset:1024 nt lds
    v_exp_f32 v114, v114
    v_mfma_f32_16x16x32_bf16 v[132:135], a[188:191], v[76:79], v[132:135]
    v_exp_f32 v115, v115
    v_mfma_f32_16x16x32_bf16 v[120:123], a[160:163], v[80:83], v[184:187]
    v_cvt_pk_bf16_f32 v145, v114, v115
    v_mfma_f32_16x16x32_bf16 v[120:123], a[164:167], v[84:87], v[120:123]
    v_exp_f32 v128, v128
    v_mfma_f32_16x16x32_bf16 v[120:123], a[168:171], v[88:91], v[120:123]
    buffer_load_dwordx4 v106, s[32:35], s57 offen offset:2048 nt lds
    v_exp_f32 v129, v129
    v_mfma_f32_16x16x32_bf16 v[120:123], a[172:175], v[92:95], v[120:123]
    v_cvt_pk_bf16_f32 v146, v128, v129
    v_mfma_f32_16x16x32_bf16 v[136:139], a[176:179], v[80:83], v[184:187]
    v_exp_f32 v130, v130
    v_mfma_f32_16x16x32_bf16 v[136:139], a[180:183], v[84:87], v[136:139]
    v_exp_f32 v131, v131
    v_mfma_f32_16x16x32_bf16 v[136:139], a[184:187], v[88:91], v[136:139]
    buffer_load_dwordx4 v107, s[32:35], s57 offen offset:3072 nt lds
    v_cvt_pk_bf16_f32 v147, v130, v131
    v_mfma_f32_16x16x32_bf16 v[136:139], a[188:191], v[92:95], v[136:139]
    v_exp_f32 v116, v116
    s_waitcnt lgkmcnt(0)
    v_mfma_f32_16x16x32_bf16 a[0:3], a[192:195], v[148:151], a[0:3]
    v_mfma_f32_16x16x32_bf16 a[16:19], a[196:199], v[148:151], a[16:19]
    ds_read_b128 a[160:163], v16 offset:8192
    v_exp_f32 v117, v117
    v_mfma_f32_16x16x32_bf16 a[32:35], a[200:203], v[148:151], a[32:35]
    s_mov_b32 m0, 110592
    v_cvt_pk_bf16_f32 v152, v116, v117
    v_exp_f32 v118, v118
    v_mfma_f32_16x16x32_bf16 a[48:51], a[204:207], v[148:151], a[48:51]
    ds_read_b128 a[164:167], v17 offset:8192
    v_xor_b32 v20, s60, v20
    v_xor_b32 v21, s60, v21
    v_mfma_f32_16x16x32_bf16 a[64:67], a[208:211], v[148:151], a[64:67]
    ds_read_b128 a[168:171], v18 offset:8192
    v_exp_f32 v119, v119
    v_mfma_f32_16x16x32_bf16 a[80:83], a[212:215], v[148:151], a[80:83]
    v_cvt_pk_bf16_f32 v153, v118, v119
    v_exp_f32 v132, v132
    v_mfma_f32_16x16x32_bf16 a[96:99], a[216:219], v[148:151], a[96:99]
    ds_read_b128 a[172:175], v19 offset:8192
    buffer_load_dwordx4 v108, s[32:35], s57 offen offset:0 nt lds
    v_xor_b32 v22, s60, v22
    v_mfma_f32_16x16x32_bf16 a[112:115], a[220:223], v[148:151], a[112:115]
    ds_read_b128 a[176:179], v16 offset:12288
    v_exp_f32 v133, v133
    v_smfmac_f32_16x16x64_bf16 a[136:139], a[144:147], v[160:167], v43
    v_cvt_pk_bf16_f32 v154, v132, v133
    v_exp_f32 v134, v134
    v_mfma_f32_16x16x32_bf16 a[4:7], a[192:195], v[156:159], a[4:7]
    ds_read_b128 a[180:183], v17 offset:12288
    v_xor_b32 v23, s60, v23
    v_xor_b32 v24, s60, v24
    v_mfma_f32_16x16x32_bf16 a[20:23], a[196:199], v[156:159], a[20:23]
    ds_read_b128 a[184:187], v18 offset:12288
    buffer_load_dwordx4 v109, s[32:35], s57 offen offset:1024 nt lds
    v_exp_f32 v135, v135
    v_mfma_f32_16x16x32_bf16 a[36:39], a[200:203], v[156:159], a[36:39]
    ds_read_b128 a[188:191], v19 offset:12288
    v_cvt_pk_bf16_f32 v155, v134, v135
    v_xor_b32 v25, s60, v25
    v_mfma_f32_16x16x32_bf16 a[52:55], a[204:207], v[156:159], a[52:55]
    ds_read_b32 v40, v37
    v_exp_f32 v120, v120
    v_mfma_f32_16x16x32_bf16 a[68:71], a[208:211], v[156:159], a[68:71]
    v_exp_f32 v121, v121
    v_xor_b32 v26, s60, v26
    v_mfma_f32_16x16x32_bf16 a[84:87], a[212:215], v[156:159], a[84:87]
    buffer_load_dwordx4 v110, s[32:35], s57 offen offset:2048 nt lds
    v_cvt_pk_bf16_f32 v160, v120, v121
    v_xor_b32 v27, s60, v27
    v_mfma_f32_16x16x32_bf16 a[100:103], a[216:219], v[156:159], a[100:103]
    v_exp_f32 v122, v122
    v_mfma_f32_16x16x32_bf16 a[116:119], a[220:223], v[156:159], a[116:119]
    v_exp_f32 v123, v123
    v_mfma_f32_16x16x32_bf16 a[8:11], a[192:195], v[164:167], a[8:11]
    v_cvt_pk_bf16_f32 v161, v122, v123
    v_mfma_f32_16x16x32_bf16 a[24:27], a[196:199], v[164:167], a[24:27]
    buffer_load_dwordx4 v111, s[32:35], s57 offen offset:3072 nt lds
    v_exp_f32 v136, v136
    v_mfma_f32_16x16x32_bf16 a[40:43], a[200:203], v[164:167], a[40:43]
    v_exp_f32 v137, v137
    v_mfma_f32_16x16x32_bf16 a[56:59], a[204:207], v[164:167], a[56:59]
    v_cvt_pk_bf16_f32 v162, v136, v137
    v_mfma_f32_16x16x32_bf16 a[72:75], a[208:211], v[164:167], a[72:75]
    v_exp_f32 v138, v138
    v_mfma_f32_16x16x32_bf16 a[88:91], a[212:215], v[164:167], a[88:91]
    v_mfma_f32_16x16x32_bf16 a[104:107], a[216:219], v[164:167], a[104:107]
    v_exp_f32 v139, v139
    v_mfma_f32_16x16x32_bf16 a[120:123], a[220:223], v[164:167], a[120:123]
    v_cvt_pk_bf16_f32 v163, v138, v139
    s_add_u32 s61, s61, 1
    s_xor_b32 s58, s58, s60
    s_xor_b32 s60, s60, 0xc000
    s_xor_b32 s59, s59, s60
    s_cmp_lt_u32 s61, 12
    v_xor_b32 v20, 0x4000, v20
    v_xor_b32 v21, 0x4000, v21
    v_xor_b32 v22, 0x4000, v22
    v_xor_b32 v23, 0x4000, v23
    v_xor_b32 v24, 0x4000, v24
    v_xor_b32 v25, 0x4000, v25
    v_xor_b32 v26, 0x4000, v26
    v_xor_b32 v27, 0x4000, v27
    v_xor_b32 v16, 0x4000, v16
    v_xor_b32 v17, 0x4000, v17
    v_xor_b32 v18, 0x4000, v18
    v_xor_b32 v19, 0x4000, v19
    s_waitcnt vmcnt(16) lgkmcnt(0)
    v_mfma_f32_16x16x32_bf16 v[112:115], a[160:163], v[48:51], v[176:179]
    ds_write_b32 v39, v38
    v_add_u32 v38, 1, v38
    v_cmp_gt_i32 vcc, v36, v40
    v_add_u32 v36, 1, v36
    v_mfma_f32_16x16x32_bf16 v[112:115], a[164:167], v[52:55], v[112:115]
    s_cbranch_vccnz L_waitL26
L_retL26:
    v_mfma_f32_16x16x32_bf16 v[112:115], a[168:171], v[56:59], v[112:115]
    ds_read_b64_tr_b16 a[192:193], v20 offset:16384
    ds_read_b64_tr_b16 a[194:195], v20 offset:20480
    s_add_u32 s65, s96, 0
    s_mov_b32 m0, 131072
    v_mfma_f32_16x16x32_bf16 v[112:115], a[172:175], v[60:63], v[112:115]
    ds_read_b64_tr_b16 a[196:197], v21 offset:16384
    ds_read_b64_tr_b16 a[198:199], v21 offset:20480
    buffer_load_dwordx4 v168, s[80:83], s65 offen offset:0 lds
    v_mfma_f32_16x16x32_bf16 v[128:131], a[176:179], v[48:51], v[176:179]
    buffer_load_dwordx4 v169, s[80:83], s65 offen offset:1024 lds
    v_mfma_f32_16x16x32_bf16 v[128:131], a[180:183], v[52:55], v[128:131]
    buffer_load_dwordx4 v170, s[80:83], s65 offen offset:2048 lds
    v_mfma_f32_16x16x32_bf16 v[128:131], a[184:187], v[56:59], v[128:131]
    buffer_load_dwordx4 v171, s[80:83], s65 offen offset:3072 lds
    v_mfma_f32_16x16x32_bf16 v[128:131], a[188:191], v[60:63], v[128:131]
    s_mov_b32 m0, 135168
    s_nop 0
    buffer_load_dwordx4 v172, s[80:83], s65 offen offset:0 lds
    v_mfma_f32_16x16x32_bf16 v[116:119], a[160:163], v[64:67], v[180:183]
    buffer_load_dwordx4 v173, s[80:83], s65 offen offset:1024 lds
    v_mfma_f32_16x16x32_bf16 v[116:119], a[164:167], v[68:71], v[116:119]
    buffer_load_dwordx4 v174, s[80:83], s65 offen offset:2048 lds
    v_mfma_f32_16x16x32_bf16 v[116:119], a[168:171], v[72:75], v[116:119]
    buffer_load_dwordx4 v175, s[80:83], s65 offen offset:3072 lds
    v_mfma_f32_16x16x32_bf16 v[116:119], a[172:175], v[76:79], v[116:119]
    s_add_u32 s65, s98, 0
    v_exp_f32 v112, v112
    v_exp_f32 v113, v113
    v_mfma_f32_16x16x32_bf16 v[132:135], a[176:179], v[64:67], v[180:183]
    s_mov_b32 m0, 16384
    v_cvt_pk_bf16_f32 v148, v112, v113
    v_exp_f32 v114, v114
    v_mfma_f32_16x16x32_bf16 v[132:135], a[180:183], v[68:71], v[132:135]
    buffer_load_dwordx4 v168, s[80:83], s65 offen offset:0 lds
    buffer_load_dwordx4 v169, s[80:83], s65 offen offset:1024 lds
    v_exp_f32 v115, v115
    v_mfma_f32_16x16x32_bf16 v[132:135], a[184:187], v[72:75], v[132:135]
    buffer_load_dwordx4 v170, s[80:83], s65 offen offset:2048 lds
    v_cvt_pk_bf16_f32 v149, v114, v115
    v_exp_f32 v128, v128
    v_mfma_f32_16x16x32_bf16 v[132:135], a[188:191], v[76:79], v[132:135]
    buffer_load_dwordx4 v171, s[80:83], s65 offen offset:3072 lds
    v_exp_f32 v129, v129
    v_exp_f32 v130, v130
    v_mfma_f32_16x16x32_bf16 v[120:123], a[160:163], v[80:83], v[184:187]
    s_mov_b32 m0, 20480
    v_cvt_pk_bf16_f32 v150, v128, v129
    v_exp_f32 v131, v131
    v_mfma_f32_16x16x32_bf16 v[120:123], a[164:167], v[84:87], v[120:123]
    buffer_load_dwordx4 v172, s[80:83], s65 offen offset:0 lds
    v_cvt_pk_bf16_f32 v151, v130, v131
    v_exp_f32 v116, v116
    v_mfma_f32_16x16x32_bf16 v[120:123], a[168:171], v[88:91], v[120:123]
    buffer_load_dwordx4 v173, s[80:83], s65 offen offset:1024 lds
    buffer_load_dwordx4 v174, s[80:83], s65 offen offset:2048 lds
    v_exp_f32 v117, v117
    v_mfma_f32_16x16x32_bf16 v[120:123], a[172:175], v[92:95], v[120:123]
    buffer_load_dwordx4 v175, s[80:83], s65 offen offset:3072 lds
    v_cvt_pk_bf16_f32 v156, v116, v117
    v_exp_f32 v118, v118
    v_mfma_f32_16x16x32_bf16 v[136:139], a[176:179], v[80:83], v[184:187]
    s_add_u32 s65, s99, 0
    v_exp_f32 v119, v119
    v_exp_f32 v132, v132
    v_mfma_f32_16x16x32_bf16 v[136:139], a[180:183], v[84:87], v[136:139]
    s_mov_b32 m0, 65536
    v_cvt_pk_bf16_f32 v157, v118, v119
    v_exp_f32 v133, v133
    v_mfma_f32_16x16x32_bf16 v[136:139], a[184:187], v[88:91], v[136:139]
    buffer_load_dwordx4 v168, s[80:83], s65 offen offset:0 lds
    v_cvt_pk_bf16_f32 v158, v132, v133
    v_exp_f32 v134, v134
    v_mfma_f32_16x16x32_bf16 v[136:139], a[188:191], v[92:95], v[136:139]
    buffer_load_dwordx4 v169, s[80:83], s65 offen offset:1024 lds
    v_exp_f32 v135, v135
    s_waitcnt lgkmcnt(0)
    v_mfma_f32_16x16x32_bf16 a[0:3], a[192:195], v[144:147], a[0:3]
    ds_read_b128 a[160:163], v16 offset:49152
    ds_read_b128 a[164:167], v17 offset:49152
    buffer_load_dwordx4 v170, s[80:83], s65 offen offset:2048 lds
    buffer_load_dwordx4 v171, s[80:83], s65 offen offset:3072 lds
    v_cvt_pk_bf16_f32 v159, v134, v135
    v_exp_f32 v120, v120
    v_mfma_f32_16x16x32_bf16 a[16:19], a[196:199], v[144:147], a[16:19]
    ds_read_b128 a[168:171], v18 offset:49152
    ds_read_b128 a[172:175], v19 offset:49152
    s_mov_b32 m0, 69632
    v_exp_f32 v121, v121
    v_exp_f32 v122, v122
    v_mfma_f32_16x16x32_bf16 a[4:7], a[192:195], v[152:155], a[4:7]
    ds_read_b128 a[176:179], v16 offset:53248
    ds_read_b128 a[180:183], v17 offset:53248
    buffer_load_dwordx4 v172, s[80:83], s65 offen offset:0 lds
    v_cvt_pk_bf16_f32 v164, v120, v121
    v_exp_f32 v123, v123
    v_mfma_f32_16x16x32_bf16 a[20:23], a[196:199], v[152:155], a[20:23]
    ds_read_b128 a[184:187], v18 offset:53248
    ds_read_b128 a[188:191], v19 offset:53248
    buffer_load_dwordx4 v173, s[80:83], s65 offen offset:1024 lds
    v_cvt_pk_bf16_f32 v165, v122, v123
    v_exp_f32 v136, v136
    v_smfmac_f32_16x16x64_bf16 a[128:131], a[144:147], v[144:151], v43
    ds_read_b32 v40, v37
    buffer_load_dwordx4 v174, s[80:83], s65 offen offset:2048 lds
    v_exp_f32 v137, v137
    v_mfma_f32_16x16x32_bf16 a[8:11], a[192:195], v[160:163], a[8:11]
    buffer_load_dwordx4 v175, s[80:83], s65 offen offset:3072 lds
    v_cvt_pk_bf16_f32 v166, v136, v137
    v_exp_f32 v138, v138
    v_mfma_f32_16x16x32_bf16 a[24:27], a[196:199], v[160:163], a[24:27]
    v_exp_f32 v139, v139
    v_smfmac_f32_16x16x64_bf16 a[132:135], a[144:147], v[152:159], v43
    v_cvt_pk_bf16_f32 v167, v138, v139
    s_waitcnt vmcnt(32) lgkmcnt(0)
    v_mfma_f32_16x16x32_bf16 v[112:115], a[160:163], v[48:51], v[176:179]
    ds_write_b32 v39, v38
    v_add_u32 v38, 1, v38
    v_cmp_gt_i32 vcc, v36, v40
    v_add_u32 v36, 1, v36
    v_mfma_f32_16x16x32_bf16 v[112:115], a[164:167], v[52:55], v[112:115]
    s_cbranch_vccnz L_waitL27
L_retL27:
    v_mfma_f32_16x16x32_bf16 v[112:115], a[168:171], v[56:59], v[112:115]
    ds_read_b64_tr_b16 a[192:193], v20 offset:24576
    ds_read_b64_tr_b16 a[194:195], v20 offset:28672
    s_add_u32 s65, s96, 524288
    s_mov_b32 m0, 139264
    v_mfma_f32_16x16x32_bf16 v[112:115], a[172:175], v[60:63], v[112:115]
    ds_read_b64_tr_b16 a[196:197], v21 offset:24576
    ds_read_b64_tr_b16 a[198:199], v21 offset:28672
    buffer_load_dwordx4 v168, s[80:83], s65 offen offset:0 lds
    v_mfma_f32_16x16x32_bf16 v[128:131], a[176:179], v[48:51], v[176:179]
    buffer_load_dwordx4 v169, s[80:83], s65 offen offset:1024 lds
    v_mfma_f32_16x16x32_bf16 v[128:131], a[180:183], v[52:55], v[128:131]
    buffer_load_dwordx4 v170, s[80:83], s65 offen offset:2048 lds
    v_mfma_f32_16x16x32_bf16 v[128:131], a[184:187], v[56:59], v[128:131]
    buffer_load_dwordx4 v171, s[80:83], s65 offen offset:3072 lds
    s_mov_b32 m0, 143360
    v_mfma_f32_16x16x32_bf16 v[128:131], a[188:191], v[60:63], v[128:131]
    buffer_load_dwordx4 v172, s[80:83], s65 offen offset:0 lds
    v_mfma_f32_16x16x32_bf16 v[116:119], a[160:163], v[64:67], v[180:183]
    buffer_load_dwordx4 v173, s[80:83], s65 offen offset:1024 lds
    v_mfma_f32_16x16x32_bf16 v[116:119], a[164:167], v[68:71], v[116:119]
    buffer_load_dwordx4 v174, s[80:83], s65 offen offset:2048 lds
    v_mfma_f32_16x16x32_bf16 v[116:119], a[168:171], v[72:75], v[116:119]
    buffer_load_dwordx4 v175, s[80:83], s65 offen offset:3072 lds
    v_mfma_f32_16x16x32_bf16 v[116:119], a[172:175], v[76:79], v[116:119]
    s_add_u32 s65, s98, 524288
    s_mov_b32 m0, 24576
    v_exp_f32 v112, v112
    v_exp_f32 v113, v113
    v_mfma_f32_16x16x32_bf16 v[132:135], a[176:179], v[64:67], v[180:183]
    buffer_load_dwordx4 v168, s[80:83], s65 offen offset:0 lds
    v_cvt_pk_bf16_f32 v192, v112, v113
    v_exp_f32 v114, v114
    v_mfma_f32_16x16x32_bf16 v[132:135], a[180:183], v[68:71], v[132:135]
    buffer_load_dwordx4 v169, s[80:83], s65 offen offset:1024 lds
    v_exp_f32 v115, v115
    v_mfma_f32_16x16x32_bf16 v[132:135], a[184:187], v[72:75], v[132:135]
    buffer_load_dwordx4 v170, s[80:83], s65 offen offset:2048 lds
    v_cvt_pk_bf16_f32 v193, v114, v115
    v_exp_f32 v128, v128
    v_exp_f32 v129, v129
    v_mfma_f32_16x16x32_bf16 v[132:135], a[188:191], v[76:79], v[132:135]
    buffer_load_dwordx4 v171, s[80:83], s65 offen offset:3072 lds
    s_mov_b32 m0, 28672
    v_cvt_pk_bf16_f32 v194, v128, v129
    v_exp_f32 v130, v130
    v_mfma_f32_16x16x32_bf16 v[120:123], a[160:163], v[80:83], v[184:187]
    buffer_load_dwordx4 v172, s[80:83], s65 offen offset:0 lds
    v_exp_f32 v131, v131
    v_mfma_f32_16x16x32_bf16 v[120:123], a[164:167], v[84:87], v[120:123]
    buffer_load_dwordx4 v173, s[80:83], s65 offen offset:1024 lds
    v_cvt_pk_bf16_f32 v195, v130, v131
    v_exp_f32 v116, v116
    v_mfma_f32_16x16x32_bf16 v[120:123], a[168:171], v[88:91], v[120:123]
    buffer_load_dwordx4 v174, s[80:83], s65 offen offset:2048 lds
    v_exp_f32 v117, v117
    v_exp_f32 v118, v118
    v_mfma_f32_16x16x32_bf16 v[120:123], a[172:175], v[92:95], v[120:123]
    buffer_load_dwordx4 v175, s[80:83], s65 offen offset:3072 lds
    v_cvt_pk_bf16_f32 v200, v116, v117
    v_exp_f32 v119, v119
    v_mfma_f32_16x16x32_bf16 v[136:139], a[176:179], v[80:83], v[184:187]
    s_add_u32 s65, s99, 524288
    s_mov_b32 m0, 73728
    v_cvt_pk_bf16_f32 v201, v118, v119
    v_exp_f32 v132, v132
    v_mfma_f32_16x16x32_bf16 v[136:139], a[180:183], v[84:87], v[136:139]
    buffer_load_dwordx4 v168, s[80:83], s65 offen offset:0 lds
    v_exp_f32 v133, v133
    v_exp_f32 v134, v134
    v_mfma_f32_16x16x32_bf16 v[136:139], a[184:187], v[88:91], v[136:139]
    buffer_load_dwordx4 v169, s[80:83], s65 offen offset:1024 lds
    v_cvt_pk_bf16_f32 v202, v132, v133
    v_exp_f32 v135, v135
    v_mfma_f32_16x16x32_bf16 v[136:139], a[188:191], v[92:95], v[136:139]
    buffer_load_dwordx4 v170, s[80:83], s65 offen offset:2048 lds
    v_cvt_pk_bf16_f32 v203, v134, v135
    v_exp_f32 v120, v120
    s_waitcnt lgkmcnt(0)
    v_mfma_f32_16x16x32_bf16 a[0:3], a[192:195], v[148:151], a[0:3]
    ds_read_b128 a[160:163], v16 offset:57344
    ds_read_b128 a[164:167], v17 offset:57344
    ds_read_b128 a[168:171], v18 offset:57344
    buffer_load_dwordx4 v171, s[80:83], s65 offen offset:3072 lds
    s_mov_b32 m0, 77824
    v_exp_f32 v121, v121
    v_mfma_f32_16x16x32_bf16 a[16:19], a[196:199], v[148:151], a[16:19]
    ds_read_b128 a[172:175], v19 offset:57344
    ds_read_b128 a[176:179], v16 offset:61440
    ds_read_b128 a[180:183], v17 offset:61440
    buffer_load_dwordx4 v172, s[80:83], s65 offen offset:0 lds
    v_cvt_pk_bf16_f32 v208, v120, v121
    v_exp_f32 v122, v122
    v_exp_f32 v123, v123
    v_smfmac_f32_16x16x64_bf16 a[136:139], a[144:147], v[160:167], v43
    ds_read_b128 a[184:187], v18 offset:61440
    ds_read_b128 a[188:191], v19 offset:61440
    buffer_load_dwordx4 v173, s[80:83], s65 offen offset:1024 lds
    v_cvt_pk_bf16_f32 v209, v122, v123
    v_exp_f32 v136, v136
    v_mfma_f32_16x16x32_bf16 a[4:7], a[192:195], v[156:159], a[4:7]
    ds_read_b32 v40, v37
    buffer_load_dwordx4 v174, s[80:83], s65 offen offset:2048 lds
    v_exp_f32 v137, v137
    v_mfma_f32_16x16x32_bf16 a[20:23], a[196:199], v[156:159], a[20:23]
    buffer_load_dwordx4 v175, s[80:83], s65 offen offset:3072 lds
    v_cvt_pk_bf16_f32 v210, v136, v137
    v_exp_f32 v138, v138
    v_mfma_f32_16x16x32_bf16 a[8:11], a[192:195], v[164:167], a[8:11]
    v_exp_f32 v139, v139
    v_mfma_f32_16x16x32_bf16 a[24:27], a[196:199], v[164:167], a[24:27]
    v_cvt_pk_bf16_f32 v211, v138, v139
    s_waitcnt vmcnt(48) lgkmcnt(0)
    v_mfma_f32_16x16x32_bf16 v[112:115], a[160:163], v[48:51], v[176:179]
    ds_write_b32 v39, v38
    v_add_u32 v38, 1, v38
    v_cmp_gt_i32 vcc, v36, v40
    v_add_u32 v36, 1, v36
    v_mfma_f32_16x16x32_bf16 v[112:115], a[164:167], v[52:55], v[112:115]
    s_cbranch_vccnz L_waitL28
L_retL28:
    v_mfma_f32_16x16x32_bf16 v[112:115], a[168:171], v[56:59], v[112:115]
    ds_read_b64_tr_b16 a[192:193], v20 offset:49152
    ds_read_b64_tr_b16 a[194:195], v20 offset:53248
    s_add_u32 s65, s97, 0
    v_mfma_f32_16x16x32_bf16 v[112:115], a[172:175], v[60:63], v[112:115]
    ds_read_b64_tr_b16 a[196:197], v21 offset:49152
    ds_read_b64_tr_b16 a[198:199], v21 offset:53248
    s_mov_b32 m0, 0
    v_mfma_f32_16x16x32_bf16 v[128:131], a[176:179], v[48:51], v[176:179]
    buffer_load_dwordx4 v168, s[80:83], s65 offen offset:0 lds
    v_mfma_f32_16x16x32_bf16 v[128:131], a[180:183], v[52:55], v[128:131]
    buffer_load_dwordx4 v169, s[80:83], s65 offen offset:1024 lds
    v_mfma_f32_16x16x32_bf16 v[128:131], a[184:187], v[56:59], v[128:131]
    v_mfma_f32_16x16x32_bf16 v[128:131], a[188:191], v[60:63], v[128:131]
    buffer_load_dwordx4 v170, s[80:83], s65 offen offset:2048 lds
    v_mfma_f32_16x16x32_bf16 v[116:119], a[160:163], v[64:67], v[180:183]
    buffer_load_dwordx4 v171, s[80:83], s65 offen offset:3072 lds
    v_mfma_f32_16x16x32_bf16 v[116:119], a[164:167], v[68:71], v[116:119]
    s_mov_b32 m0, 4096
    v_mfma_f32_16x16x32_bf16 v[116:119], a[168:171], v[72:75], v[116:119]
    buffer_load_dwordx4 v172, s[80:83], s65 offen offset:0 lds
    v_mfma_f32_16x16x32_bf16 v[116:119], a[172:175], v[76:79], v[116:119]
    v_exp_f32 v112, v112
    v_exp_f32 v113, v113
    v_mfma_f32_16x16x32_bf16 v[132:135], a[176:179], v[64:67], v[180:183]
    buffer_load_dwordx4 v173, s[80:83], s65 offen offset:1024 lds
    v_cvt_pk_bf16_f32 v196, v112, v113
    v_exp_f32 v114, v114
    v_mfma_f32_16x16x32_bf16 v[132:135], a[180:183], v[68:71], v[132:135]
    buffer_load_dwordx4 v174, s[80:83], s65 offen offset:2048 lds
    v_exp_f32 v115, v115
    v_mfma_f32_16x16x32_bf16 v[132:135], a[184:187], v[72:75], v[132:135]
    buffer_load_dwordx4 v175, s[80:83], s65 offen offset:3072 lds
    v_cvt_pk_bf16_f32 v197, v114, v115
    v_exp_f32 v128, v128
    v_mfma_f32_16x16x32_bf16 v[132:135], a[188:191], v[76:79], v[132:135]
    v_exp_f32 v129, v129
    v_exp_f32 v130, v130
    v_mfma_f32_16x16x32_bf16 v[120:123], a[160:163], v[80:83], v[184:187]
    s_add_u32 s65, s96, 131072
    v_cvt_pk_bf16_f32 v198, v128, v129
    v_exp_f32 v131, v131
    v_mfma_f32_16x16x32_bf16 v[120:123], a[164:167], v[84:87], v[120:123]
    s_mov_b32 m0, 49152
    v_cvt_pk_bf16_f32 v199, v130, v131
    v_exp_f32 v116, v116
    v_mfma_f32_16x16x32_bf16 v[120:123], a[168:171], v[88:91], v[120:123]
    buffer_load_dwordx4 v168, s[80:83], s65 offen offset:0 lds
    v_exp_f32 v117, v117
    v_mfma_f32_16x16x32_bf16 v[120:123], a[172:175], v[92:95], v[120:123]
    buffer_load_dwordx4 v169, s[80:83], s65 offen offset:1024 lds
    v_cvt_pk_bf16_f32 v204, v116, v117
    v_exp_f32 v118, v118
    v_mfma_f32_16x16x32_bf16 v[136:139], a[176:179], v[80:83], v[184:187]
    v_exp_f32 v119, v119
    v_exp_f32 v132, v132
    v_mfma_f32_16x16x32_bf16 v[136:139], a[180:183], v[84:87], v[136:139]
    buffer_load_dwordx4 v170, s[80:83], s65 offen offset:2048 lds
    v_cvt_pk_bf16_f32 v205, v118, v119
    v_exp_f32 v133, v133
    v_mfma_f32_16x16x32_bf16 v[136:139], a[184:187], v[88:91], v[136:139]
    buffer_load_dwordx4 v171, s[80:83], s65 offen offset:3072 lds
    v_cvt_pk_bf16_f32 v206, v132, v133
    v_exp_f32 v134, v134
    v_mfma_f32_16x16x32_bf16 v[136:139], a[188:191], v[92:95], v[136:139]
    s_mov_b32 m0, 53248
    v_exp_f32 v135, v135
    s_waitcnt lgkmcnt(0)
    v_mfma_f32_16x16x32_bf16 a[0:3], a[192:195], v[192:195], a[0:3]
    ds_read_b128 a[160:163], v16 offset:32768
    ds_read_b128 a[164:167], v17 offset:32768
    buffer_load_dwordx4 v172, s[80:83], s65 offen offset:0 lds
    v_cvt_pk_bf16_f32 v207, v134, v135
    v_exp_f32 v120, v120
    v_mfma_f32_16x16x32_bf16 a[16:19], a[196:199], v[192:195], a[16:19]
    ds_read_b128 a[168:171], v18 offset:32768
    ds_read_b128 a[172:175], v19 offset:32768
    v_exp_f32 v121, v121
    v_exp_f32 v122, v122
    v_mfma_f32_16x16x32_bf16 a[4:7], a[192:195], v[200:203], a[4:7]
    ds_read_b128 a[176:179], v16 offset:36864
    ds_read_b128 a[180:183], v17 offset:36864
    buffer_load_dwordx4 v173, s[80:83], s65 offen offset:1024 lds
    v_cvt_pk_bf16_f32 v212, v120, v121
    v_exp_f32 v123, v123
    v_mfma_f32_16x16x32_bf16 a[20:23], a[196:199], v[200:203], a[20:23]
    ds_read_b128 a[184:187], v18 offset:36864
    ds_read_b128 a[188:191], v19 offset:36864
    buffer_load_dwordx4 v174, s[80:83], s65 offen offset:2048 lds
    v_cvt_pk_bf16_f32 v213, v122, v123
    v_exp_f32 v136, v136
    v_smfmac_f32_16x16x64_bf16 a[128:131], a[144:147], v[192:199], v43
    ds_read_b32 v40, v37
    buffer_load_dwordx4 v175, s[80:83], s65 offen offset:3072 lds
    v_exp_f32 v137, v137
    v_mfma_f32_16x16x32_bf16 a[8:11], a[192:195], v[208:211], a[8:11]
    v_cvt_pk_bf16_f32 v214, v136, v137
    v_exp_f32 v138, v138
    v_mfma_f32_16x16x32_bf16 a[24:27], a[196:199], v[208:211], a[24:27]
    v_exp_f32 v139, v139
    v_smfmac_f32_16x16x64_bf16 a[132:135], a[144:147], v[200:207], v43
    v_cvt_pk_bf16_f32 v215, v138, v139
    s_waitcnt lgkmcnt(0)
    v_mfma_f32_16x16x32_bf16 v[112:115], a[160:163], v[48:51], v[176:179]
    v_cmp_gt_i32 vcc, v36, v40
    v_add_u32 v36, 1, v36
    v_mfma_f32_16x16x32_bf16 v[112:115], a[164:167], v[52:55], v[112:115]
    s_cbranch_vccnz L_waitL29
L_retL29:
    v_mfma_f32_16x16x32_bf16 v[112:115], a[168:171], v[56:59], v[112:115]
    ds_read_b64_tr_b16 a[192:193], v20 offset:57344
    ds_read_b64_tr_b16 a[194:195], v20 offset:61440
    s_add_u32 s65, s97, 524288
    v_mfma_f32_16x16x32_bf16 v[112:115], a[172:175], v[60:63], v[112:115]
    ds_read_b64_tr_b16 a[196:197], v21 offset:57344
    ds_read_b64_tr_b16 a[198:199], v21 offset:61440
    s_mov_b32 m0, 8192
    v_mfma_f32_16x16x32_bf16 v[128:131], a[176:179], v[48:51], v[176:179]
    buffer_load_dwordx4 v168, s[80:83], s65 offen offset:0 lds
    v_mfma_f32_16x16x32_bf16 v[128:131], a[180:183], v[52:55], v[128:131]
    buffer_load_dwordx4 v169, s[80:83], s65 offen offset:1024 lds
    v_mfma_f32_16x16x32_bf16 v[128:131], a[184:187], v[56:59], v[128:131]
    buffer_load_dwordx4 v170, s[80:83], s65 offen offset:2048 lds
    v_mfma_f32_16x16x32_bf16 v[128:131], a[188:191], v[60:63], v[128:131]
    v_mfma_f32_16x16x32_bf16 v[116:119], a[160:163], v[64:67], v[180:183]
    buffer_load_dwordx4 v171, s[80:83], s65 offen offset:3072 lds
    v_mfma_f32_16x16x32_bf16 v[116:119], a[164:167], v[68:71], v[116:119]
    s_mov_b32 m0, 12288
    v_mfma_f32_16x16x32_bf16 v[116:119], a[168:171], v[72:75], v[116:119]
    buffer_load_dwordx4 v172, s[80:83], s65 offen offset:0 lds
    v_mfma_f32_16x16x32_bf16 v[116:119], a[172:175], v[76:79], v[116:119]
    buffer_load_dwordx4 v173, s[80:83], s65 offen offset:1024 lds
    v_exp_f32 v112, v112
    v_exp_f32 v113, v113
    v_mfma_f32_16x16x32_bf16 v[132:135], a[176:179], v[64:67], v[180:183]
    v_cvt_pk_bf16_f32 v224, v112, v113
    v_exp_f32 v114, v114
    v_mfma_f32_16x16x32_bf16 v[132:135], a[180:183], v[68:71], v[132:135]
    buffer_load_dwordx4 v174, s[80:83], s65 offen offset:2048 lds
    v_exp_f32 v115, v115
    v_mfma_f32_16x16x32_bf16 v[132:135], a[184:187], v[72:75], v[132:135]
    buffer_load_dwordx4 v175, s[80:83], s65 offen offset:3072 lds
    v_cvt_pk_bf16_f32 v225, v114, v115
    v_exp_f32 v128, v128
    v_exp_f32 v129, v129
    v_mfma_f32_16x16x32_bf16 v[132:135], a[188:191], v[76:79], v[132:135]
    s_add_u32 s65, s96, 655360
    v_cvt_pk_bf16_f32 v226, v128, v129
    v_exp_f32 v130, v130
    v_mfma_f32_16x16x32_bf16 v[120:123], a[160:163], v[80:83], v[184:187]
    s_mov_b32 m0, 57344
    v_exp_f32 v131, v131
    v_mfma_f32_16x16x32_bf16 v[120:123], a[164:167], v[84:87], v[120:123]
    buffer_load_dwordx4 v168, s[80:83], s65 offen offset:0 lds
    v_cvt_pk_bf16_f32 v227, v130, v131
    v_exp_f32 v116, v116
    v_mfma_f32_16x16x32_bf16 v[120:123], a[168:171], v[88:91], v[120:123]
    v_exp_f32 v117, v117
    v_exp_f32 v118, v118
    v_mfma_f32_16x16x32_bf16 v[120:123], a[172:175], v[92:95], v[120:123]
    buffer_load_dwordx4 v169, s[80:83], s65 offen offset:1024 lds
    v_cvt_pk_bf16_f32 v232, v116, v117
    v_exp_f32 v119, v119
    v_mfma_f32_16x16x32_bf16 v[136:139], a[176:179], v[80:83], v[184:187]
    buffer_load_dwordx4 v170, s[80:83], s65 offen offset:2048 lds
    v_cvt_pk_bf16_f32 v233, v118, v119
    v_exp_f32 v132, v132
    v_mfma_f32_16x16x32_bf16 v[136:139], a[180:183], v[84:87], v[136:139]
    buffer_load_dwordx4 v171, s[80:83], s65 offen offset:3072 lds
    v_exp_f32 v133, v133
    v_exp_f32 v134, v134
    v_mfma_f32_16x16x32_bf16 v[136:139], a[184:187], v[88:91], v[136:139]
    s_mov_b32 m0, 61440
    v_cvt_pk_bf16_f32 v234, v132, v133
    v_exp_f32 v135, v135
    v_mfma_f32_16x16x32_bf16 v[136:139], a[188:191], v[92:95], v[136:139]
    v_cvt_pk_bf16_f32 v235, v134, v135
    v_exp_f32 v120, v120
    s_waitcnt lgkmcnt(0)
    v_mfma_f32_16x16x32_bf16 a[0:3], a[192:195], v[196:199], a[0:3]
    ds_read_b128 a[160:163], v16 offset:40960
    ds_read_b128 a[164:167], v17 offset:40960
    ds_read_b128 a[168:171], v18 offset:40960
    buffer_load_dwordx4 v172, s[80:83], s65 offen offset:0 lds
    v_exp_f32 v121, v121
    v_mfma_f32_16x16x32_bf16 a[16:19], a[196:199], v[196:199], a[16:19]
    ds_read_b128 a[172:175], v19 offset:40960
    ds_read_b128 a[176:179], v16 offset:45056
    ds_read_b128 a[180:183], v17 offset:45056
    buffer_load_dwordx4 v173, s[80:83], s65 offen offset:1024 lds
    v_cvt_pk_bf16_f32 v240, v120, v121
    v_exp_f32 v122, v122
    v_exp_f32 v123, v123
    v_smfmac_f32_16x16x64_bf16 a[136:139], a[144:147], v[208:215], v43
    ds_read_b128 a[184:187], v18 offset:45056
    ds_read_b128 a[188:191], v19 offset:45056
    buffer_load_dwordx4 v174, s[80:83], s65 offen offset:2048 lds
    v_cvt_pk_bf16_f32 v241, v122, v123
    v_exp_f32 v136, v136
    v_mfma_f32_16x16x32_bf16 a[4:7], a[192:195], v[204:207], a[4:7]
    ds_read_b32 v40, v37
    buffer_load_dwordx4 v175, s[80:83], s65 offen offset:3072 lds
    v_exp_f32 v137, v137
    v_mfma_f32_16x16x32_bf16 a[20:23], a[196:199], v[204:207], a[20:23]
    v_cvt_pk_bf16_f32 v242, v136, v137
    v_exp_f32 v138, v138
    v_mfma_f32_16x16x32_bf16 a[8:11], a[192:195], v[212:215], a[8:11]
    v_exp_f32 v139, v139
    v_mfma_f32_16x16x32_bf16 a[24:27], a[196:199], v[212:215], a[24:27]
    v_cvt_pk_bf16_f32 v243, v138, v139
    s_waitcnt lgkmcnt(0)
    v_mfma_f32_16x16x32_bf16 v[112:115], a[160:163], v[48:51], v[176:179]
    v_cmp_gt_i32 vcc, v36, v40
    v_add_u32 v36, 1, v36
    v_mfma_f32_16x16x32_bf16 v[112:115], a[164:167], v[52:55], v[112:115]
    s_cbranch_vccnz L_waitL30
L_retL30:
    v_mfma_f32_16x16x32_bf16 v[112:115], a[168:171], v[56:59], v[112:115]
    ds_read_b64_tr_b16 a[192:193], v20 offset:32768
    ds_read_b64_tr_b16 a[194:195], v20 offset:36864
    s_add_u32 s65, s97, 131072
    v_mfma_f32_16x16x32_bf16 v[112:115], a[172:175], v[60:63], v[112:115]
    ds_read_b64_tr_b16 a[196:197], v21 offset:32768
    ds_read_b64_tr_b16 a[198:199], v21 offset:36864
    v_mfma_f32_16x16x32_bf16 v[128:131], a[176:179], v[48:51], v[176:179]
    s_mov_b32 m0, 32768
    v_mfma_f32_16x16x32_bf16 v[128:131], a[180:183], v[52:55], v[128:131]
    v_mfma_f32_16x16x32_bf16 v[128:131], a[184:187], v[56:59], v[128:131]
    v_mfma_f32_16x16x32_bf16 v[128:131], a[188:191], v[60:63], v[128:131]
    buffer_load_dwordx4 v168, s[80:83], s65 offen offset:0 lds
    v_mfma_f32_16x16x32_bf16 v[116:119], a[160:163], v[64:67], v[180:183]
    v_mfma_f32_16x16x32_bf16 v[116:119], a[164:167], v[68:71], v[116:119]
    buffer_load_dwordx4 v169, s[80:83], s65 offen offset:1024 lds
    v_mfma_f32_16x16x32_bf16 v[116:119], a[168:171], v[72:75], v[116:119]
    v_mfma_f32_16x16x32_bf16 v[116:119], a[172:175], v[76:79], v[116:119]
    v_exp_f32 v112, v112
    v_exp_f32 v113, v113
    v_mfma_f32_16x16x32_bf16 v[132:135], a[176:179], v[64:67], v[180:183]
    buffer_load_dwordx4 v170, s[80:83], s65 offen offset:2048 lds
    v_cvt_pk_bf16_f32 v228, v112, v113
    v_exp_f32 v114, v114
    v_mfma_f32_16x16x32_bf16 v[132:135], a[180:183], v[68:71], v[132:135]
    v_exp_f32 v115, v115
    v_mfma_f32_16x16x32_bf16 v[132:135], a[184:187], v[72:75], v[132:135]
    buffer_load_dwordx4 v171, s[80:83], s65 offen offset:3072 lds
    v_cvt_pk_bf16_f32 v229, v114, v115
    v_exp_f32 v128, v128
    v_mfma_f32_16x16x32_bf16 v[132:135], a[188:191], v[76:79], v[132:135]
    v_exp_f32 v129, v129
    v_exp_f32 v130, v130
    v_mfma_f32_16x16x32_bf16 v[120:123], a[160:163], v[80:83], v[184:187]
    v_cvt_pk_bf16_f32 v230, v128, v129
    v_exp_f32 v131, v131
    v_mfma_f32_16x16x32_bf16 v[120:123], a[164:167], v[84:87], v[120:123]
    s_mov_b32 m0, 36864
    v_cvt_pk_bf16_f32 v231, v130, v131
    v_exp_f32 v116, v116
    v_mfma_f32_16x16x32_bf16 v[120:123], a[168:171], v[88:91], v[120:123]
    v_exp_f32 v117, v117
    v_mfma_f32_16x16x32_bf16 v[120:123], a[172:175], v[92:95], v[120:123]
    buffer_load_dwordx4 v172, s[80:83], s65 offen offset:0 lds
    v_cvt_pk_bf16_f32 v236, v116, v117
    v_exp_f32 v118, v118
    v_mfma_f32_16x16x32_bf16 v[136:139], a[176:179], v[80:83], v[184:187]
    v_exp_f32 v119, v119
    v_exp_f32 v132, v132
    v_mfma_f32_16x16x32_bf16 v[136:139], a[180:183], v[84:87], v[136:139]
    v_cvt_pk_bf16_f32 v237, v118, v119
    v_exp_f32 v133, v133
    v_mfma_f32_16x16x32_bf16 v[136:139], a[184:187], v[88:91], v[136:139]
    buffer_load_dwordx4 v173, s[80:83], s65 offen offset:1024 lds
    v_cvt_pk_bf16_f32 v238, v132, v133
    v_exp_f32 v134, v134
    v_mfma_f32_16x16x32_bf16 v[136:139], a[188:191], v[92:95], v[136:139]
    v_exp_f32 v135, v135
    s_waitcnt lgkmcnt(0)
    v_mfma_f32_16x16x32_bf16 a[0:3], a[192:195], v[224:227], a[0:3]
    buffer_load_dwordx4 v174, s[80:83], s65 offen offset:2048 lds
    v_cvt_pk_bf16_f32 v239, v134, v135
    v_exp_f32 v120, v120
    v_mfma_f32_16x16x32_bf16 a[16:19], a[196:199], v[224:227], a[16:19]
    ds_read_b32 v40, v37
    v_exp_f32 v121, v121
    v_exp_f32 v122, v122
    v_mfma_f32_16x16x32_bf16 a[4:7], a[192:195], v[232:235], a[4:7]
    v_cvt_pk_bf16_f32 v244, v120, v121
    v_exp_f32 v123, v123
    v_mfma_f32_16x16x32_bf16 a[20:23], a[196:199], v[232:235], a[20:23]
    buffer_load_dwordx4 v175, s[80:83], s65 offen offset:3072 lds
    v_cvt_pk_bf16_f32 v245, v122, v123
    v_exp_f32 v136, v136
    v_smfmac_f32_16x16x64_bf16 a[128:131], a[144:147], v[224:231], v43
    v_exp_f32 v137, v137
    v_mfma_f32_16x16x32_bf16 a[8:11], a[192:195], v[240:243], a[8:11]
    v_cvt_pk_bf16_f32 v246, v136, v137
    v_exp_f32 v138, v138
    v_mfma_f32_16x16x32_bf16 a[24:27], a[196:199], v[240:243], a[24:27]
    v_exp_f32 v139, v139
    v_smfmac_f32_16x16x64_bf16 a[132:135], a[144:147], v[232:239], v43
    v_cvt_pk_bf16_f32 v247, v138, v139
L_pretail:
    ds_read_b32 v40, v37
    s_waitcnt lgkmcnt(0)
    v_cmp_gt_i32 vcc, v36, v40
    s_add_u32 s49, s49, 1
    s_cmp_ge_u32 s49, 0x80000
    s_cbranch_scc1 L_end
    s_cbranch_vccnz L_pretail
    s_add_u32 s65, s97, 655360
    s_mov_b32 m0, 40960
    s_nop 0
    buffer_load_dwordx4 v168, s[80:83], s65 offen offset:0 lds
    buffer_load_dwordx4 v169, s[80:83], s65 offen offset:1024 lds
    buffer_load_dwordx4 v170, s[80:83], s65 offen offset:2048 lds
    buffer_load_dwordx4 v171, s[80:83], s65 offen offset:3072 lds
    s_mov_b32 m0, 45056
    s_nop 0
    buffer_load_dwordx4 v172, s[80:83], s65 offen offset:0 lds
    buffer_load_dwordx4 v173, s[80:83], s65 offen offset:1024 lds
    buffer_load_dwordx4 v174, s[80:83], s65 offen offset:2048 lds
    buffer_load_dwordx4 v175, s[80:83], s65 offen offset:3072 lds
    s_branch L_tail
L_waitL24:
    ds_read_b32 v40, v37
    s_waitcnt lgkmcnt(0)
    v_add_u32 v9, 1, v40
    v_cmp_gt_i32 vcc, v36, v9
    s_add_u32 s49, s49, 1
    s_cmp_ge_u32 s49, 0x80000
    s_cbranch_scc1 L_end
    s_cbranch_vccnz L_waitL24
    s_branch L_retL24
L_waitL25:
    ds_read_b32 v40, v37
    s_waitcnt lgkmcnt(0)
    v_add_u32 v9, 1, v40
    v_cmp_gt_i32 vcc, v36, v9
    s_add_u32 s49, s49, 1
    s_cmp_ge_u32 s49, 0x80000
    s_cbranch_scc1 L_end
    s_cbranch_vccnz L_waitL25
    s_branch L_retL25
L_waitL26:
    ds_read_b32 v40, v37
    s_waitcnt lgkmcnt(0)
    v_add_u32 v9, 1, v40
    v_cmp_gt_i32 vcc, v36, v9
    s_add_u32 s49, s49, 1
    s_cmp_ge_u32 s49, 0x80000
    s_cbranch_scc1 L_end
    s_cbranch_vccnz L_waitL26
    s_branch L_retL26
L_waitL27:
    ds_read_b32 v40, v37
    s_waitcnt lgkmcnt(0)
    v_add_u32 v9, 1, v40
    v_cmp_gt_i32 vcc, v36, v9
    s_add_u32 s49, s49, 1
    s_cmp_ge_u32 s49, 0x80000
    s_cbranch_scc1 L_end
    s_cbranch_vccnz L_waitL27
    s_branch L_retL27
L_waitL28:
    ds_read_b32 v40, v37
    s_waitcnt lgkmcnt(0)
    v_add_u32 v9, 1, v40
    v_cmp_gt_i32 vcc, v36, v9
    s_add_u32 s49, s49, 1
    s_cmp_ge_u32 s49, 0x80000
    s_cbranch_scc1 L_end
    s_cbranch_vccnz L_waitL28
    s_branch L_retL28
L_waitL29:
    ds_read_b32 v40, v37
    s_waitcnt lgkmcnt(0)
    v_add_u32 v9, 1, v40
    v_cmp_gt_i32 vcc, v36, v9
    s_add_u32 s49, s49, 1
    s_cmp_ge_u32 s49, 0x80000
    s_cbranch_scc1 L_end
    s_cbranch_vccnz L_waitL29
    s_branch L_retL29
L_waitL30:
    ds_read_b32 v40, v37
    s_waitcnt lgkmcnt(0)
    v_add_u32 v9, 1, v40
    v_cmp_gt_i32 vcc, v36, v9
    s_add_u32 s49, s49, 1
    s_cmp_ge_u32 s49, 0x80000
    s_cbranch_scc1 L_end
    s_cbranch_vccnz L_waitL30
    s_branch L_retL30
L_tail:
    ds_read_b64_tr_b16 a[192:193], v20 offset:40960
    ds_read_b64_tr_b16 a[194:195], v20 offset:45056
    ds_read_b64_tr_b16 a[196:197], v21 offset:40960
    ds_read_b64_tr_b16 a[198:199], v21 offset:45056
    ds_read_b64_tr_b16 a[200:201], v22 offset:16384
    ds_read_b64_tr_b16 a[202:203], v22 offset:20480
    ds_read_b64_tr_b16 a[204:205], v23 offset:16384
    ds_read_b64_tr_b16 a[206:207], v23 offset:20480
    ds_read_b64_tr_b16 a[208:209], v22 offset:24576
    ds_read_b64_tr_b16 a[210:211], v22 offset:28672
    ds_read_b64_tr_b16 a[212:213], v23 offset:24576
    ds_read_b64_tr_b16 a[214:215], v23 offset:28672
    ds_read_b64_tr_b16 a[216:217], v22 offset:49152
    ds_read_b64_tr_b16 a[218:219], v22 offset:53248
    ds_read_b64_tr_b16 a[220:221], v23 offset:49152
    ds_read_b64_tr_b16 a[222:223], v23 offset:53248
    v_exp_f32 v127, v127
    v_exp_f32 v140, v140
    v_exp_f32 v141, v141
    v_exp_f32 v142, v142
    v_exp_f32 v143, v143
    v_cvt_pk_bf16_f32 v253, v126, v127
    v_cvt_pk_bf16_f32 v254, v140, v141
    v_cvt_pk_bf16_f32 v255, v142, v143
    s_mov_b32 s3, 0x4f800000
    s_lshl_b32 s66, s40, 2
    s_add_u32 s66, s66, 156672
    v_smfmac_f32_16x16x64_bf16 a[136:139], a[144:147], v[240:247], v43
    v_smfmac_f32_16x16x64_bf16 a[140:143], a[144:147], v[248:255], v43
    v_mov_b32 v9, s66
    v_mov_b32 v14, 156672
    s_mov_b32 s56, s36
    s_mov_b32 s57, s37
    s_and_b32 s58, s50, 16384
    s_mov_b32 s59, 0x20000
    s_waitcnt lgkmcnt(12)
    v_mfma_f32_16x16x32_bf16 a[0:3], a[192:195], v[228:231], a[0:3]
    v_mfma_f32_16x16x32_bf16 a[16:19], a[196:199], v[228:231], a[16:19]
    v_accvgpr_read_b32 v10, a128
    v_accvgpr_read_b32 v11, a132
    v_mfma_f32_16x16x32_bf16 a[4:7], a[192:195], v[236:239], a[4:7]
    v_accvgpr_read_b32 v12, a136
    v_accvgpr_read_b32 v13, a140
    v_mfma_f32_16x16x32_bf16 a[20:23], a[196:199], v[236:239], a[20:23]
    v_accvgpr_read_b32 v112, a129
    v_accvgpr_read_b32 v113, a133
    v_mfma_f32_16x16x32_bf16 a[8:11], a[192:195], v[244:247], a[8:11]
    v_accvgpr_read_b32 v114, a137
    v_accvgpr_read_b32 v115, a141
    v_mfma_f32_16x16x32_bf16 a[24:27], a[196:199], v[244:247], a[24:27]
    v_add_f32 v10, v10, v112
    v_add_f32 v11, v11, v113
    v_mfma_f32_16x16x32_bf16 a[12:15], a[192:195], v[252:255], a[12:15]
    v_add_f32 v12, v12, v114
    v_add_f32 v13, v13, v115
    v_mfma_f32_16x16x32_bf16 a[28:31], a[196:199], v[252:255], a[28:31]
    v_cmp_nge_f32 s[66:67], s3, v10
    v_cmp_nge_f32 s[68:69], s3, v11
    v_cmp_nge_f32 s[70:71], s3, v12
    v_cmp_nge_f32 s[72:73], s3, v13
    v_rcp_f32 v10, v10
    v_rcp_f32 v11, v11
    v_rcp_f32 v12, v12
    v_rcp_f32 v13, v13
    s_or_b64 s[66:67], s[66:67], s[68:69]
    s_and_b64 s[72:73], s[72:73], s[50:51]
    s_or_b64 s[70:71], s[70:71], s[72:73]
    s_or_b64 s[66:67], s[66:67], s[70:71]
    s_cselect_b32 s3, 3, 1
    v_mov_b32 v1, s3
    s_waitcnt vmcnt(0)
    s_waitcnt lgkmcnt(8)
    v_mfma_f32_16x16x32_bf16 a[32:35], a[200:203], v[144:147], a[32:35]
    ds_read_b64_tr_b16 a[192:193], v22 offset:57344
    v_mfma_f32_16x16x32_bf16 a[48:51], a[204:207], v[144:147], a[48:51]
    ds_read_b64_tr_b16 a[194:195], v22 offset:61440
    v_mfma_f32_16x16x32_bf16 a[36:39], a[200:203], v[152:155], a[36:39]
    ds_read_b64_tr_b16 a[196:197], v23 offset:57344
    v_accvgpr_read_b32 v112, a0
    v_accvgpr_read_b32 v113, a1
    v_mfma_f32_16x16x32_bf16 a[52:55], a[204:207], v[152:155], a[52:55]
    ds_read_b64_tr_b16 a[198:199], v23 offset:61440
    v_accvgpr_read_b32 v114, a2
    v_accvgpr_read_b32 v115, a3
    v_mfma_f32_16x16x32_bf16 a[40:43], a[200:203], v[160:163], a[40:43]
    v_accvgpr_read_b32 v116, a16
    v_accvgpr_read_b32 v117, a17
    v_mfma_f32_16x16x32_bf16 a[56:59], a[204:207], v[160:163], a[56:59]
    v_accvgpr_read_b32 v118, a18
    v_accvgpr_read_b32 v119, a19
    v_mfma_f32_16x16x32_bf16 a[44:47], a[200:203], v[168:171], a[44:47]
    v_mul_f32 v112, v112, v10
    v_mul_f32 v113, v113, v10
    v_mfma_f32_16x16x32_bf16 a[60:63], a[204:207], v[168:171], a[60:63]
    v_mul_f32 v114, v114, v10
    s_waitcnt lgkmcnt(8)
    v_mfma_f32_16x16x32_bf16 a[32:35], a[208:211], v[148:151], a[32:35]
    ds_read_b64_tr_b16 a[200:201], v22 offset:32768
    v_mul_f32 v115, v115, v10
    v_mul_f32 v116, v116, v10
    v_mfma_f32_16x16x32_bf16 a[48:51], a[212:215], v[148:151], a[48:51]
    ds_read_b64_tr_b16 a[202:203], v22 offset:36864
    v_mul_f32 v117, v117, v10
    v_mul_f32 v118, v118, v10
    v_mfma_f32_16x16x32_bf16 a[36:39], a[208:211], v[156:159], a[36:39]
    ds_read_b64_tr_b16 a[204:205], v23 offset:32768
    v_mul_f32 v119, v119, v10
    v_cvt_pk_bf16_f32 v128, v112, v113
    v_mfma_f32_16x16x32_bf16 a[52:55], a[212:215], v[156:159], a[52:55]
    ds_read_b64_tr_b16 a[206:207], v23 offset:36864
    v_cvt_pk_bf16_f32 v129, v114, v115
    v_cvt_pk_bf16_f32 v130, v116, v117
    v_mfma_f32_16x16x32_bf16 a[40:43], a[208:211], v[164:167], a[40:43]
    v_cvt_pk_bf16_f32 v131, v118, v119
    buffer_store_dwordx4 v[128:131], v15, s[36:39], s44 offen offset:0 sc1
    v_mfma_f32_16x16x32_bf16 a[56:59], a[212:215], v[164:167], a[56:59]
    v_accvgpr_read_b32 v120, a4
    v_mfma_f32_16x16x32_bf16 a[44:47], a[208:211], v[172:175], a[44:47]
    v_accvgpr_read_b32 v121, a5
    v_accvgpr_read_b32 v122, a6
    v_mfma_f32_16x16x32_bf16 a[60:63], a[212:215], v[172:175], a[60:63]
    v_accvgpr_read_b32 v123, a7
    v_accvgpr_read_b32 v124, a20
    s_waitcnt lgkmcnt(8)
    v_mfma_f32_16x16x32_bf16 a[32:35], a[216:219], v[192:195], a[32:35]
    ds_read_b64_tr_b16 a[208:209], v22 offset:40960
    v_accvgpr_read_b32 v125, a21
    v_accvgpr_read_b32 v126, a22
    v_mfma_f32_16x16x32_bf16 a[48:51], a[220:223], v[192:195], a[48:51]
    ds_read_b64_tr_b16 a[210:211], v22 offset:45056
    v_accvgpr_read_b32 v127, a23
    v_mul_f32 v120, v120, v11
    v_mfma_f32_16x16x32_bf16 a[36:39], a[216:219], v[200:203], a[36:39]
    ds_read_b64_tr_b16 a[212:213], v23 offset:40960
    v_mul_f32 v121, v121, v11
    v_mul_f32 v122, v122, v11
    v_mfma_f32_16x16x32_bf16 a[52:55], a[220:223], v[200:203], a[52:55]
    ds_read_b64_tr_b16 a[214:215], v23 offset:45056
    v_mul_f32 v123, v123, v11
    v_mfma_f32_16x16x32_bf16 a[40:43], a[216:219], v[208:211], a[40:43]
    v_mul_f32 v124, v124, v11
    v_mul_f32 v125, v125, v11
    v_mfma_f32_16x16x32_bf16 a[56:59], a[220:223], v[208:211], a[56:59]
    v_mul_f32 v126, v126, v11
    v_mul_f32 v127, v127, v11
    v_mfma_f32_16x16x32_bf16 a[44:47], a[216:219], v[216:219], a[44:47]
    v_cvt_pk_bf16_f32 v132, v120, v121
    v_cvt_pk_bf16_f32 v133, v122, v123
    v_mfma_f32_16x16x32_bf16 a[60:63], a[220:223], v[216:219], a[60:63]
    v_cvt_pk_bf16_f32 v134, v124, v125
    v_cvt_pk_bf16_f32 v135, v126, v127
    s_waitcnt lgkmcnt(8)
    v_mfma_f32_16x16x32_bf16 a[32:35], a[192:195], v[196:199], a[32:35]
    ds_read_b64_tr_b16 a[216:217], v24 offset:16384
    buffer_store_dwordx4 v[132:135], v15, s[36:39], s44 offen offset:1024 sc1
    v_mfma_f32_16x16x32_bf16 a[48:51], a[196:199], v[196:199], a[48:51]
    ds_read_b64_tr_b16 a[218:219], v24 offset:20480
    v_accvgpr_read_b32 v112, a8
    v_accvgpr_read_b32 v113, a9
    v_mfma_f32_16x16x32_bf16 a[36:39], a[192:195], v[204:207], a[36:39]
    ds_read_b64_tr_b16 a[220:221], v25 offset:16384
    v_accvgpr_read_b32 v114, a10
    v_accvgpr_read_b32 v115, a11
    v_mfma_f32_16x16x32_bf16 a[52:55], a[196:199], v[204:207], a[52:55]
    ds_read_b64_tr_b16 a[222:223], v25 offset:20480
    v_accvgpr_read_b32 v116, a24
    v_accvgpr_read_b32 v117, a25
    v_mfma_f32_16x16x32_bf16 a[40:43], a[192:195], v[212:215], a[40:43]
    v_accvgpr_read_b32 v118, a26
    v_accvgpr_read_b32 v119, a27
    v_mfma_f32_16x16x32_bf16 a[56:59], a[196:199], v[212:215], a[56:59]
    v_mul_f32 v112, v112, v12
    v_mul_f32 v113, v113, v12
    v_mfma_f32_16x16x32_bf16 a[44:47], a[192:195], v[220:223], a[44:47]
    v_mul_f32 v114, v114, v12
    v_mfma_f32_16x16x32_bf16 a[60:63], a[196:199], v[220:223], a[60:63]
    v_mul_f32 v115, v115, v12
    v_mul_f32 v116, v116, v12
    s_waitcnt lgkmcnt(8)
    v_mfma_f32_16x16x32_bf16 a[32:35], a[200:203], v[224:227], a[32:35]
    ds_read_b64_tr_b16 a[192:193], v24 offset:24576
    v_mul_f32 v117, v117, v12
    v_mul_f32 v118, v118, v12
    v_mfma_f32_16x16x32_bf16 a[48:51], a[204:207], v[224:227], a[48:51]
    ds_read_b64_tr_b16 a[194:195], v24 offset:28672
    v_mul_f32 v119, v119, v12
    v_cvt_pk_bf16_f32 v136, v112, v113
    v_mfma_f32_16x16x32_bf16 a[36:39], a[200:203], v[232:235], a[36:39]
    ds_read_b64_tr_b16 a[196:197], v25 offset:24576
    v_cvt_pk_bf16_f32 v137, v114, v115
    v_cvt_pk_bf16_f32 v138, v116, v117
    v_mfma_f32_16x16x32_bf16 a[52:55], a[204:207], v[232:235], a[52:55]
    ds_read_b64_tr_b16 a[198:199], v25 offset:28672
    v_cvt_pk_bf16_f32 v139, v118, v119
    buffer_store_dwordx4 v[136:139], v15, s[36:39], s44 offen offset:2048 sc1
    v_mfma_f32_16x16x32_bf16 a[40:43], a[200:203], v[240:243], a[40:43]
    v_accvgpr_read_b32 v120, a12
    v_mfma_f32_16x16x32_bf16 a[56:59], a[204:207], v[240:243], a[56:59]
    v_accvgpr_read_b32 v121, a13
    v_accvgpr_read_b32 v122, a14
    v_mfma_f32_16x16x32_bf16 a[44:47], a[200:203], v[248:251], a[44:47]
    v_accvgpr_read_b32 v123, a15
    v_accvgpr_read_b32 v124, a28
    v_mfma_f32_16x16x32_bf16 a[60:63], a[204:207], v[248:251], a[60:63]
    v_accvgpr_read_b32 v125, a29
    v_accvgpr_read_b32 v126, a30
    s_waitcnt lgkmcnt(8)
    v_mfma_f32_16x16x32_bf16 a[32:35], a[208:211], v[228:231], a[32:35]
    ds_read_b64_tr_b16 a[200:201], v24 offset:49152
    v_accvgpr_read_b32 v127, a31
    v_mul_f32 v120, v120, v13
    v_mfma_f32_16x16x32_bf16 a[48:51], a[212:215], v[228:231], a[48:51]
    ds_read_b64_tr_b16 a[202:203], v24 offset:53248
    v_mul_f32 v121, v121, v13
    v_mul_f32 v122, v122, v13
    v_mfma_f32_16x16x32_bf16 a[36:39], a[208:211], v[236:239], a[36:39]
    ds_read_b64_tr_b16 a[204:205], v25 offset:49152
    v_mul_f32 v123, v123, v13
    v_mfma_f32_16x16x32_bf16 a[52:55], a[212:215], v[236:239], a[52:55]
    ds_read_b64_tr_b16 a[206:207], v25 offset:53248
    v_mul_f32 v124, v124, v13
    v_mul_f32 v125, v125, v13
    v_mfma_f32_16x16x32_bf16 a[40:43], a[208:211], v[244:247], a[40:43]
    v_mul_f32 v126, v126, v13
    v_mul_f32 v127, v127, v13
    v_mfma_f32_16x16x32_bf16 a[56:59], a[212:215], v[244:247], a[56:59]
    v_cvt_pk_bf16_f32 v140, v120, v121
    v_cvt_pk_bf16_f32 v141, v122, v123
    v_mfma_f32_16x16x32_bf16 a[44:47], a[208:211], v[252:255], a[44:47]
    v_cvt_pk_bf16_f32 v142, v124, v125
    v_cvt_pk_bf16_f32 v143, v126, v127
    v_mfma_f32_16x16x32_bf16 a[60:63], a[212:215], v[252:255], a[60:63]
    buffer_store_dwordx4 v[140:143], v15, s[56:59], s44 offen offset:3072 sc1
    s_waitcnt lgkmcnt(8)
    v_mfma_f32_16x16x32_bf16 a[64:67], a[216:219], v[144:147], a[64:67]
    ds_read_b64_tr_b16 a[208:209], v24 offset:57344
    v_mfma_f32_16x16x32_bf16 a[80:83], a[220:223], v[144:147], a[80:83]
    ds_read_b64_tr_b16 a[210:211], v24 offset:61440
    v_mfma_f32_16x16x32_bf16 a[68:71], a[216:219], v[152:155], a[68:71]
    ds_read_b64_tr_b16 a[212:213], v25 offset:57344
    v_accvgpr_read_b32 v112, a32
    v_accvgpr_read_b32 v113, a33
    v_mfma_f32_16x16x32_bf16 a[84:87], a[220:223], v[152:155], a[84:87]
    ds_read_b64_tr_b16 a[214:215], v25 offset:61440
    v_accvgpr_read_b32 v114, a34
    v_accvgpr_read_b32 v115, a35
    v_mfma_f32_16x16x32_bf16 a[72:75], a[216:219], v[160:163], a[72:75]
    v_accvgpr_read_b32 v116, a48
    v_accvgpr_read_b32 v117, a49
    v_mfma_f32_16x16x32_bf16 a[88:91], a[220:223], v[160:163], a[88:91]
    v_accvgpr_read_b32 v118, a50
    v_accvgpr_read_b32 v119, a51
    v_mfma_f32_16x16x32_bf16 a[76:79], a[216:219], v[168:171], a[76:79]
    v_mul_f32 v112, v112, v10
    v_mul_f32 v113, v113, v10
    v_mfma_f32_16x16x32_bf16 a[92:95], a[220:223], v[168:171], a[92:95]
    v_mul_f32 v114, v114, v10
    s_waitcnt lgkmcnt(8)
    v_mfma_f32_16x16x32_bf16 a[64:67], a[192:195], v[148:151], a[64:67]
    ds_read_b64_tr_b16 a[216:217], v24 offset:32768
    v_mul_f32 v115, v115, v10
    v_mul_f32 v116, v116, v10
    v_mfma_f32_16x16x32_bf16 a[80:83], a[196:199], v[148:151], a[80:83]
    ds_read_b64_tr_b16 a[218:219], v24 offset:36864
    v_mul_f32 v117, v117, v10
    v_mul_f32 v118, v118, v10
    v_mfma_f32_16x16x32_bf16 a[68:71], a[192:195], v[156:159], a[68:71]
    ds_read_b64_tr_b16 a[220:221], v25 offset:32768
    v_mul_f32 v119, v119, v10
    v_cvt_pk_bf16_f32 v128, v112, v113
    v_mfma_f32_16x16x32_bf16 a[84:87], a[196:199], v[156:159], a[84:87]
    ds_read_b64_tr_b16 a[222:223], v25 offset:36864
    v_cvt_pk_bf16_f32 v129, v114, v115
    v_cvt_pk_bf16_f32 v130, v116, v117
    v_mfma_f32_16x16x32_bf16 a[72:75], a[192:195], v[164:167], a[72:75]
    v_cvt_pk_bf16_f32 v131, v118, v119
    buffer_store_dwordx4 v[128:131], v15, s[36:39], s45 offen offset:0 sc1
    v_mfma_f32_16x16x32_bf16 a[88:91], a[196:199], v[164:167], a[88:91]
    v_accvgpr_read_b32 v120, a36
    v_mfma_f32_16x16x32_bf16 a[76:79], a[192:195], v[172:175], a[76:79]
    v_accvgpr_read_b32 v121, a37
    v_accvgpr_read_b32 v122, a38
    v_mfma_f32_16x16x32_bf16 a[92:95], a[196:199], v[172:175], a[92:95]
    v_accvgpr_read_b32 v123, a39
    v_accvgpr_read_b32 v124, a52
    s_waitcnt lgkmcnt(8)
    v_mfma_f32_16x16x32_bf16 a[64:67], a[200:203], v[192:195], a[64:67]
    ds_read_b64_tr_b16 a[192:193], v24 offset:40960
    v_accvgpr_read_b32 v125, a53
    v_accvgpr_read_b32 v126, a54
    v_mfma_f32_16x16x32_bf16 a[80:83], a[204:207], v[192:195], a[80:83]
    ds_read_b64_tr_b16 a[194:195], v24 offset:45056
    v_accvgpr_read_b32 v127, a55
    v_mul_f32 v120, v120, v11
    v_mfma_f32_16x16x32_bf16 a[68:71], a[200:203], v[200:203], a[68:71]
    ds_read_b64_tr_b16 a[196:197], v25 offset:40960
    v_mul_f32 v121, v121, v11
    v_mul_f32 v122, v122, v11
    v_mfma_f32_16x16x32_bf16 a[84:87], a[204:207], v[200:203], a[84:87]
    ds_read_b64_tr_b16 a[198:199], v25 offset:45056
    v_mul_f32 v123, v123, v11
    v_mfma_f32_16x16x32_bf16 a[72:75], a[200:203], v[208:211], a[72:75]
    v_mul_f32 v124, v124, v11
    v_mul_f32 v125, v125, v11
    v_mfma_f32_16x16x32_bf16 a[88:91], a[204:207], v[208:211], a[88:91]
    v_mul_f32 v126, v126, v11
    v_mul_f32 v127, v127, v11
    v_mfma_f32_16x16x32_bf16 a[76:79], a[200:203], v[216:219], a[76:79]
    v_cvt_pk_bf16_f32 v132, v120, v121
    v_cvt_pk_bf16_f32 v133, v122, v123
    v_mfma_f32_16x16x32_bf16 a[92:95], a[204:207], v[216:219], a[92:95]
    v_cvt_pk_bf16_f32 v134, v124, v125
    v_cvt_pk_bf16_f32 v135, v126, v127
    s_waitcnt lgkmcnt(8)
    v_mfma_f32_16x16x32_bf16 a[64:67], a[208:211], v[196:199], a[64:67]
    ds_read_b64_tr_b16 a[200:201], v26 offset:16384
    buffer_store_dwordx4 v[132:135], v15, s[36:39], s45 offen offset:1024 sc1
    v_mfma_f32_16x16x32_bf16 a[80:83], a[212:215], v[196:199], a[80:83]
    ds_read_b64_tr_b16 a[202:203], v26 offset:20480
    v_accvgpr_read_b32 v112, a40
    v_accvgpr_read_b32 v113, a41
    v_mfma_f32_16x16x32_bf16 a[68:71], a[208:211], v[204:207], a[68:71]
    ds_read_b64_tr_b16 a[204:205], v27 offset:16384
    v_accvgpr_read_b32 v114, a42
    v_accvgpr_read_b32 v115, a43
    v_mfma_f32_16x16x32_bf16 a[84:87], a[212:215], v[204:207], a[84:87]
    ds_read_b64_tr_b16 a[206:207], v27 offset:20480
    v_accvgpr_read_b32 v116, a56
    v_accvgpr_read_b32 v117, a57
    v_mfma_f32_16x16x32_bf16 a[72:75], a[208:211], v[212:215], a[72:75]
    v_accvgpr_read_b32 v118, a58
    v_accvgpr_read_b32 v119, a59
    v_mfma_f32_16x16x32_bf16 a[88:91], a[212:215], v[212:215], a[88:91]
    v_mul_f32 v112, v112, v12
    v_mul_f32 v113, v113, v12
    v_mfma_f32_16x16x32_bf16 a[76:79], a[208:211], v[220:223], a[76:79]
    v_mul_f32 v114, v114, v12
    v_mfma_f32_16x16x32_bf16 a[92:95], a[212:215], v[220:223], a[92:95]
    v_mul_f32 v115, v115, v12
    v_mul_f32 v116, v116, v12
    s_waitcnt lgkmcnt(8)
    v_mfma_f32_16x16x32_bf16 a[64:67], a[216:219], v[224:227], a[64:67]
    ds_read_b64_tr_b16 a[208:209], v26 offset:24576
    v_mul_f32 v117, v117, v12
    v_mul_f32 v118, v118, v12
    v_mfma_f32_16x16x32_bf16 a[80:83], a[220:223], v[224:227], a[80:83]
    ds_read_b64_tr_b16 a[210:211], v26 offset:28672
    v_mul_f32 v119, v119, v12
    v_cvt_pk_bf16_f32 v136, v112, v113
    v_mfma_f32_16x16x32_bf16 a[68:71], a[216:219], v[232:235], a[68:71]
    ds_read_b64_tr_b16 a[212:213], v27 offset:24576
    v_cvt_pk_bf16_f32 v137, v114, v115
    v_cvt_pk_bf16_f32 v138, v116, v117
    v_mfma_f32_16x16x32_bf16 a[84:87], a[220:223], v[232:235], a[84:87]
    ds_read_b64_tr_b16 a[214:215], v27 offset:28672
    v_cvt_pk_bf16_f32 v139, v118, v119
    buffer_store_dwordx4 v[136:139], v15, s[36:39], s45 offen offset:2048 sc1
    v_mfma_f32_16x16x32_bf16 a[72:75], a[216:219], v[240:243], a[72:75]
    v_accvgpr_read_b32 v120, a44
    v_mfma_f32_16x16x32_bf16 a[88:91], a[220:223], v[240:243], a[88:91]
    v_accvgpr_read_b32 v121, a45
    v_accvgpr_read_b32 v122, a46
    v_mfma_f32_16x16x32_bf16 a[76:79], a[216:219], v[248:251], a[76:79]
    v_accvgpr_read_b32 v123, a47
    v_accvgpr_read_b32 v124, a60
    v_mfma_f32_16x16x32_bf16 a[92:95], a[220:223], v[248:251], a[92:95]
    v_accvgpr_read_b32 v125, a61
    v_accvgpr_read_b32 v126, a62
    s_waitcnt lgkmcnt(8)
    v_mfma_f32_16x16x32_bf16 a[64:67], a[192:195], v[228:231], a[64:67]
    ds_read_b64_tr_b16 a[216:217], v26 offset:49152
    v_accvgpr_read_b32 v127, a63
    v_mul_f32 v120, v120, v13
    v_mfma_f32_16x16x32_bf16 a[80:83], a[196:199], v[228:231], a[80:83]
    ds_read_b64_tr_b16 a[218:219], v26 offset:53248
    v_mul_f32 v121, v121, v13
    v_mul_f32 v122, v122, v13
    v_mfma_f32_16x16x32_bf16 a[68:71], a[192:195], v[236:239], a[68:71]
    ds_read_b64_tr_b16 a[220:221], v27 offset:49152
    v_mul_f32 v123, v123, v13
    v_mfma_f32_16x16x32_bf16 a[84:87], a[196:199], v[236:239], a[84:87]
    ds_read_b64_tr_b16 a[222:223], v27 offset:53248
    v_mul_f32 v124, v124, v13
    v_mul_f32 v125, v125, v13
    v_mfma_f32_16x16x32_bf16 a[72:75], a[192:195], v[244:247], a[72:75]
    v_mul_f32 v126, v126, v13
    v_mul_f32 v127, v127, v13
    v_mfma_f32_16x16x32_bf16 a[88:91], a[196:199], v[244:247], a[88:91]
    v_cvt_pk_bf16_f32 v140, v120, v121
    v_cvt_pk_bf16_f32 v141, v122, v123
    v_mfma_f32_16x16x32_bf16 a[76:79], a[192:195], v[252:255], a[76:79]
    v_cvt_pk_bf16_f32 v142, v124, v125
    v_cvt_pk_bf16_f32 v143, v126, v127
    v_mfma_f32_16x16x32_bf16 a[92:95], a[196:199], v[252:255], a[92:95]
    buffer_store_dwordx4 v[140:143], v15, s[56:59], s45 offen offset:3072 sc1
    s_waitcnt lgkmcnt(8)
    v_mfma_f32_16x16x32_bf16 a[96:99], a[200:203], v[144:147], a[96:99]
    ds_read_b64_tr_b16 a[192:193], v26 offset:57344
    v_mfma_f32_16x16x32_bf16 a[112:115], a[204:207], v[144:147], a[112:115]
    ds_read_b64_tr_b16 a[194:195], v26 offset:61440
    v_mfma_f32_16x16x32_bf16 a[100:103], a[200:203], v[152:155], a[100:103]
    ds_read_b64_tr_b16 a[196:197], v27 offset:57344
    v_accvgpr_read_b32 v112, a64
    v_accvgpr_read_b32 v113, a65
    v_mfma_f32_16x16x32_bf16 a[116:119], a[204:207], v[152:155], a[116:119]
    ds_read_b64_tr_b16 a[198:199], v27 offset:61440
    v_accvgpr_read_b32 v114, a66
    v_accvgpr_read_b32 v115, a67
    v_mfma_f32_16x16x32_bf16 a[104:107], a[200:203], v[160:163], a[104:107]
    v_accvgpr_read_b32 v116, a80
    v_accvgpr_read_b32 v117, a81
    v_mfma_f32_16x16x32_bf16 a[120:123], a[204:207], v[160:163], a[120:123]
    v_accvgpr_read_b32 v118, a82
    v_accvgpr_read_b32 v119, a83
    v_mfma_f32_16x16x32_bf16 a[108:111], a[200:203], v[168:171], a[108:111]
    v_mul_f32 v112, v112, v10
    v_mul_f32 v113, v113, v10
    v_mfma_f32_16x16x32_bf16 a[124:127], a[204:207], v[168:171], a[124:127]
    v_mul_f32 v114, v114, v10
    s_waitcnt lgkmcnt(8)
    v_mfma_f32_16x16x32_bf16 a[96:99], a[208:211], v[148:151], a[96:99]
    ds_read_b64_tr_b16 a[200:201], v26 offset:32768
    v_mul_f32 v115, v115, v10
    v_mul_f32 v116, v116, v10
    v_mfma_f32_16x16x32_bf16 a[112:115], a[212:215], v[148:151], a[112:115]
    ds_read_b64_tr_b16 a[202:203], v26 offset:36864
    v_mul_f32 v117, v117, v10
    v_mul_f32 v118, v118, v10
    v_mfma_f32_16x16x32_bf16 a[100:103], a[208:211], v[156:159], a[100:103]
    ds_read_b64_tr_b16 a[204:205], v27 offset:32768
    v_mul_f32 v119, v119, v10
    v_cvt_pk_bf16_f32 v128, v112, v113
    v_mfma_f32_16x16x32_bf16 a[116:119], a[212:215], v[156:159], a[116:119]
    ds_read_b64_tr_b16 a[206:207], v27 offset:36864
    v_cvt_pk_bf16_f32 v129, v114, v115
    v_cvt_pk_bf16_f32 v130, v116, v117
    v_mfma_f32_16x16x32_bf16 a[104:107], a[208:211], v[164:167], a[104:107]
    v_cvt_pk_bf16_f32 v131, v118, v119
    buffer_store_dwordx4 v[128:131], v15, s[36:39], s46 offen offset:0 sc1
    v_mfma_f32_16x16x32_bf16 a[120:123], a[212:215], v[164:167], a[120:123]
    v_accvgpr_read_b32 v120, a68
    v_mfma_f32_16x16x32_bf16 a[108:111], a[208:211], v[172:175], a[108:111]
    v_accvgpr_read_b32 v121, a69
    v_accvgpr_read_b32 v122, a70
    v_mfma_f32_16x16x32_bf16 a[124:127], a[212:215], v[172:175], a[124:127]
    v_accvgpr_read_b32 v123, a71
    v_accvgpr_read_b32 v124, a84
    s_waitcnt lgkmcnt(8)
    v_mfma_f32_16x16x32_bf16 a[96:99], a[216:219], v[192:195], a[96:99]
    ds_read_b64_tr_b16 a[208:209], v26 offset:40960
    v_accvgpr_read_b32 v125, a85
    v_accvgpr_read_b32 v126, a86
    v_mfma_f32_16x16x32_bf16 a[112:115], a[220:223], v[192:195], a[112:115]
    ds_read_b64_tr_b16 a[210:211], v26 offset:45056
    v_accvgpr_read_b32 v127, a87
    v_mul_f32 v120, v120, v11
    v_mfma_f32_16x16x32_bf16 a[100:103], a[216:219], v[200:203], a[100:103]
    ds_read_b64_tr_b16 a[212:213], v27 offset:40960
    v_mul_f32 v121, v121, v11
    v_mul_f32 v122, v122, v11
    v_mfma_f32_16x16x32_bf16 a[116:119], a[220:223], v[200:203], a[116:119]
    ds_read_b64_tr_b16 a[214:215], v27 offset:45056
    v_mul_f32 v123, v123, v11
    v_mfma_f32_16x16x32_bf16 a[104:107], a[216:219], v[208:211], a[104:107]
    v_mul_f32 v124, v124, v11
    v_mul_f32 v125, v125, v11
    v_mfma_f32_16x16x32_bf16 a[120:123], a[220:223], v[208:211], a[120:123]
    v_mul_f32 v126, v126, v11
    v_mul_f32 v127, v127, v11
    v_mfma_f32_16x16x32_bf16 a[108:111], a[216:219], v[216:219], a[108:111]
    v_cvt_pk_bf16_f32 v132, v120, v121
    v_cvt_pk_bf16_f32 v133, v122, v123
    v_mfma_f32_16x16x32_bf16 a[124:127], a[220:223], v[216:219], a[124:127]
    v_cvt_pk_bf16_f32 v134, v124, v125
    v_cvt_pk_bf16_f32 v135, v126, v127
    s_waitcnt lgkmcnt(8)
    v_mfma_f32_16x16x32_bf16 a[96:99], a[192:195], v[196:199], a[96:99]
    buffer_store_dwordx4 v[132:135], v15, s[36:39], s46 offen offset:1024 sc1
    v_mfma_f32_16x16x32_bf16 a[112:115], a[196:199], v[196:199], a[112:115]
    v_accvgpr_read_b32 v112, a72
    v_accvgpr_read_b32 v113, a73
    v_mfma_f32_16x16x32_bf16 a[100:103], a[192:195], v[204:207], a[100:103]
    v_accvgpr_read_b32 v114, a74
    v_accvgpr_read_b32 v115, a75
    v_mfma_f32_16x16x32_bf16 a[116:119], a[196:199], v[204:207], a[116:119]
    v_accvgpr_read_b32 v116, a88
    v_accvgpr_read_b32 v117, a89
    v_mfma_f32_16x16x32_bf16 a[104:107], a[192:195], v[212:215], a[104:107]
    v_accvgpr_read_b32 v118, a90
    v_accvgpr_read_b32 v119, a91
    v_mfma_f32_16x16x32_bf16 a[120:123], a[196:199], v[212:215], a[120:123]
    v_mul_f32 v112, v112, v12
    v_mul_f32 v113, v113, v12
    v_mfma_f32_16x16x32_bf16 a[108:111], a[192:195], v[220:223], a[108:111]
    v_mul_f32 v114, v114, v12
    v_mfma_f32_16x16x32_bf16 a[124:127], a[196:199], v[220:223], a[124:127]
    v_mul_f32 v115, v115, v12
    v_mul_f32 v116, v116, v12
    s_waitcnt lgkmcnt(4)
    v_mfma_f32_16x16x32_bf16 a[96:99], a[200:203], v[224:227], a[96:99]
    v_mul_f32 v117, v117, v12
    v_mul_f32 v118, v118, v12
    v_mfma_f32_16x16x32_bf16 a[112:115], a[204:207], v[224:227], a[112:115]
    v_mul_f32 v119, v119, v12
    v_cvt_pk_bf16_f32 v136, v112, v113
    v_mfma_f32_16x16x32_bf16 a[100:103], a[200:203], v[232:235], a[100:103]
    v_cvt_pk_bf16_f32 v137, v114, v115
    v_cvt_pk_bf16_f32 v138, v116, v117
    v_mfma_f32_16x16x32_bf16 a[116:119], a[204:207], v[232:235], a[116:119]
    v_cvt_pk_bf16_f32 v139, v118, v119
    buffer_store_dwordx4 v[136:139], v15, s[36:39], s46 offen offset:2048 sc1
    v_mfma_f32_16x16x32_bf16 a[104:107], a[200:203], v[240:243], a[104:107]
    v_accvgpr_read_b32 v120, a76
    v_mfma_f32_16x16x32_bf16 a[120:123], a[204:207], v[240:243], a[120:123]
    v_accvgpr_read_b32 v121, a77
    v_accvgpr_read_b32 v122, a78
    v_mfma_f32_16x16x32_bf16 a[108:111], a[200:203], v[248:251], a[108:111]
    v_accvgpr_read_b32 v123, a79
    v_accvgpr_read_b32 v124, a92
    v_mfma_f32_16x16x32_bf16 a[124:127], a[204:207], v[248:251], a[124:127]
    v_accvgpr_read_b32 v125, a93
    v_accvgpr_read_b32 v126, a94
    s_waitcnt lgkmcnt(0)
    ds_write_b32 v9, v1
    v_mfma_f32_16x16x32_bf16 a[96:99], a[208:211], v[228:231], a[96:99]
    v_accvgpr_read_b32 v127, a95
    v_mul_f32 v120, v120, v13
    v_mfma_f32_16x16x32_bf16 a[112:115], a[212:215], v[228:231], a[112:115]
    v_mul_f32 v121, v121, v13
    v_mul_f32 v122, v122, v13
    v_mfma_f32_16x16x32_bf16 a[100:103], a[208:211], v[236:239], a[100:103]
    v_mul_f32 v123, v123, v13
    v_mfma_f32_16x16x32_bf16 a[116:119], a[212:215], v[236:239], a[116:119]
    v_mul_f32 v124, v124, v13
    v_mul_f32 v125, v125, v13
    v_mfma_f32_16x16x32_bf16 a[104:107], a[208:211], v[244:247], a[104:107]
    v_mul_f32 v126, v126, v13
    v_mul_f32 v127, v127, v13
    v_mfma_f32_16x16x32_bf16 a[120:123], a[212:215], v[244:247], a[120:123]
    v_cvt_pk_bf16_f32 v140, v120, v121
    v_cvt_pk_bf16_f32 v141, v122, v123
    v_mfma_f32_16x16x32_bf16 a[108:111], a[208:211], v[252:255], a[108:111]
    v_cvt_pk_bf16_f32 v142, v124, v125
    v_cvt_pk_bf16_f32 v143, v126, v127
    v_mfma_f32_16x16x32_bf16 a[124:127], a[212:215], v[252:255], a[124:127]
    buffer_store_dwordx4 v[140:143], v15, s[56:59], s46 offen offset:3072 sc1
    s_nop 3
    v_accvgpr_read_b32 v112, a96
    v_accvgpr_read_b32 v113, a97
    v_accvgpr_read_b32 v114, a98
    v_accvgpr_read_b32 v115, a99
    v_accvgpr_read_b32 v116, a112
    v_accvgpr_read_b32 v117, a113
    v_accvgpr_read_b32 v118, a114
    v_accvgpr_read_b32 v119, a115
    v_mul_f32 v112, v112, v10
    v_mul_f32 v113, v113, v10
    v_mul_f32 v114, v114, v10
    v_mul_f32 v115, v115, v10
    v_mul_f32 v116, v116, v10
    v_mul_f32 v117, v117, v10
    v_mul_f32 v118, v118, v10
    v_mul_f32 v119, v119, v10
    v_cvt_pk_bf16_f32 v128, v112, v113
    v_cvt_pk_bf16_f32 v129, v114, v115
    v_cvt_pk_bf16_f32 v130, v116, v117
    v_cvt_pk_bf16_f32 v131, v118, v119
    buffer_store_dwordx4 v[128:131], v15, s[36:39], s47 offen offset:0 sc1
    v_accvgpr_read_b32 v120, a100
    v_accvgpr_read_b32 v121, a101
    v_accvgpr_read_b32 v122, a102
    v_accvgpr_read_b32 v123, a103
    v_accvgpr_read_b32 v124, a116
    v_accvgpr_read_b32 v125, a117
    v_accvgpr_read_b32 v126, a118
    v_accvgpr_read_b32 v127, a119
    v_mul_f32 v120, v120, v11
    v_mul_f32 v121, v121, v11
    v_mul_f32 v122, v122, v11
    v_mul_f32 v123, v123, v11
    v_mul_f32 v124, v124, v11
    v_mul_f32 v125, v125, v11
    v_mul_f32 v126, v126, v11
    v_mul_f32 v127, v127, v11
    v_cvt_pk_bf16_f32 v132, v120, v121
    v_cvt_pk_bf16_f32 v133, v122, v123
    v_cvt_pk_bf16_f32 v134, v124, v125
    v_cvt_pk_bf16_f32 v135, v126, v127
    buffer_store_dwordx4 v[132:135], v15, s[36:39], s47 offen offset:1024 sc1
    v_accvgpr_read_b32 v112, a104
    v_accvgpr_read_b32 v113, a105
    v_accvgpr_read_b32 v114, a106
    v_accvgpr_read_b32 v115, a107
    v_accvgpr_read_b32 v116, a120
    v_accvgpr_read_b32 v117, a121
    v_accvgpr_read_b32 v118, a122
    v_accvgpr_read_b32 v119, a123
    v_mul_f32 v112, v112, v12
    v_mul_f32 v113, v113, v12
    v_mul_f32 v114, v114, v12
    v_mul_f32 v115, v115, v12
    v_mul_f32 v116, v116, v12
    v_mul_f32 v117, v117, v12
    v_mul_f32 v118, v118, v12
    v_mul_f32 v119, v119, v12
    v_cvt_pk_bf16_f32 v136, v112, v113
    v_cvt_pk_bf16_f32 v137, v114, v115
    v_cvt_pk_bf16_f32 v138, v116, v117
    v_cvt_pk_bf16_f32 v139, v118, v119
    buffer_store_dwordx4 v[136:139], v15, s[36:39], s47 offen offset:2048 sc1
    s_cmp_eq_u32 s40, 3
    s_cbranch_scc1 L_stored
    v_accvgpr_read_b32 v120, a108
    v_accvgpr_read_b32 v121, a109
    v_accvgpr_read_b32 v122, a110
    v_accvgpr_read_b32 v123, a111
    v_accvgpr_read_b32 v124, a124
    v_accvgpr_read_b32 v125, a125
    v_accvgpr_read_b32 v126, a126
    v_accvgpr_read_b32 v127, a127
    v_mul_f32 v120, v120, v13
    v_mul_f32 v121, v121, v13
    v_mul_f32 v122, v122, v13
    v_mul_f32 v123, v123, v13
    v_mul_f32 v124, v124, v13
    v_mul_f32 v125, v125, v13
    v_mul_f32 v126, v126, v13
    v_mul_f32 v127, v127, v13
    v_cvt_pk_bf16_f32 v140, v120, v121
    v_cvt_pk_bf16_f32 v141, v122, v123
    v_cvt_pk_bf16_f32 v142, v124, v125
    v_cvt_pk_bf16_f32 v143, v126, v127
    buffer_store_dwordx4 v[140:143], v15, s[56:59], s47 offen offset:3072 sc1
L_stored:
    s_lshl_b32 s69, s40, 11
    s_lshl_b32 s65, s40, 13
    v_add_u32 v40, s65, v46
    s_add_u32 s65, s65, 3072
    v_add_u32 v41, s65, v47
    v_readfirstlane_b32 s67, v45
    v_lshl_add_u32 v14, v6, 2, v14
L_verdict:
    ds_read_b32 v1, v14
    s_waitcnt lgkmcnt(0)
    v_cmp_eq_u32 vcc, 0, v1
    s_add_u32 s49, s49, 1
    s_cmp_ge_u32 s49, 0x80000
    s_cbranch_scc1 L_end
    s_cbranch_vccnz L_verdict
    v_cmp_eq_u32 vcc, 3, v1
    s_cmp_lg_u32 s62, 0
    s_cbranch_scc1 L_accept
    s_cbranch_vccnz L_fallback
L_accept:
    s_add_u32 m0, s69, 81920
    s_add_u32 s65, s98, 131072
    buffer_load_dwordx4 v40, s[80:83], s65 offen offset:0 lds
    buffer_load_dwordx4 v41, s[80:83], s65 offen offset:1024 lds
    s_add_u32 m0, s69, 90112
    s_add_u32 s65, s98, 655360
    buffer_load_dwordx4 v40, s[80:83], s65 offen offset:0 lds
    buffer_load_dwordx4 v41, s[80:83], s65 offen offset:1024 lds
    s_add_u32 m0, s69, 114688
    s_add_u32 s65, s99, 131072
    buffer_load_dwordx4 v40, s[80:83], s65 offen offset:0 lds
    buffer_load_dwordx4 v41, s[80:83], s65 offen offset:1024 lds
    s_add_u32 m0, s69, 122880
    s_add_u32 s65, s99, 655360
    buffer_load_dwordx4 v40, s[80:83], s65 offen offset:0 lds
    buffer_load_dwordx4 v41, s[80:83], s65 offen offset:1024 lds
    s_add_u32 m0, s69, 98304
    s_add_u32 s65, s96, 262144
    buffer_load_dwordx4 v40, s[80:83], s65 offen offset:0 lds
    buffer_load_dwordx4 v41, s[80:83], s65 offen offset:1024 lds
    s_add_u32 m0, s69, 106496
    s_add_u32 s65, s96, 786432
    buffer_load_dwordx4 v40, s[80:83], s65 offen offset:0 lds
    buffer_load_dwordx4 v41, s[80:83], s65 offen offset:1024 lds
    v_lshl_add_u32 v11, v3, 2, v5
    v_and_b32 v12, 7, v11
    v_lshlrev_b32 v13, 3, v6
    v_lshl_add_u32 v11, v11, 8, v13
    s_lshr_b32 s65, s40, 1
    s_lshl_b32 s65, s65, 13
    v_add_u32 v11, s65, v11
    s_lshl_b32 s66, s93, 1
    s_add_u32 s3, s66, 0
    s_and_b32 s3, s3, 7
    v_xor_b32 v9, s3, v12
    v_lshl_add_u32 v16, v9, 5, v11
    v_add_u32 v24, 0x10000, v16
    v_add_u32 v32, 0x20000, v16
    s_add_u32 s3, s66, 1
    s_and_b32 s3, s3, 7
    v_xor_b32 v9, s3, v12
    v_lshl_add_u32 v17, v9, 5, v11
    v_add_u32 v25, 0x10000, v17
    v_add_u32 v33, 0x20000, v17
    s_add_u32 s3, s66, 2
    s_and_b32 s3, s3, 7
    v_xor_b32 v9, s3, v12
    v_lshl_add_u32 v18, v9, 5, v11
    v_add_u32 v26, 0x10000, v18
    v_add_u32 v34, 0x20000, v18
    s_add_u32 s3, s66, 3
    s_and_b32 s3, s3, 7
    v_xor_b32 v9, s3, v12
    v_lshl_add_u32 v19, v9, 5, v11
    v_add_u32 v27, 0x10000, v19
    v_add_u32 v35, 0x20000, v19
    s_add_u32 s3, s66, 4
    s_and_b32 s3, s3, 7
    v_xor_b32 v9, s3, v12
    v_lshl_add_u32 v20, v9, 5, v11
    v_add_u32 v28, 0x10000, v20
    v_add_u32 v36, 0x20000, v20
    s_add_u32 s3, s66, 5
    s_and_b32 s3, s3, 7
    v_xor_b32 v9, s3, v12
    v_lshl_add_u32 v21, v9, 5, v11
    v_add_u32 v29, 0x10000, v21
    v_add_u32 v37, 0x20000, v21
    s_add_u32 s3, s66, 6
    s_and_b32 s3, s3, 7
    v_xor_b32 v9, s3, v12
    v_lshl_add_u32 v22, v9, 5, v11
    v_add_u32 v30, 0x10000, v22
    v_add_u32 v38, 0x20000, v22
    s_add_u32 s3, s66, 7
    s_and_b32 s3, s3, 7
    v_xor_b32 v9, s3, v12
    v_lshl_add_u32 v23, v9, 5, v11
    v_add_u32 v31, 0x10000, v23
    v_add_u32 v39, 0x20000, v23
    ds_read_b64_tr_b16 a[0:1], v32 offset:0
    ds_read_b64_tr_b16 a[2:3], v32 offset:4096
    ds_read_b64_tr_b16 a[4:5], v33 offset:0
    ds_read_b64_tr_b16 a[6:7], v33 offset:4096
    ds_read_b64_tr_b16 a[8:9], v34 offset:0
    ds_read_b64_tr_b16 a[10:11], v34 offset:4096
    ds_read_b64_tr_b16 a[12:13], v35 offset:0
    ds_read_b64_tr_b16 a[14:15], v35 offset:4096
    ds_read_b64_tr_b16 a[16:17], v36 offset:0
    ds_read_b64_tr_b16 a[18:19], v36 offset:4096
    ds_read_b64_tr_b16 a[20:21], v37 offset:0
    ds_read_b64_tr_b16 a[22:23], v37 offset:4096
    ds_read_b64_tr_b16 a[24:25], v38 offset:0
    ds_read_b64_tr_b16 a[26:27], v38 offset:4096
    ds_read_b64_tr_b16 a[28:29], v39 offset:0
    ds_read_b64_tr_b16 a[30:31], v39 offset:4096
    ds_read_b64_tr_b16 a[32:33], v16 offset:0
    ds_read_b64_tr_b16 a[34:35], v16 offset:4096
    ds_read_b64_tr_b16 a[36:37], v17 offset:0
    ds_read_b64_tr_b16 a[38:39], v17 offset:4096
    ds_read_b64_tr_b16 a[40:41], v18 offset:0
    ds_read_b64_tr_b16 a[42:43], v18 offset:4096
    ds_read_b64_tr_b16 a[44:45], v19 offset:0
    ds_read_b64_tr_b16 a[46:47], v19 offset:4096
    ds_read_b64_tr_b16 a[48:49], v20 offset:0
    ds_read_b64_tr_b16 a[50:51], v20 offset:4096
    ds_read_b64_tr_b16 a[52:53], v21 offset:0
    ds_read_b64_tr_b16 a[54:55], v21 offset:4096
    ds_read_b64_tr_b16 a[56:57], v22 offset:0
    ds_read_b64_tr_b16 a[58:59], v22 offset:4096
    ds_read_b64_tr_b16 a[60:61], v23 offset:0
    ds_read_b64_tr_b16 a[62:63], v23 offset:4096
    s_lshl_b32 s3, s41, 2
    s_add_u32 s65, s3, s40
    s_lshl_b32 s65, s65, 5
    s_add_u32 s65, s65, s42
    s_lshl_b32 s68, s65, 7
    s_and_b32 s65, s40, 1
    s_add_u32 s3, s3, s65
    s_lshl_b32 s65, s95, 1
    s_add_u32 s3, s3, s65
    s_lshl_b32 s3, s3, 2
    s_add_u32 s3, s3, s93
    s_lshl_b32 s3, s3, 1
    s_lshr_b32 s65, s40, 1
    s_add_u32 s3, s3, s65
    s_lshl_b32 s75, s3, 9
    s_lshl_b32 s3, s3, 16
    s_add_u32 s70, s18, s3
    s_addc_u32 s71, s19, 0
    s_mul_i32 s3, s41, 245760
    s_add_u32 s14, s14, s3
    s_addc_u32 s15, s15, 0
    v_mov_b32 v10, 0
    v_lshlrev_b32 v9, 7, v6

    s_mov_b32 s28, s70
    s_mov_b32 s29, s71
    s_mov_b32 s30, 65536
    s_mov_b32 s31, 0x20000
    s_mov_b32 s20, s14
    s_mov_b32 s21, s15
    s_mov_b32 s22, 245760
    s_mov_b32 s23, 0x20000
    s_and_b32 s3, s40, s95
    s_mov_b32 s56, s70
    s_mov_b32 s57, s71
    s_cselect_b32 s58, 0, 65536
    s_lshr_b32 s52, s96, 3
    s_lshr_b32 s53, s97, 3
    s_lshr_b32 s54, s98, 3
    s_lshr_b32 s55, s99, 3
    ds_read_b64_tr_b16 a[64:65], v16 offset:16384
    ds_read_b64_tr_b16 a[66:67], v16 offset:20480
    ds_read_b64_tr_b16 a[68:69], v17 offset:16384
    ds_read_b64_tr_b16 a[70:71], v17 offset:20480
    ds_read_b64_tr_b16 a[72:73], v18 offset:16384
    ds_read_b64_tr_b16 a[74:75], v18 offset:20480
    ds_read_b64_tr_b16 a[76:77], v19 offset:16384
    ds_read_b64_tr_b16 a[78:79], v19 offset:20480
    ds_read_b64_tr_b16 a[80:81], v20 offset:16384
    ds_read_b64_tr_b16 a[82:83], v20 offset:20480
    ds_read_b64_tr_b16 a[84:85], v21 offset:16384
    ds_read_b64_tr_b16 a[86:87], v21 offset:20480
    ds_read_b64_tr_b16 a[88:89], v22 offset:16384
    ds_read_b64_tr_b16 a[90:91], v22 offset:20480
    ds_read_b64_tr_b16 a[92:93], v23 offset:16384
    ds_read_b64_tr_b16 a[94:95], v23 offset:20480
    ds_read_b64_tr_b16 a[96:97], v24 offset:0
    ds_read_b64_tr_b16 a[98:99], v24 offset:4096
    ds_read_b64_tr_b16 a[100:101], v25 offset:0
    ds_read_b64_tr_b16 a[102:103], v25 offset:4096
    ds_read_b64_tr_b16 a[104:105], v26 offset:0
    ds_read_b64_tr_b16 a[106:107], v26 offset:4096
    ds_read_b64_tr_b16 a[108:109], v27 offset:0
    ds_read_b64_tr_b16 a[110:111], v27 offset:4096
    ds_read_b64_tr_b16 a[112:113], v28 offset:0
    ds_read_b64_tr_b16 a[114:115], v28 offset:4096
    ds_read_b64_tr_b16 a[116:117], v29 offset:0
    ds_read_b64_tr_b16 a[118:119], v29 offset:4096
    ds_read_b64_tr_b16 a[120:121], v30 offset:0
    ds_read_b64_tr_b16 a[122:123], v30 offset:4096
    ds_read_b64_tr_b16 a[124:125], v31 offset:0
    ds_read_b64_tr_b16 a[126:127], v31 offset:4096
    ds_read_b64_tr_b16 a[128:129], v16 offset:49152
    ds_read_b64_tr_b16 a[130:131], v16 offset:53248
    ds_read_b64_tr_b16 a[132:133], v17 offset:49152
    ds_read_b64_tr_b16 a[134:135], v17 offset:53248
    ds_read_b64_tr_b16 a[136:137], v18 offset:49152
    ds_read_b64_tr_b16 a[138:139], v18 offset:53248
    ds_read_b64_tr_b16 a[140:141], v19 offset:49152
    ds_read_b64_tr_b16 a[142:143], v19 offset:53248
    ds_read_b64_tr_b16 a[144:145], v20 offset:49152
    ds_read_b64_tr_b16 a[146:147], v20 offset:53248
    ds_read_b64_tr_b16 a[148:149], v21 offset:49152
    ds_read_b64_tr_b16 a[150:151], v21 offset:53248
    ds_read_b64_tr_b16 a[152:153], v22 offset:49152
    ds_read_b64_tr_b16 a[154:155], v22 offset:53248
    ds_read_b64_tr_b16 a[156:157], v23 offset:49152
    ds_read_b64_tr_b16 a[158:159], v23 offset:53248
    ds_read_b64_tr_b16 a[160:161], v16 offset:32768
    ds_read_b64_tr_b16 a[162:163], v16 offset:36864
    ds_read_b64_tr_b16 a[164:165], v17 offset:32768
    ds_read_b64_tr_b16 a[166:167], v17 offset:36864
    ds_read_b64_tr_b16 a[168:169], v18 offset:32768
    ds_read_b64_tr_b16 a[170:171], v18 offset:36864
    ds_read_b64_tr_b16 a[172:173], v19 offset:32768
    ds_read_b64_tr_b16 a[174:175], v19 offset:36864
    ds_read_b64_tr_b16 a[176:177], v20 offset:32768
    ds_read_b64_tr_b16 a[178:179], v20 offset:36864
    ds_read_b64_tr_b16 a[180:181], v21 offset:32768
    ds_read_b64_tr_b16 a[182:183], v21 offset:36864
    ds_read_b64_tr_b16 a[184:185], v22 offset:32768
    ds_read_b64_tr_b16 a[186:187], v22 offset:36864
    ds_read_b64_tr_b16 a[188:189], v23 offset:32768
    ds_read_b64_tr_b16 a[190:191], v23 offset:36864
L_tagwait:
    s_cmp_lg_u32 s67, 0
    s_cbranch_scc1 L_havetag
    buffer_load_dwordx2 v[44:45], v10, s[88:91], 0 offen sc1
    s_add_u32 s49, s49, 1
    s_cmp_ge_u32 s49, 0x80000
    s_cbranch_scc1 L_end
    s_waitcnt vmcnt(0)
    v_readfirstlane_b32 s67, v45
    s_nop 3
    s_branch L_tagwait
L_havetag:
    s_waitcnt vmcnt(0)
    s_mov_b64 exec, 1
    buffer_store_dwordx2 v[44:45], v10, s[84:87], s68 offen sc1
    s_mov_b64 exec, -1
    s_waitcnt lgkmcnt(0)
    s_barrier
    s_add_u32 m0, s69, 147456
    s_add_u32 s65, s97, 262144
    buffer_load_dwordx4 v40, s[80:83], s65 offen offset:0 lds
    buffer_load_dwordx4 v41, s[80:83], s65 offen offset:1024 lds
    s_add_u32 m0, s69, 155648
    s_add_u32 s65, s97, 786432
    buffer_load_dwordx4 v40, s[80:83], s65 offen offset:0 lds
    buffer_load_dwordx4 v41, s[80:83], s65 offen offset:1024 lds
    s_add_u32 m0, s69, 131072
    s_add_u32 s65, s98, 262144
    buffer_load_dwordx4 v40, s[80:83], s65 offen offset:0 lds
    buffer_load_dwordx4 v41, s[80:83], s65 offen offset:1024 lds
    s_add_u32 m0, s69, 139264
    s_add_u32 s65, s98, 786432
    buffer_load_dwordx4 v40, s[80:83], s65 offen offset:0 lds
    buffer_load_dwordx4 v41, s[80:83], s65 offen offset:1024 lds
    s_add_u32 m0, s69, 0
    s_add_u32 s65, s99, 262144
    buffer_load_dwordx4 v40, s[80:83], s65 offen offset:0 lds
    buffer_load_dwordx4 v41, s[80:83], s65 offen offset:1024 lds
    s_add_u32 m0, s69, 8192
    s_add_u32 s65, s99, 786432
    buffer_load_dwordx4 v40, s[80:83], s65 offen offset:0 lds
    buffer_load_dwordx4 v41, s[80:83], s65 offen offset:1024 lds
    s_add_u32 m0, s69, 16384
    s_add_u32 s65, s96, 393216
    buffer_load_dwordx4 v40, s[80:83], s65 offen offset:0 lds
    buffer_load_dwordx4 v41, s[80:83], s65 offen offset:1024 lds
    s_add_u32 m0, s69, 24576
    s_add_u32 s65, s96, 917504
    buffer_load_dwordx4 v40, s[80:83], s65 offen offset:0 lds
    buffer_load_dwordx4 v41, s[80:83], s65 offen offset:1024 lds
    s_add_u32 m0, s69, 65536
    s_add_u32 s65, s97, 393216
    buffer_load_dwordx4 v40, s[80:83], s65 offen offset:0 lds
    buffer_load_dwordx4 v41, s[80:83], s65 offen offset:1024 lds
    s_add_u32 m0, s69, 73728
    s_add_u32 s65, s97, 917504
    buffer_load_dwordx4 v40, s[80:83], s65 offen offset:0 lds
    buffer_load_dwordx4 v41, s[80:83], s65 offen offset:1024 lds
    s_add_u32 m0, s69, 49152
    s_add_u32 s65, s98, 393216
    buffer_load_dwordx4 v40, s[80:83], s65 offen offset:0 lds
    buffer_load_dwordx4 v41, s[80:83], s65 offen offset:1024 lds
    s_add_u32 m0, s69, 57344
    s_add_u32 s65, s98, 917504
    buffer_load_dwordx4 v40, s[80:83], s65 offen offset:0 lds
    buffer_load_dwordx4 v41, s[80:83], s65 offen offset:1024 lds
    s_add_u32 m0, s69, 32768
    s_add_u32 s65, s99, 393216
    buffer_load_dwordx4 v40, s[80:83], s65 offen offset:0 lds
    buffer_load_dwordx4 v41, s[80:83], s65 offen offset:1024 lds
    s_add_u32 m0, s69, 40960
    s_add_u32 s65, s99, 917504
    buffer_load_dwordx4 v40, s[80:83], s65 offen offset:0 lds
    buffer_load_dwordx4 v41, s[80:83], s65 offen offset:1024 lds
L_poll:
    buffer_load_dwordx2 v[10:11], v9, s[84:87], s75 offen sc1
    s_waitcnt vmcnt(0)
    v_cmp_ne_u64 vcc, v[10:11], v[44:45]
    s_add_u32 s49, s49, 1
    s_cmp_ge_u32 s49, 0x80000
    s_cbranch_scc1 L_end
    s_cbranch_vccnz L_poll
L_ready:
    s_add_u32 s66, s52, 0
    buffer_load_dwordx4 v[176:179], v15, s[28:31], s66 offen offset:0 sc1
    buffer_load_dwordx4 v[180:183], v15, s[28:31], s66 offen offset:1024 sc1
    buffer_load_dwordx4 v[184:187], v15, s[28:31], s66 offen offset:2048 sc1
    buffer_load_dwordx4 v[188:191], v15, s[56:59], s66 offen offset:3072 sc1
    s_add_u32 s66, s53, 0
    buffer_load_dwordx4 v[192:195], v15, s[28:31], s66 offen offset:0 sc1
    buffer_load_dwordx4 v[196:199], v15, s[28:31], s66 offen offset:1024 sc1
    buffer_load_dwordx4 v[200:203], v15, s[28:31], s66 offen offset:2048 sc1
    buffer_load_dwordx4 v[204:207], v15, s[56:59], s66 offen offset:3072 sc1
    s_waitcnt vmcnt(4) lgkmcnt(0)
    v_mfma_f32_16x16x32_bf16 v[48:51], a[0:3], v[176:179], 0
    v_mfma_f32_16x16x32_bf16 v[52:55], a[0:3], v[180:183], 0
    s_add_u32 s66, s54, 0
    v_mfma_f32_16x16x32_bf16 v[56:59], a[0:3], v[184:187], 0
    v_mfma_f32_16x16x32_bf16 v[60:63], a[0:3], v[188:191], 0
    buffer_load_dwordx4 v[208:211], v15, s[28:31], s66 offen offset:0 sc1
    v_mfma_f32_16x16x32_bf16 v[64:67], a[4:7], v[176:179], 0
    v_mfma_f32_16x16x32_bf16 v[68:71], a[4:7], v[180:183], 0
    buffer_load_dwordx4 v[212:215], v15, s[28:31], s66 offen offset:1024 sc1
    v_mfma_f32_16x16x32_bf16 v[72:75], a[4:7], v[184:187], 0
    v_mfma_f32_16x16x32_bf16 v[76:79], a[4:7], v[188:191], 0
    buffer_load_dwordx4 v[216:219], v15, s[28:31], s66 offen offset:2048 sc1
    v_mfma_f32_16x16x32_bf16 v[80:83], a[8:11], v[176:179], 0
    v_mfma_f32_16x16x32_bf16 v[84:87], a[8:11], v[180:183], 0
    buffer_load_dwordx4 v[220:223], v15, s[56:59], s66 offen offset:3072 sc1
    v_mfma_f32_16x16x32_bf16 v[88:91], a[8:11], v[184:187], 0
    v_mfma_f32_16x16x32_bf16 v[92:95], a[8:11], v[188:191], 0
    s_add_u32 s66, s55, 0
    v_mfma_f32_16x16x32_bf16 v[96:99], a[12:15], v[176:179], 0
    v_mfma_f32_16x16x32_bf16 v[100:103], a[12:15], v[180:183], 0
    buffer_load_dwordx4 v[224:227], v15, s[28:31], s66 offen offset:0 sc1
    v_mfma_f32_16x16x32_bf16 v[104:107], a[12:15], v[184:187], 0
    v_mfma_f32_16x16x32_bf16 v[108:111], a[12:15], v[188:191], 0
    buffer_load_dwordx4 v[228:231], v15, s[28:31], s66 offen offset:1024 sc1
    v_mfma_f32_16x16x32_bf16 v[112:115], a[16:19], v[176:179], 0
    v_mfma_f32_16x16x32_bf16 v[116:119], a[16:19], v[180:183], 0
    buffer_load_dwordx4 v[232:235], v15, s[28:31], s66 offen offset:2048 sc1
    v_mfma_f32_16x16x32_bf16 v[120:123], a[16:19], v[184:187], 0
    v_mfma_f32_16x16x32_bf16 v[124:127], a[16:19], v[188:191], 0
    buffer_load_dwordx4 v[236:239], v15, s[56:59], s66 offen offset:3072 sc1
    v_mfma_f32_16x16x32_bf16 v[128:131], a[20:23], v[176:179], 0
    v_mfma_f32_16x16x32_bf16 v[132:135], a[20:23], v[180:183], 0
    v_mfma_f32_16x16x32_bf16 v[136:139], a[20:23], v[184:187], 0
    v_mfma_f32_16x16x32_bf16 v[140:143], a[20:23], v[188:191], 0
    v_mfma_f32_16x16x32_bf16 v[144:147], a[24:27], v[176:179], 0
    v_mfma_f32_16x16x32_bf16 v[148:151], a[24:27], v[180:183], 0
    v_mfma_f32_16x16x32_bf16 v[152:155], a[24:27], v[184:187], 0
    v_mfma_f32_16x16x32_bf16 v[156:159], a[24:27], v[188:191], 0
    v_mfma_f32_16x16x32_bf16 v[160:163], a[28:31], v[176:179], 0
    v_mfma_f32_16x16x32_bf16 v[164:167], a[28:31], v[180:183], 0
    v_mfma_f32_16x16x32_bf16 v[168:171], a[28:31], v[184:187], 0
    v_mfma_f32_16x16x32_bf16 v[172:175], a[28:31], v[188:191], 0
    s_waitcnt vmcnt(8) lgkmcnt(0)
    v_mfma_f32_16x16x32_bf16 v[48:51], a[32:35], v[192:195], v[48:51]
    v_mfma_f32_16x16x32_bf16 v[52:55], a[32:35], v[196:199], v[52:55]
    s_add_u32 s66, s52, 16384
    v_mfma_f32_16x16x32_bf16 v[56:59], a[32:35], v[200:203], v[56:59]
    v_mfma_f32_16x16x32_bf16 v[60:63], a[32:35], v[204:207], v[60:63]
    buffer_load_dwordx4 a[224:227], v15, s[28:31], s66 offen offset:0 sc1
    v_mfma_f32_16x16x32_bf16 v[64:67], a[36:39], v[192:195], v[64:67]
    v_mfma_f32_16x16x32_bf16 v[68:71], a[36:39], v[196:199], v[68:71]
    buffer_load_dwordx4 a[228:231], v15, s[28:31], s66 offen offset:1024 sc1
    v_mfma_f32_16x16x32_bf16 v[72:75], a[36:39], v[200:203], v[72:75]
    v_mfma_f32_16x16x32_bf16 v[76:79], a[36:39], v[204:207], v[76:79]
    buffer_load_dwordx4 a[232:235], v15, s[28:31], s66 offen offset:2048 sc1
    v_mfma_f32_16x16x32_bf16 v[80:83], a[40:43], v[192:195], v[80:83]
    v_mfma_f32_16x16x32_bf16 v[84:87], a[40:43], v[196:199], v[84:87]
    buffer_load_dwordx4 a[236:239], v15, s[56:59], s66 offen offset:3072 sc1
    v_mfma_f32_16x16x32_bf16 v[88:91], a[40:43], v[200:203], v[88:91]
    v_mfma_f32_16x16x32_bf16 v[92:95], a[40:43], v[204:207], v[92:95]
    s_add_u32 s66, s53, 16384
    v_mfma_f32_16x16x32_bf16 v[96:99], a[44:47], v[192:195], v[96:99]
    v_mfma_f32_16x16x32_bf16 v[100:103], a[44:47], v[196:199], v[100:103]
    buffer_load_dwordx4 a[240:243], v15, s[28:31], s66 offen offset:0 sc1
    v_mfma_f32_16x16x32_bf16 v[104:107], a[44:47], v[200:203], v[104:107]
    v_mfma_f32_16x16x32_bf16 v[108:111], a[44:47], v[204:207], v[108:111]
    buffer_load_dwordx4 a[244:247], v15, s[28:31], s66 offen offset:1024 sc1
    v_mfma_f32_16x16x32_bf16 v[112:115], a[48:51], v[192:195], v[112:115]
    v_mfma_f32_16x16x32_bf16 v[116:119], a[48:51], v[196:199], v[116:119]
    buffer_load_dwordx4 a[248:251], v15, s[28:31], s66 offen offset:2048 sc1
    v_mfma_f32_16x16x32_bf16 v[120:123], a[48:51], v[200:203], v[120:123]
    v_mfma_f32_16x16x32_bf16 v[124:127], a[48:51], v[204:207], v[124:127]
    buffer_load_dwordx4 a[252:255], v15, s[56:59], s66 offen offset:3072 sc1
    v_mfma_f32_16x16x32_bf16 v[128:131], a[52:55], v[192:195], v[128:131]
    v_mfma_f32_16x16x32_bf16 v[132:135], a[52:55], v[196:199], v[132:135]
    v_mfma_f32_16x16x32_bf16 v[136:139], a[52:55], v[200:203], v[136:139]
    v_mfma_f32_16x16x32_bf16 v[140:143], a[52:55], v[204:207], v[140:143]
    v_mfma_f32_16x16x32_bf16 v[144:147], a[56:59], v[192:195], v[144:147]
    v_mfma_f32_16x16x32_bf16 v[148:151], a[56:59], v[196:199], v[148:151]
    v_mfma_f32_16x16x32_bf16 v[152:155], a[56:59], v[200:203], v[152:155]
    v_mfma_f32_16x16x32_bf16 v[156:159], a[56:59], v[204:207], v[156:159]
    v_mfma_f32_16x16x32_bf16 v[160:163], a[60:63], v[192:195], v[160:163]
    v_mfma_f32_16x16x32_bf16 v[164:167], a[60:63], v[196:199], v[164:167]
    v_mfma_f32_16x16x32_bf16 v[168:171], a[60:63], v[200:203], v[168:171]
    v_mfma_f32_16x16x32_bf16 v[172:175], a[60:63], v[204:207], v[172:175]
    s_waitcnt vmcnt(12) lgkmcnt(0)
    v_mfma_f32_16x16x32_bf16 v[48:51], a[64:67], v[208:211], v[48:51]
    v_mfma_f32_16x16x32_bf16 v[52:55], a[64:67], v[212:215], v[52:55]
    s_add_u32 s66, s54, 16384
    v_mfma_f32_16x16x32_bf16 v[56:59], a[64:67], v[216:219], v[56:59]
    v_mfma_f32_16x16x32_bf16 v[60:63], a[64:67], v[220:223], v[60:63]
    buffer_load_dwordx4 v[176:179], v15, s[28:31], s66 offen offset:0 sc1
    v_mfma_f32_16x16x32_bf16 v[64:67], a[68:71], v[208:211], v[64:67]
    v_mfma_f32_16x16x32_bf16 v[68:71], a[68:71], v[212:215], v[68:71]
    buffer_load_dwordx4 v[180:183], v15, s[28:31], s66 offen offset:1024 sc1
    v_mfma_f32_16x16x32_bf16 v[72:75], a[68:71], v[216:219], v[72:75]
    v_mfma_f32_16x16x32_bf16 v[76:79], a[68:71], v[220:223], v[76:79]
    buffer_load_dwordx4 v[184:187], v15, s[28:31], s66 offen offset:2048 sc1
    v_mfma_f32_16x16x32_bf16 v[80:83], a[72:75], v[208:211], v[80:83]
    v_mfma_f32_16x16x32_bf16 v[84:87], a[72:75], v[212:215], v[84:87]
    buffer_load_dwordx4 v[188:191], v15, s[56:59], s66 offen offset:3072 sc1
    v_mfma_f32_16x16x32_bf16 v[88:91], a[72:75], v[216:219], v[88:91]
    v_mfma_f32_16x16x32_bf16 v[92:95], a[72:75], v[220:223], v[92:95]
    s_add_u32 s66, s55, 16384
    v_mfma_f32_16x16x32_bf16 v[96:99], a[76:79], v[208:211], v[96:99]
    v_mfma_f32_16x16x32_bf16 v[100:103], a[76:79], v[212:215], v[100:103]
    buffer_load_dwordx4 v[192:195], v15, s[28:31], s66 offen offset:0 sc1
    v_mfma_f32_16x16x32_bf16 v[104:107], a[76:79], v[216:219], v[104:107]
    v_mfma_f32_16x16x32_bf16 v[108:111], a[76:79], v[220:223], v[108:111]
    buffer_load_dwordx4 v[196:199], v15, s[28:31], s66 offen offset:1024 sc1
    v_mfma_f32_16x16x32_bf16 v[112:115], a[80:83], v[208:211], v[112:115]
    v_mfma_f32_16x16x32_bf16 v[116:119], a[80:83], v[212:215], v[116:119]
    buffer_load_dwordx4 v[200:203], v15, s[28:31], s66 offen offset:2048 sc1
    v_mfma_f32_16x16x32_bf16 v[120:123], a[80:83], v[216:219], v[120:123]
    v_mfma_f32_16x16x32_bf16 v[124:127], a[80:83], v[220:223], v[124:127]
    buffer_load_dwordx4 v[204:207], v15, s[56:59], s66 offen offset:3072 sc1
    v_mfma_f32_16x16x32_bf16 v[128:131], a[84:87], v[208:211], v[128:131]
    v_mfma_f32_16x16x32_bf16 v[132:135], a[84:87], v[212:215], v[132:135]
    v_mfma_f32_16x16x32_bf16 v[136:139], a[84:87], v[216:219], v[136:139]
    v_mfma_f32_16x16x32_bf16 v[140:143], a[84:87], v[220:223], v[140:143]
    v_mfma_f32_16x16x32_bf16 v[144:147], a[88:91], v[208:211], v[144:147]
    v_mfma_f32_16x16x32_bf16 v[148:151], a[88:91], v[212:215], v[148:151]
    v_mfma_f32_16x16x32_bf16 v[152:155], a[88:91], v[216:219], v[152:155]
    v_mfma_f32_16x16x32_bf16 v[156:159], a[88:91], v[220:223], v[156:159]
    v_mfma_f32_16x16x32_bf16 v[160:163], a[92:95], v[208:211], v[160:163]
    v_mfma_f32_16x16x32_bf16 v[164:167], a[92:95], v[212:215], v[164:167]
    v_mfma_f32_16x16x32_bf16 v[168:171], a[92:95], v[216:219], v[168:171]
    v_mfma_f32_16x16x32_bf16 v[172:175], a[92:95], v[220:223], v[172:175]
    s_waitcnt vmcnt(16) lgkmcnt(0)
    s_barrier
    v_mfma_f32_16x16x32_bf16 v[48:51], a[96:99], v[224:227], v[48:51]
    v_mfma_f32_16x16x32_bf16 v[52:55], a[96:99], v[228:231], v[52:55]
    s_add_u32 s66, s52, 32768
    v_mfma_f32_16x16x32_bf16 v[56:59], a[96:99], v[232:235], v[56:59]
    v_mfma_f32_16x16x32_bf16 v[60:63], a[96:99], v[236:239], v[60:63]
    buffer_load_dwordx4 a[0:3], v15, s[28:31], s66 offen offset:0 sc1
    v_mfma_f32_16x16x32_bf16 v[64:67], a[100:103], v[224:227], v[64:67]
    v_mfma_f32_16x16x32_bf16 v[68:71], a[100:103], v[228:231], v[68:71]
    buffer_load_dwordx4 a[4:7], v15, s[28:31], s66 offen offset:1024 sc1
    v_mfma_f32_16x16x32_bf16 v[72:75], a[100:103], v[232:235], v[72:75]
    v_mfma_f32_16x16x32_bf16 v[76:79], a[100:103], v[236:239], v[76:79]
    buffer_load_dwordx4 a[8:11], v15, s[28:31], s66 offen offset:2048 sc1
    v_mfma_f32_16x16x32_bf16 v[80:83], a[104:107], v[224:227], v[80:83]
    v_mfma_f32_16x16x32_bf16 v[84:87], a[104:107], v[228:231], v[84:87]
    buffer_load_dwordx4 a[12:15], v15, s[56:59], s66 offen offset:3072 sc1
    v_mfma_f32_16x16x32_bf16 v[88:91], a[104:107], v[232:235], v[88:91]
    v_mfma_f32_16x16x32_bf16 v[92:95], a[104:107], v[236:239], v[92:95]
    v_mfma_f32_16x16x32_bf16 v[96:99], a[108:111], v[224:227], v[96:99]
    v_mfma_f32_16x16x32_bf16 v[100:103], a[108:111], v[228:231], v[100:103]
    v_mfma_f32_16x16x32_bf16 v[104:107], a[108:111], v[232:235], v[104:107]
    v_mfma_f32_16x16x32_bf16 v[108:111], a[108:111], v[236:239], v[108:111]
    v_mfma_f32_16x16x32_bf16 v[112:115], a[112:115], v[224:227], v[112:115]
    v_mfma_f32_16x16x32_bf16 v[116:119], a[112:115], v[228:231], v[116:119]
    v_mfma_f32_16x16x32_bf16 v[120:123], a[112:115], v[232:235], v[120:123]
    v_mfma_f32_16x16x32_bf16 v[124:127], a[112:115], v[236:239], v[124:127]
    v_mfma_f32_16x16x32_bf16 v[128:131], a[116:119], v[224:227], v[128:131]
    v_mfma_f32_16x16x32_bf16 v[132:135], a[116:119], v[228:231], v[132:135]
    v_mfma_f32_16x16x32_bf16 v[136:139], a[116:119], v[232:235], v[136:139]
    v_mfma_f32_16x16x32_bf16 v[140:143], a[116:119], v[236:239], v[140:143]
    v_mfma_f32_16x16x32_bf16 v[144:147], a[120:123], v[224:227], v[144:147]
    v_mfma_f32_16x16x32_bf16 v[148:151], a[120:123], v[228:231], v[148:151]
    v_mfma_f32_16x16x32_bf16 v[152:155], a[120:123], v[232:235], v[152:155]
    v_mfma_f32_16x16x32_bf16 v[156:159], a[120:123], v[236:239], v[156:159]
    v_mfma_f32_16x16x32_bf16 v[160:163], a[124:127], v[224:227], v[160:163]
    v_mfma_f32_16x16x32_bf16 v[164:167], a[124:127], v[228:231], v[164:167]
    v_mfma_f32_16x16x32_bf16 v[168:171], a[124:127], v[232:235], v[168:171]
    v_mfma_f32_16x16x32_bf16 v[172:175], a[124:127], v[236:239], v[172:175]
    s_waitcnt vmcnt(16) lgkmcnt(0)
    v_mfma_f32_16x16x32_bf16 v[48:51], a[128:131], a[224:227], v[48:51]
    v_mfma_f32_16x16x32_bf16 v[52:55], a[128:131], a[228:231], v[52:55]
    s_add_u32 s66, s53, 32768
    v_mfma_f32_16x16x32_bf16 v[56:59], a[128:131], a[232:235], v[56:59]
    v_mfma_f32_16x16x32_bf16 v[60:63], a[128:131], a[236:239], v[60:63]
    buffer_load_dwordx4 a[16:19], v15, s[28:31], s66 offen offset:0 sc1
    v_mfma_f32_16x16x32_bf16 v[64:67], a[132:135], a[224:227], v[64:67]
    v_mfma_f32_16x16x32_bf16 v[68:71], a[132:135], a[228:231], v[68:71]
    buffer_load_dwordx4 a[20:23], v15, s[28:31], s66 offen offset:1024 sc1
    v_mfma_f32_16x16x32_bf16 v[72:75], a[132:135], a[232:235], v[72:75]
    v_mfma_f32_16x16x32_bf16 v[76:79], a[132:135], a[236:239], v[76:79]
    buffer_load_dwordx4 a[24:27], v15, s[28:31], s66 offen offset:2048 sc1
    v_mfma_f32_16x16x32_bf16 v[80:83], a[136:139], a[224:227], v[80:83]
    v_mfma_f32_16x16x32_bf16 v[84:87], a[136:139], a[228:231], v[84:87]
    buffer_load_dwordx4 a[28:31], v15, s[56:59], s66 offen offset:3072 sc1
    v_mfma_f32_16x16x32_bf16 v[88:91], a[136:139], a[232:235], v[88:91]
    v_mfma_f32_16x16x32_bf16 v[92:95], a[136:139], a[236:239], v[92:95]
    v_mfma_f32_16x16x32_bf16 v[96:99], a[140:143], a[224:227], v[96:99]
    v_mfma_f32_16x16x32_bf16 v[100:103], a[140:143], a[228:231], v[100:103]
    v_mfma_f32_16x16x32_bf16 v[104:107], a[140:143], a[232:235], v[104:107]
    v_mfma_f32_16x16x32_bf16 v[108:111], a[140:143], a[236:239], v[108:111]
    v_mfma_f32_16x16x32_bf16 v[112:115], a[144:147], a[224:227], v[112:115]
    v_mfma_f32_16x16x32_bf16 v[116:119], a[144:147], a[228:231], v[116:119]
    v_mfma_f32_16x16x32_bf16 v[120:123], a[144:147], a[232:235], v[120:123]
    v_mfma_f32_16x16x32_bf16 v[124:127], a[144:147], a[236:239], v[124:127]
    v_mfma_f32_16x16x32_bf16 v[128:131], a[148:151], a[224:227], v[128:131]
    v_mfma_f32_16x16x32_bf16 v[132:135], a[148:151], a[228:231], v[132:135]
    v_mfma_f32_16x16x32_bf16 v[136:139], a[148:151], a[232:235], v[136:139]
    v_mfma_f32_16x16x32_bf16 v[140:143], a[148:151], a[236:239], v[140:143]
    v_mfma_f32_16x16x32_bf16 v[144:147], a[152:155], a[224:227], v[144:147]
    v_mfma_f32_16x16x32_bf16 v[148:151], a[152:155], a[228:231], v[148:151]
    v_mfma_f32_16x16x32_bf16 v[152:155], a[152:155], a[232:235], v[152:155]
    v_mfma_f32_16x16x32_bf16 v[156:159], a[152:155], a[236:239], v[156:159]
    v_mfma_f32_16x16x32_bf16 v[160:163], a[156:159], a[224:227], v[160:163]
    v_mfma_f32_16x16x32_bf16 v[164:167], a[156:159], a[228:231], v[164:167]
    v_mfma_f32_16x16x32_bf16 v[168:171], a[156:159], a[232:235], v[168:171]
    v_mfma_f32_16x16x32_bf16 v[172:175], a[156:159], a[236:239], v[172:175]
    s_waitcnt vmcnt(16) lgkmcnt(0)
    v_mfma_f32_16x16x32_bf16 v[48:51], a[160:163], a[240:243], v[48:51]
    ds_read_b64_tr_b16 a[192:193], v24 offset:16384
    v_mfma_f32_16x16x32_bf16 v[52:55], a[160:163], a[244:247], v[52:55]
    ds_read_b64_tr_b16 a[194:195], v24 offset:20480
    s_add_u32 s66, s54, 32768
    v_mfma_f32_16x16x32_bf16 v[56:59], a[160:163], a[248:251], v[56:59]
    ds_read_b64_tr_b16 a[196:197], v25 offset:16384
    v_mfma_f32_16x16x32_bf16 v[60:63], a[160:163], a[252:255], v[60:63]
    ds_read_b64_tr_b16 a[198:199], v25 offset:20480
    buffer_load_dwordx4 a[32:35], v15, s[28:31], s66 offen offset:0 sc1
    v_mfma_f32_16x16x32_bf16 v[64:67], a[164:167], a[240:243], v[64:67]
    ds_read_b64_tr_b16 a[200:201], v26 offset:16384
    v_mfma_f32_16x16x32_bf16 v[68:71], a[164:167], a[244:247], v[68:71]
    ds_read_b64_tr_b16 a[202:203], v26 offset:20480
    buffer_load_dwordx4 a[36:39], v15, s[28:31], s66 offen offset:1024 sc1
    v_mfma_f32_16x16x32_bf16 v[72:75], a[164:167], a[248:251], v[72:75]
    ds_read_b64_tr_b16 a[204:205], v27 offset:16384
    v_mfma_f32_16x16x32_bf16 v[76:79], a[164:167], a[252:255], v[76:79]
    ds_read_b64_tr_b16 a[206:207], v27 offset:20480
    buffer_load_dwordx4 a[40:43], v15, s[28:31], s66 offen offset:2048 sc1
    v_mfma_f32_16x16x32_bf16 v[80:83], a[168:171], a[240:243], v[80:83]
    ds_read_b64_tr_b16 a[208:209], v28 offset:16384
    v_mfma_f32_16x16x32_bf16 v[84:87], a[168:171], a[244:247], v[84:87]
    ds_read_b64_tr_b16 a[210:211], v28 offset:20480
    buffer_load_dwordx4 a[44:47], v15, s[56:59], s66 offen offset:3072 sc1
    v_mfma_f32_16x16x32_bf16 v[88:91], a[168:171], a[248:251], v[88:91]
    ds_read_b64_tr_b16 a[212:213], v29 offset:16384
    v_mfma_f32_16x16x32_bf16 v[92:95], a[168:171], a[252:255], v[92:95]
    ds_read_b64_tr_b16 a[214:215], v29 offset:20480
    v_mfma_f32_16x16x32_bf16 v[96:99], a[172:175], a[240:243], v[96:99]
    ds_read_b64_tr_b16 a[216:217], v30 offset:16384
    v_mfma_f32_16x16x32_bf16 v[100:103], a[172:175], a[244:247], v[100:103]
    ds_read_b64_tr_b16 a[218:219], v30 offset:20480
    v_mfma_f32_16x16x32_bf16 v[104:107], a[172:175], a[248:251], v[104:107]
    ds_read_b64_tr_b16 a[220:221], v31 offset:16384
    v_mfma_f32_16x16x32_bf16 v[108:111], a[172:175], a[252:255], v[108:111]
    ds_read_b64_tr_b16 a[222:223], v31 offset:20480
    v_mfma_f32_16x16x32_bf16 v[112:115], a[176:179], a[240:243], v[112:115]
    v_mfma_f32_16x16x32_bf16 v[116:119], a[176:179], a[244:247], v[116:119]
    v_mfma_f32_16x16x32_bf16 v[120:123], a[176:179], a[248:251], v[120:123]
    v_mfma_f32_16x16x32_bf16 v[124:127], a[176:179], a[252:255], v[124:127]
    v_mfma_f32_16x16x32_bf16 v[128:131], a[180:183], a[240:243], v[128:131]
    v_mfma_f32_16x16x32_bf16 v[132:135], a[180:183], a[244:247], v[132:135]
    v_mfma_f32_16x16x32_bf16 v[136:139], a[180:183], a[248:251], v[136:139]
    v_mfma_f32_16x16x32_bf16 v[140:143], a[180:183], a[252:255], v[140:143]
    v_mfma_f32_16x16x32_bf16 v[144:147], a[184:187], a[240:243], v[144:147]
    v_mfma_f32_16x16x32_bf16 v[148:151], a[184:187], a[244:247], v[148:151]
    v_mfma_f32_16x16x32_bf16 v[152:155], a[184:187], a[248:251], v[152:155]
    v_mfma_f32_16x16x32_bf16 v[156:159], a[184:187], a[252:255], v[156:159]
    v_mfma_f32_16x16x32_bf16 v[160:163], a[188:191], a[240:243], v[160:163]
    v_mfma_f32_16x16x32_bf16 v[164:167], a[188:191], a[244:247], v[164:167]
    v_mfma_f32_16x16x32_bf16 v[168:171], a[188:191], a[248:251], v[168:171]
    v_mfma_f32_16x16x32_bf16 v[172:175], a[188:191], a[252:255], v[172:175]
    s_waitcnt vmcnt(16) lgkmcnt(0)
    v_mfma_f32_16x16x32_bf16 v[48:51], a[192:195], v[176:179], v[48:51]
    ds_read_b64_tr_b16 a[224:225], v24 offset:49152
    v_mfma_f32_16x16x32_bf16 v[52:55], a[192:195], v[180:183], v[52:55]
    ds_read_b64_tr_b16 a[226:227], v24 offset:53248
    s_add_u32 s66, s55, 32768
    v_mfma_f32_16x16x32_bf16 v[56:59], a[192:195], v[184:187], v[56:59]
    ds_read_b64_tr_b16 a[228:229], v25 offset:49152
    v_mfma_f32_16x16x32_bf16 v[60:63], a[192:195], v[188:191], v[60:63]
    ds_read_b64_tr_b16 a[230:231], v25 offset:53248
    buffer_load_dwordx4 a[48:51], v15, s[28:31], s66 offen offset:0 sc1
    v_mfma_f32_16x16x32_bf16 v[64:67], a[196:199], v[176:179], v[64:67]
    ds_read_b64_tr_b16 a[232:233], v26 offset:49152
    v_mfma_f32_16x16x32_bf16 v[68:71], a[196:199], v[180:183], v[68:71]
    ds_read_b64_tr_b16 a[234:235], v26 offset:53248
    buffer_load_dwordx4 a[52:55], v15, s[28:31], s66 offen offset:1024 sc1
    v_mfma_f32_16x16x32_bf16 v[72:75], a[196:199], v[184:187], v[72:75]
    ds_read_b64_tr_b16 a[236:237], v27 offset:49152
    v_mfma_f32_16x16x32_bf16 v[76:79], a[196:199], v[188:191], v[76:79]
    ds_read_b64_tr_b16 a[238:239], v27 offset:53248
    buffer_load_dwordx4 a[56:59], v15, s[28:31], s66 offen offset:2048 sc1
    v_mfma_f32_16x16x32_bf16 v[80:83], a[200:203], v[176:179], v[80:83]
    ds_read_b64_tr_b16 a[240:241], v28 offset:49152
    v_mfma_f32_16x16x32_bf16 v[84:87], a[200:203], v[180:183], v[84:87]
    ds_read_b64_tr_b16 a[242:243], v28 offset:53248
    buffer_load_dwordx4 a[60:63], v15, s[56:59], s66 offen offset:3072 sc1
    v_mfma_f32_16x16x32_bf16 v[88:91], a[200:203], v[184:187], v[88:91]
    ds_read_b64_tr_b16 a[244:245], v29 offset:49152
    v_mfma_f32_16x16x32_bf16 v[92:95], a[200:203], v[188:191], v[92:95]
    ds_read_b64_tr_b16 a[246:247], v29 offset:53248
    v_mfma_f32_16x16x32_bf16 v[96:99], a[204:207], v[176:179], v[96:99]
    ds_read_b64_tr_b16 a[248:249], v30 offset:49152
    v_mfma_f32_16x16x32_bf16 v[100:103], a[204:207], v[180:183], v[100:103]
    ds_read_b64_tr_b16 a[250:251], v30 offset:53248
    v_mfma_f32_16x16x32_bf16 v[104:107], a[204:207], v[184:187], v[104:107]
    ds_read_b64_tr_b16 a[252:253], v31 offset:49152
    v_mfma_f32_16x16x32_bf16 v[108:111], a[204:207], v[188:191], v[108:111]
    ds_read_b64_tr_b16 a[254:255], v31 offset:53248
    v_mfma_f32_16x16x32_bf16 v[112:115], a[208:211], v[176:179], v[112:115]
    v_mfma_f32_16x16x32_bf16 v[116:119], a[208:211], v[180:183], v[116:119]
    v_mfma_f32_16x16x32_bf16 v[120:123], a[208:211], v[184:187], v[120:123]
    v_mfma_f32_16x16x32_bf16 v[124:127], a[208:211], v[188:191], v[124:127]
    v_mfma_f32_16x16x32_bf16 v[128:131], a[212:215], v[176:179], v[128:131]
    v_mfma_f32_16x16x32_bf16 v[132:135], a[212:215], v[180:183], v[132:135]
    v_mfma_f32_16x16x32_bf16 v[136:139], a[212:215], v[184:187], v[136:139]
    v_mfma_f32_16x16x32_bf16 v[140:143], a[212:215], v[188:191], v[140:143]
    v_mfma_f32_16x16x32_bf16 v[144:147], a[216:219], v[176:179], v[144:147]
    v_mfma_f32_16x16x32_bf16 v[148:151], a[216:219], v[180:183], v[148:151]
    v_mfma_f32_16x16x32_bf16 v[152:155], a[216:219], v[184:187], v[152:155]
    v_mfma_f32_16x16x32_bf16 v[156:159], a[216:219], v[188:191], v[156:159]
    v_mfma_f32_16x16x32_bf16 v[160:163], a[220:223], v[176:179], v[160:163]
    v_mfma_f32_16x16x32_bf16 v[164:167], a[220:223], v[180:183], v[164:167]
    v_mfma_f32_16x16x32_bf16 v[168:171], a[220:223], v[184:187], v[168:171]
    v_mfma_f32_16x16x32_bf16 v[172:175], a[220:223], v[188:191], v[172:175]
    s_waitcnt vmcnt(16) lgkmcnt(0)
    v_mfma_f32_16x16x32_bf16 v[48:51], a[224:227], v[192:195], v[48:51]
    ds_read_b64_tr_b16 a[64:65], v24 offset:32768
    v_mfma_f32_16x16x32_bf16 v[52:55], a[224:227], v[196:199], v[52:55]
    ds_read_b64_tr_b16 a[66:67], v24 offset:36864
    s_add_u32 s66, s52, 49152
    v_mfma_f32_16x16x32_bf16 v[56:59], a[224:227], v[200:203], v[56:59]
    ds_read_b64_tr_b16 a[68:69], v25 offset:32768
    v_mfma_f32_16x16x32_bf16 v[60:63], a[224:227], v[204:207], v[60:63]
    ds_read_b64_tr_b16 a[70:71], v25 offset:36864
    buffer_load_dwordx4 a[72:75], v15, s[28:31], s66 offen offset:0 sc1
    v_mfma_f32_16x16x32_bf16 v[64:67], a[228:231], v[192:195], v[64:67]
    ds_read_b64_tr_b16 a[200:201], v26 offset:32768
    v_mfma_f32_16x16x32_bf16 v[68:71], a[228:231], v[196:199], v[68:71]
    ds_read_b64_tr_b16 a[202:203], v26 offset:36864
    buffer_load_dwordx4 a[76:79], v15, s[28:31], s66 offen offset:1024 sc1
    v_mfma_f32_16x16x32_bf16 v[72:75], a[228:231], v[200:203], v[72:75]
    ds_read_b64_tr_b16 a[204:205], v27 offset:32768
    v_mfma_f32_16x16x32_bf16 v[76:79], a[228:231], v[204:207], v[76:79]
    ds_read_b64_tr_b16 a[206:207], v27 offset:36864
    buffer_load_dwordx4 a[80:83], v15, s[28:31], s66 offen offset:2048 sc1
    v_mfma_f32_16x16x32_bf16 v[80:83], a[232:235], v[192:195], v[80:83]
    ds_read_b64_tr_b16 a[208:209], v28 offset:32768
    v_mfma_f32_16x16x32_bf16 v[84:87], a[232:235], v[196:199], v[84:87]
    ds_read_b64_tr_b16 a[210:211], v28 offset:36864
    buffer_load_dwordx4 a[84:87], v15, s[56:59], s66 offen offset:3072 sc1
    v_mfma_f32_16x16x32_bf16 v[88:91], a[232:235], v[200:203], v[88:91]
    ds_read_b64_tr_b16 a[212:213], v29 offset:32768
    v_mfma_f32_16x16x32_bf16 v[92:95], a[232:235], v[204:207], v[92:95]
    ds_read_b64_tr_b16 a[214:215], v29 offset:36864
    v_mfma_f32_16x16x32_bf16 v[96:99], a[236:239], v[192:195], v[96:99]
    ds_read_b64_tr_b16 a[216:217], v30 offset:32768
    v_mfma_f32_16x16x32_bf16 v[100:103], a[236:239], v[196:199], v[100:103]
    ds_read_b64_tr_b16 a[218:219], v30 offset:36864
    v_mfma_f32_16x16x32_bf16 v[104:107], a[236:239], v[200:203], v[104:107]
    ds_read_b64_tr_b16 a[220:221], v31 offset:32768
    v_mfma_f32_16x16x32_bf16 v[108:111], a[236:239], v[204:207], v[108:111]
    ds_read_b64_tr_b16 a[222:223], v31 offset:36864
    v_mfma_f32_16x16x32_bf16 v[112:115], a[240:243], v[192:195], v[112:115]
    v_mfma_f32_16x16x32_bf16 v[116:119], a[240:243], v[196:199], v[116:119]
    v_mfma_f32_16x16x32_bf16 v[120:123], a[240:243], v[200:203], v[120:123]
    v_mfma_f32_16x16x32_bf16 v[124:127], a[240:243], v[204:207], v[124:127]
    v_mfma_f32_16x16x32_bf16 v[128:131], a[244:247], v[192:195], v[128:131]
    v_mfma_f32_16x16x32_bf16 v[132:135], a[244:247], v[196:199], v[132:135]
    v_mfma_f32_16x16x32_bf16 v[136:139], a[244:247], v[200:203], v[136:139]
    v_mfma_f32_16x16x32_bf16 v[140:143], a[244:247], v[204:207], v[140:143]
    v_mfma_f32_16x16x32_bf16 v[144:147], a[248:251], v[192:195], v[144:147]
    v_mfma_f32_16x16x32_bf16 v[148:151], a[248:251], v[196:199], v[148:151]
    v_mfma_f32_16x16x32_bf16 v[152:155], a[248:251], v[200:203], v[152:155]
    v_mfma_f32_16x16x32_bf16 v[156:159], a[248:251], v[204:207], v[156:159]
    v_mfma_f32_16x16x32_bf16 v[160:163], a[252:255], v[192:195], v[160:163]
    v_mfma_f32_16x16x32_bf16 v[164:167], a[252:255], v[196:199], v[164:167]
    v_mfma_f32_16x16x32_bf16 v[168:171], a[252:255], v[200:203], v[168:171]
    v_mfma_f32_16x16x32_bf16 v[172:175], a[252:255], v[204:207], v[172:175]
    s_waitcnt vmcnt(16) lgkmcnt(0)
    v_mfma_f32_16x16x32_bf16 v[80:83], a[200:203], a[0:3], v[80:83]
    ds_read_b64_tr_b16 a[88:89], v32 offset:16384
    v_mfma_f32_16x16x32_bf16 v[84:87], a[200:203], a[4:7], v[84:87]
    ds_read_b64_tr_b16 a[90:91], v32 offset:20480
    s_add_u32 s66, s53, 49152
    v_mfma_f32_16x16x32_bf16 v[88:91], a[200:203], a[8:11], v[88:91]
    ds_read_b64_tr_b16 a[92:93], v33 offset:16384
    v_mfma_f32_16x16x32_bf16 v[92:95], a[200:203], a[12:15], v[92:95]
    ds_read_b64_tr_b16 a[94:95], v33 offset:20480
    buffer_load_dwordx4 a[96:99], v15, s[28:31], s66 offen offset:0 sc1
    v_mfma_f32_16x16x32_bf16 v[96:99], a[204:207], a[0:3], v[96:99]
    ds_read_b64_tr_b16 a[232:233], v34 offset:16384
    v_mfma_f32_16x16x32_bf16 v[100:103], a[204:207], a[4:7], v[100:103]
    ds_read_b64_tr_b16 a[234:235], v34 offset:20480
    buffer_load_dwordx4 a[100:103], v15, s[28:31], s66 offen offset:1024 sc1
    v_mfma_f32_16x16x32_bf16 v[104:107], a[204:207], a[8:11], v[104:107]
    ds_read_b64_tr_b16 a[236:237], v35 offset:16384
    v_mfma_f32_16x16x32_bf16 v[108:111], a[204:207], a[12:15], v[108:111]
    ds_read_b64_tr_b16 a[238:239], v35 offset:20480
    buffer_load_dwordx4 a[104:107], v15, s[28:31], s66 offen offset:2048 sc1
    v_mfma_f32_16x16x32_bf16 v[112:115], a[208:211], a[0:3], v[112:115]
    ds_read_b64_tr_b16 a[240:241], v36 offset:16384
    v_mfma_f32_16x16x32_bf16 v[116:119], a[208:211], a[4:7], v[116:119]
    ds_read_b64_tr_b16 a[242:243], v36 offset:20480
    buffer_load_dwordx4 a[108:111], v15, s[56:59], s66 offen offset:3072 sc1
    v_mfma_f32_16x16x32_bf16 v[120:123], a[208:211], a[8:11], v[120:123]
    ds_read_b64_tr_b16 a[244:245], v37 offset:16384
    v_mfma_f32_16x16x32_bf16 v[124:127], a[208:211], a[12:15], v[124:127]
    ds_read_b64_tr_b16 a[246:247], v37 offset:20480
    v_mfma_f32_16x16x32_bf16 v[128:131], a[212:215], a[0:3], v[128:131]
    ds_read_b64_tr_b16 a[248:249], v38 offset:16384
    v_mfma_f32_16x16x32_bf16 v[132:135], a[212:215], a[4:7], v[132:135]
    ds_read_b64_tr_b16 a[250:251], v38 offset:20480
    v_mfma_f32_16x16x32_bf16 v[136:139], a[212:215], a[8:11], v[136:139]
    ds_read_b64_tr_b16 a[252:253], v39 offset:16384
    v_mfma_f32_16x16x32_bf16 v[140:143], a[212:215], a[12:15], v[140:143]
    ds_read_b64_tr_b16 a[254:255], v39 offset:20480
    v_mfma_f32_16x16x32_bf16 v[144:147], a[216:219], a[0:3], v[144:147]
    v_mfma_f32_16x16x32_bf16 v[148:151], a[216:219], a[4:7], v[148:151]
    v_mfma_f32_16x16x32_bf16 v[152:155], a[216:219], a[8:11], v[152:155]
    v_mfma_f32_16x16x32_bf16 v[156:159], a[216:219], a[12:15], v[156:159]
    v_mfma_f32_16x16x32_bf16 v[160:163], a[220:223], a[0:3], v[160:163]
    v_mfma_f32_16x16x32_bf16 v[164:167], a[220:223], a[4:7], v[164:167]
    v_mfma_f32_16x16x32_bf16 v[168:171], a[220:223], a[8:11], v[168:171]
    v_mfma_f32_16x16x32_bf16 v[172:175], a[220:223], a[12:15], v[172:175]
    s_waitcnt vmcnt(16) lgkmcnt(0)
    v_mfma_f32_16x16x32_bf16 v[80:83], a[232:235], a[16:19], v[80:83]
    ds_read_b64_tr_b16 a[112:113], v32 offset:0
    v_mfma_f32_16x16x32_bf16 v[84:87], a[232:235], a[20:23], v[84:87]
    ds_read_b64_tr_b16 a[114:115], v32 offset:4096
    s_add_u32 s66, s54, 49152
    v_mfma_f32_16x16x32_bf16 v[88:91], a[232:235], a[24:27], v[88:91]
    ds_read_b64_tr_b16 a[116:117], v33 offset:0
    v_mfma_f32_16x16x32_bf16 v[92:95], a[232:235], a[28:31], v[92:95]
    ds_read_b64_tr_b16 a[118:119], v33 offset:4096
    buffer_load_dwordx4 a[120:123], v15, s[28:31], s66 offen offset:0 sc1
    v_mfma_f32_16x16x32_bf16 v[96:99], a[236:239], a[16:19], v[96:99]
    ds_read_b64_tr_b16 a[200:201], v34 offset:0
    v_mfma_f32_16x16x32_bf16 v[100:103], a[236:239], a[20:23], v[100:103]
    ds_read_b64_tr_b16 a[202:203], v34 offset:4096
    buffer_load_dwordx4 a[124:127], v15, s[28:31], s66 offen offset:1024 sc1
    v_mfma_f32_16x16x32_bf16 v[104:107], a[236:239], a[24:27], v[104:107]
    ds_read_b64_tr_b16 a[204:205], v35 offset:0
    v_mfma_f32_16x16x32_bf16 v[108:111], a[236:239], a[28:31], v[108:111]
    ds_read_b64_tr_b16 a[206:207], v35 offset:4096
    buffer_load_dwordx4 a[128:131], v15, s[28:31], s66 offen offset:2048 sc1
    v_mfma_f32_16x16x32_bf16 v[112:115], a[240:243], a[16:19], v[112:115]
    ds_read_b64_tr_b16 a[208:209], v36 offset:0
    v_mfma_f32_16x16x32_bf16 v[116:119], a[240:243], a[20:23], v[116:119]
    ds_read_b64_tr_b16 a[210:211], v36 offset:4096
    buffer_load_dwordx4 a[132:135], v15, s[56:59], s66 offen offset:3072 sc1
    v_mfma_f32_16x16x32_bf16 v[120:123], a[240:243], a[24:27], v[120:123]
    ds_read_b64_tr_b16 a[212:213], v37 offset:0
    v_mfma_f32_16x16x32_bf16 v[124:127], a[240:243], a[28:31], v[124:127]
    ds_read_b64_tr_b16 a[214:215], v37 offset:4096
    v_mfma_f32_16x16x32_bf16 v[128:131], a[244:247], a[16:19], v[128:131]
    ds_read_b64_tr_b16 a[216:217], v38 offset:0
    v_mfma_f32_16x16x32_bf16 v[132:135], a[244:247], a[20:23], v[132:135]
    ds_read_b64_tr_b16 a[218:219], v38 offset:4096
    v_mfma_f32_16x16x32_bf16 v[136:139], a[244:247], a[24:27], v[136:139]
    ds_read_b64_tr_b16 a[220:221], v39 offset:0
    v_mfma_f32_16x16x32_bf16 v[140:143], a[244:247], a[28:31], v[140:143]
    ds_read_b64_tr_b16 a[222:223], v39 offset:4096
    v_mfma_f32_16x16x32_bf16 v[144:147], a[248:251], a[16:19], v[144:147]
    v_mfma_f32_16x16x32_bf16 v[148:151], a[248:251], a[20:23], v[148:151]
    v_mfma_f32_16x16x32_bf16 v[152:155], a[248:251], a[24:27], v[152:155]
    v_mfma_f32_16x16x32_bf16 v[156:159], a[248:251], a[28:31], v[156:159]
    v_mfma_f32_16x16x32_bf16 v[160:163], a[252:255], a[16:19], v[160:163]
    v_mfma_f32_16x16x32_bf16 v[164:167], a[252:255], a[20:23], v[164:167]
    v_mfma_f32_16x16x32_bf16 v[168:171], a[252:255], a[24:27], v[168:171]
    v_mfma_f32_16x16x32_bf16 v[172:175], a[252:255], a[28:31], v[172:175]
    s_waitcnt vmcnt(16) lgkmcnt(0)
    v_mfma_f32_16x16x32_bf16 v[80:83], a[200:203], a[32:35], v[80:83]
    ds_read_b64_tr_b16 a[136:137], v16 offset:0
    v_mfma_f32_16x16x32_bf16 v[84:87], a[200:203], a[36:39], v[84:87]
    ds_read_b64_tr_b16 a[138:139], v16 offset:4096
    s_add_u32 s66, s55, 49152
    v_mfma_f32_16x16x32_bf16 v[88:91], a[200:203], a[40:43], v[88:91]
    ds_read_b64_tr_b16 a[140:141], v17 offset:0
    v_mfma_f32_16x16x32_bf16 v[92:95], a[200:203], a[44:47], v[92:95]
    ds_read_b64_tr_b16 a[142:143], v17 offset:4096
    buffer_load_dwordx4 a[144:147], v15, s[28:31], s66 offen offset:0 sc1
    v_mfma_f32_16x16x32_bf16 v[96:99], a[204:207], a[32:35], v[96:99]
    ds_read_b64_tr_b16 a[232:233], v18 offset:0
    v_mfma_f32_16x16x32_bf16 v[100:103], a[204:207], a[36:39], v[100:103]
    ds_read_b64_tr_b16 a[234:235], v18 offset:4096
    buffer_load_dwordx4 a[148:151], v15, s[28:31], s66 offen offset:1024 sc1
    v_mfma_f32_16x16x32_bf16 v[104:107], a[204:207], a[40:43], v[104:107]
    ds_read_b64_tr_b16 a[236:237], v19 offset:0
    v_mfma_f32_16x16x32_bf16 v[108:111], a[204:207], a[44:47], v[108:111]
    ds_read_b64_tr_b16 a[238:239], v19 offset:4096
    buffer_load_dwordx4 a[152:155], v15, s[28:31], s66 offen offset:2048 sc1
    v_mfma_f32_16x16x32_bf16 v[112:115], a[208:211], a[32:35], v[112:115]
    ds_read_b64_tr_b16 a[240:241], v20 offset:0
    v_mfma_f32_16x16x32_bf16 v[116:119], a[208:211], a[36:39], v[116:119]
    ds_read_b64_tr_b16 a[242:243], v20 offset:4096
    buffer_load_dwordx4 a[156:159], v15, s[56:59], s66 offen offset:3072 sc1
    v_mfma_f32_16x16x32_bf16 v[120:123], a[208:211], a[40:43], v[120:123]
    ds_read_b64_tr_b16 a[244:245], v21 offset:0
    v_mfma_f32_16x16x32_bf16 v[124:127], a[208:211], a[44:47], v[124:127]
    ds_read_b64_tr_b16 a[246:247], v21 offset:4096
    v_mfma_f32_16x16x32_bf16 v[128:131], a[212:215], a[32:35], v[128:131]
    ds_read_b64_tr_b16 a[248:249], v22 offset:0
    v_mfma_f32_16x16x32_bf16 v[132:135], a[212:215], a[36:39], v[132:135]
    ds_read_b64_tr_b16 a[250:251], v22 offset:4096
    v_mfma_f32_16x16x32_bf16 v[136:139], a[212:215], a[40:43], v[136:139]
    ds_read_b64_tr_b16 a[252:253], v23 offset:0
    v_mfma_f32_16x16x32_bf16 v[140:143], a[212:215], a[44:47], v[140:143]
    ds_read_b64_tr_b16 a[254:255], v23 offset:4096
    v_mfma_f32_16x16x32_bf16 v[144:147], a[216:219], a[32:35], v[144:147]
    v_mfma_f32_16x16x32_bf16 v[148:151], a[216:219], a[36:39], v[148:151]
    v_mfma_f32_16x16x32_bf16 v[152:155], a[216:219], a[40:43], v[152:155]
    v_mfma_f32_16x16x32_bf16 v[156:159], a[216:219], a[44:47], v[156:159]
    v_mfma_f32_16x16x32_bf16 v[160:163], a[220:223], a[32:35], v[160:163]
    v_mfma_f32_16x16x32_bf16 v[164:167], a[220:223], a[36:39], v[164:167]
    v_mfma_f32_16x16x32_bf16 v[168:171], a[220:223], a[40:43], v[168:171]
    v_mfma_f32_16x16x32_bf16 v[172:175], a[220:223], a[44:47], v[172:175]
    s_waitcnt vmcnt(16) lgkmcnt(0)
    v_mfma_f32_16x16x32_bf16 v[80:83], a[232:235], a[48:51], v[80:83]
    ds_read_b64_tr_b16 a[160:161], v16 offset:16384
    v_mfma_f32_16x16x32_bf16 v[84:87], a[232:235], a[52:55], v[84:87]
    ds_read_b64_tr_b16 a[162:163], v16 offset:20480
    v_mfma_f32_16x16x32_bf16 v[88:91], a[232:235], a[56:59], v[88:91]
    ds_read_b64_tr_b16 a[164:165], v17 offset:16384
    v_mfma_f32_16x16x32_bf16 v[92:95], a[232:235], a[60:63], v[92:95]
    ds_read_b64_tr_b16 a[166:167], v17 offset:20480
    v_mfma_f32_16x16x32_bf16 v[96:99], a[236:239], a[48:51], v[96:99]
    ds_read_b64_tr_b16 a[200:201], v18 offset:16384
    v_mfma_f32_16x16x32_bf16 v[100:103], a[236:239], a[52:55], v[100:103]
    ds_read_b64_tr_b16 a[202:203], v18 offset:20480
    v_mfma_f32_16x16x32_bf16 v[104:107], a[236:239], a[56:59], v[104:107]
    ds_read_b64_tr_b16 a[204:205], v19 offset:16384
    v_mfma_f32_16x16x32_bf16 v[108:111], a[236:239], a[60:63], v[108:111]
    ds_read_b64_tr_b16 a[206:207], v19 offset:20480
    v_mfma_f32_16x16x32_bf16 v[112:115], a[240:243], a[48:51], v[112:115]
    ds_read_b64_tr_b16 a[208:209], v20 offset:16384
    s_lshl_b32 s3, s40, 14
    v_mfma_f32_16x16x32_bf16 v[116:119], a[240:243], a[52:55], v[116:119]
    ds_read_b64_tr_b16 a[210:211], v20 offset:20480
    s_add_u32 s65, s3, 0x18000
    v_mfma_f32_16x16x32_bf16 v[120:123], a[240:243], a[56:59], v[120:123]
    ds_read_b64_tr_b16 a[212:213], v21 offset:16384
    v_add_u32 v9, s65, v15
    v_mfma_f32_16x16x32_bf16 v[124:127], a[240:243], a[60:63], v[124:127]
    ds_read_b64_tr_b16 a[214:215], v21 offset:20480
    s_xor_b32 s3, s3, 0x8000
    v_mfma_f32_16x16x32_bf16 v[128:131], a[244:247], a[48:51], v[128:131]
    ds_read_b64_tr_b16 a[216:217], v22 offset:16384
    s_add_u32 s65, s3, 0x18000
    v_mfma_f32_16x16x32_bf16 v[132:135], a[244:247], a[52:55], v[132:135]
    ds_read_b64_tr_b16 a[218:219], v22 offset:20480
    v_add_u32 v10, s65, v15
    v_mfma_f32_16x16x32_bf16 v[136:139], a[244:247], a[56:59], v[136:139]
    ds_read_b64_tr_b16 a[220:221], v23 offset:16384
    s_lshl_b32 s3, s41, 1
    v_mfma_f32_16x16x32_bf16 v[140:143], a[244:247], a[60:63], v[140:143]
    ds_read_b64_tr_b16 a[222:223], v23 offset:20480
    s_add_u32 s3, s3, s95
    v_mfma_f32_16x16x32_bf16 v[144:147], a[248:251], a[48:51], v[144:147]
    s_lshl_b32 s3, s3, 2
    v_mfma_f32_16x16x32_bf16 v[148:151], a[248:251], a[52:55], v[148:151]
    s_add_u32 s3, s3, s94
    v_mfma_f32_16x16x32_bf16 v[152:155], a[248:251], a[56:59], v[152:155]
    s_lshl_b32 s65, s3, 11
    v_mfma_f32_16x16x32_bf16 v[156:159], a[248:251], a[60:63], v[156:159]
    s_mul_i32 s3, s3, 98304
    v_mfma_f32_16x16x32_bf16 v[160:163], a[252:255], a[48:51], v[160:163]
    s_add_u32 s3, s3, 20971520
    v_mfma_f32_16x16x32_bf16 v[164:167], a[252:255], a[52:55], v[164:167]
    s_add_u32 s28, s18, s3
    v_mfma_f32_16x16x32_bf16 v[168:171], a[252:255], a[56:59], v[168:171]
    s_addc_u32 s29, s19, 0
    v_mfma_f32_16x16x32_bf16 v[172:175], a[252:255], a[60:63], v[172:175]
    s_mov_b32 s30, 98304
    s_waitcnt vmcnt(12) lgkmcnt(0)
    s_barrier
    v_mfma_f32_16x16x32_bf16 v[80:83], a[200:203], a[72:75], v[80:83]
    ds_read_b64_tr_b16 a[168:169], v24 offset:0
    s_add_u32 s65, s65, 1048576
    s_lshl_b32 s66, s40, 7
    v_mfma_f32_16x16x32_bf16 v[84:87], a[200:203], a[76:79], v[84:87]
    ds_read_b64_tr_b16 a[170:171], v24 offset:4096
    s_add_u32 s65, s65, s66
    s_lshl_b32 s66, s93, 9
    v_mfma_f32_16x16x32_bf16 v[88:91], a[200:203], a[80:83], v[88:91]
    ds_read_b64_tr_b16 a[172:173], v25 offset:0
    s_add_u32 s66, s66, s65
    v_mfma_f32_16x16x32_bf16 v[92:95], a[200:203], a[84:87], v[92:95]
    ds_read_b64_tr_b16 a[174:175], v25 offset:4096
    v_mov_b32 v13, 0
    v_min_u32 v11, 2, v6
    v_mfma_f32_16x16x32_bf16 v[96:99], a[204:207], a[72:75], v[96:99]
    ds_read_b64_tr_b16 a[232:233], v26 offset:0
    v_sub_u32 v11, s93, v11
    v_mfma_f32_16x16x32_bf16 v[100:103], a[204:207], a[76:79], v[100:103]
    ds_read_b64_tr_b16 a[234:235], v26 offset:4096
    v_add_u32 v11, 3, v11
    v_and_b32 v11, 3, v11
    v_mfma_f32_16x16x32_bf16 v[104:107], a[204:207], a[80:83], v[104:107]
    ds_read_b64_tr_b16 a[236:237], v27 offset:0
    v_lshlrev_b32 v11, 9, v11
    s_mov_b32 s86, 1179648
    v_mfma_f32_16x16x32_bf16 v[108:111], a[204:207], a[84:87], v[108:111]
    ds_read_b64_tr_b16 a[238:239], v27 offset:4096
    v_lshlrev_b32 v12, 10, v4
    v_mfma_f32_16x16x32_bf16 v[112:115], a[208:211], a[72:75], v[112:115]
    ds_read_b64_tr_b16 a[240:241], v28 offset:0
    v_lshl_add_u32 v12, v3, 4, v12
    s_lshl_b32 s3, s95, 2
    v_mfma_f32_16x16x32_bf16 v[116:119], a[208:211], a[76:79], v[116:119]
    ds_read_b64_tr_b16 a[242:243], v28 offset:4096
    s_add_u32 s3, s3, s40
    v_mfma_f32_16x16x32_bf16 v[120:123], a[208:211], a[80:83], v[120:123]
    ds_read_b64_tr_b16 a[244:245], v29 offset:0
    s_mov_b32 s56, s28
    s_mov_b32 s57, s29
    v_mfma_f32_16x16x32_bf16 v[124:127], a[208:211], a[84:87], v[124:127]
    ds_read_b64_tr_b16 a[246:247], v29 offset:4096
    s_cmp_eq_u32 s3, 7
    v_mfma_f32_16x16x32_bf16 v[128:131], a[212:215], a[72:75], v[128:131]
    ds_read_b64_tr_b16 a[248:249], v30 offset:0
    s_cselect_b32 s58, 0, s30
    s_add_u32 s3, s93, 1
    v_mfma_f32_16x16x32_bf16 v[132:135], a[212:215], a[76:79], v[132:135]
    ds_read_b64_tr_b16 a[250:251], v30 offset:4096
    s_and_b32 s3, s3, 3
    s_mul_i32 s3, s3, 12
    v_mfma_f32_16x16x32_bf16 v[136:139], a[212:215], a[80:83], v[136:139]
    ds_read_b64_tr_b16 a[252:253], v31 offset:0
    s_add_u32 s3, s3, s40
    v_mfma_f32_16x16x32_bf16 v[140:143], a[212:215], a[84:87], v[140:143]
    ds_read_b64_tr_b16 a[254:255], v31 offset:4096
    s_lshl_b32 s3, s3, 11
    s_add_u32 s44, s3, 0
    v_mfma_f32_16x16x32_bf16 v[144:147], a[216:219], a[72:75], v[144:147]
    s_add_u32 s3, s93, 2
    v_mfma_f32_16x16x32_bf16 v[148:151], a[216:219], a[76:79], v[148:151]
    s_and_b32 s3, s3, 3
    s_mul_i32 s3, s3, 12
    v_mfma_f32_16x16x32_bf16 v[152:155], a[216:219], a[80:83], v[152:155]
    s_add_u32 s3, s3, s40
    s_lshl_b32 s3, s3, 11
    v_mfma_f32_16x16x32_bf16 v[156:159], a[216:219], a[84:87], v[156:159]
    s_add_u32 s45, s3, 8192
    v_mfma_f32_16x16x32_bf16 v[160:163], a[220:223], a[72:75], v[160:163]
    s_add_u32 s3, s93, 3
    s_and_b32 s3, s3, 3
    v_mfma_f32_16x16x32_bf16 v[164:167], a[220:223], a[76:79], v[164:167]
    s_mul_i32 s3, s3, 12
    v_mfma_f32_16x16x32_bf16 v[168:171], a[220:223], a[80:83], v[168:171]
    s_add_u32 s3, s3, s40
    s_lshl_b32 s3, s3, 11
    v_mfma_f32_16x16x32_bf16 v[172:175], a[220:223], a[84:87], v[172:175]
    s_add_u32 s46, s3, 16384
    s_waitcnt vmcnt(8) lgkmcnt(0)
    v_mfma_f32_16x16x32_bf16 v[80:83], a[232:235], a[96:99], v[80:83]
    ds_read_b64_tr_b16 a[176:177], v16 offset:49152
    ds_read_b64_tr_b16 a[178:179], v16 offset:53248
    v_mfma_f32_16x16x32_bf16 v[84:87], a[232:235], a[100:103], v[84:87]
    ds_read_b64_tr_b16 a[180:181], v17 offset:49152
    ds_read_b64_tr_b16 a[182:183], v17 offset:53248
    v_mfma_f32_16x16x32_bf16 v[88:91], a[232:235], a[104:107], v[88:91]
    ds_read_b64_tr_b16 a[200:201], v18 offset:49152
    v_mfma_f32_16x16x32_bf16 v[92:95], a[232:235], a[108:111], v[92:95]
    ds_read_b64_tr_b16 a[202:203], v18 offset:53248
    ds_read_b64_tr_b16 a[204:205], v19 offset:49152
    v_mfma_f32_16x16x32_bf16 v[96:99], a[236:239], a[96:99], v[96:99]
    ds_read_b64_tr_b16 a[206:207], v19 offset:53248
    v_mfma_f32_16x16x32_bf16 v[100:103], a[236:239], a[100:103], v[100:103]
    ds_read_b64_tr_b16 a[208:209], v20 offset:49152
    ds_read_b64_tr_b16 a[210:211], v20 offset:53248
    v_mfma_f32_16x16x32_bf16 v[104:107], a[236:239], a[104:107], v[104:107]
    ds_read_b64_tr_b16 a[212:213], v21 offset:49152
    ds_read_b64_tr_b16 a[214:215], v21 offset:53248
    v_mfma_f32_16x16x32_bf16 v[108:111], a[236:239], a[108:111], v[108:111]
    ds_read_b64_tr_b16 a[216:217], v22 offset:49152
    v_mfma_f32_16x16x32_bf16 v[112:115], a[240:243], a[96:99], v[112:115]
    ds_read_b64_tr_b16 a[218:219], v22 offset:53248
    ds_read_b64_tr_b16 a[220:221], v23 offset:49152
    v_mfma_f32_16x16x32_bf16 v[116:119], a[240:243], a[100:103], v[116:119]
    ds_read_b64_tr_b16 a[222:223], v23 offset:53248
    v_mfma_f32_16x16x32_bf16 v[120:123], a[240:243], a[104:107], v[120:123]
    ds_read_b64_tr_b16 a[184:185], v16 offset:32768
    ds_read_b64_tr_b16 a[186:187], v16 offset:36864
    v_mfma_f32_16x16x32_bf16 v[124:127], a[240:243], a[108:111], v[124:127]
    ds_read_b64_tr_b16 a[188:189], v17 offset:32768
    ds_read_b64_tr_b16 a[190:191], v17 offset:36864
    v_mfma_f32_16x16x32_bf16 v[128:131], a[244:247], a[96:99], v[128:131]
    ds_read_b64_tr_b16 v[208:209], v18 offset:32768
    v_mfma_f32_16x16x32_bf16 v[132:135], a[244:247], a[100:103], v[132:135]
    ds_read_b64_tr_b16 v[210:211], v18 offset:36864
    ds_read_b64_tr_b16 v[212:213], v19 offset:32768
    v_mfma_f32_16x16x32_bf16 v[136:139], a[244:247], a[104:107], v[136:139]
    ds_read_b64_tr_b16 v[214:215], v19 offset:36864
    v_mfma_f32_16x16x32_bf16 v[140:143], a[244:247], a[108:111], v[140:143]
    ds_read_b64_tr_b16 v[216:217], v20 offset:32768
    ds_read_b64_tr_b16 v[218:219], v20 offset:36864
    v_mfma_f32_16x16x32_bf16 v[144:147], a[248:251], a[96:99], v[144:147]
    ds_read_b64_tr_b16 v[220:221], v21 offset:32768
    ds_read_b64_tr_b16 v[222:223], v21 offset:36864
    v_mfma_f32_16x16x32_bf16 v[148:151], a[248:251], a[100:103], v[148:151]
    ds_read_b64_tr_b16 v[224:225], v22 offset:32768
    v_mfma_f32_16x16x32_bf16 v[152:155], a[248:251], a[104:107], v[152:155]
    ds_read_b64_tr_b16 v[226:227], v22 offset:36864
    ds_read_b64_tr_b16 v[228:229], v23 offset:32768
    v_mfma_f32_16x16x32_bf16 v[156:159], a[248:251], a[108:111], v[156:159]
    ds_read_b64_tr_b16 v[230:231], v23 offset:36864
    v_mfma_f32_16x16x32_bf16 v[160:163], a[252:255], a[96:99], v[160:163]
    v_mfma_f32_16x16x32_bf16 v[164:167], a[252:255], a[100:103], v[164:167]
    v_mfma_f32_16x16x32_bf16 v[168:171], a[252:255], a[104:107], v[168:171]
    v_mfma_f32_16x16x32_bf16 v[172:175], a[252:255], a[108:111], v[172:175]
    s_waitcnt vmcnt(0) lgkmcnt(0)
    s_cmp_ge_u32 s40, 2
    s_cbranch_scc1 L_red1
    v_mfma_f32_16x16x32_bf16 v[88:91], a[200:203], a[128:131], v[88:91]
    v_mfma_f32_16x16x32_bf16 v[92:95], a[200:203], a[132:135], v[92:95]
    v_mfma_f32_16x16x32_bf16 v[104:107], a[204:207], a[128:131], v[104:107]
    v_mfma_f32_16x16x32_bf16 v[108:111], a[204:207], a[132:135], v[108:111]
    v_mfma_f32_16x16x32_bf16 v[120:123], a[208:211], a[128:131], v[120:123]
    v_mfma_f32_16x16x32_bf16 v[124:127], a[208:211], a[132:135], v[124:127]
    v_mfma_f32_16x16x32_bf16 v[136:139], a[212:215], a[128:131], v[136:139]
    v_mfma_f32_16x16x32_bf16 v[140:143], a[212:215], a[132:135], v[140:143]
    v_mfma_f32_16x16x32_bf16 v[152:155], a[216:219], a[128:131], v[152:155]
    v_mfma_f32_16x16x32_bf16 v[156:159], a[216:219], a[132:135], v[156:159]
    v_mfma_f32_16x16x32_bf16 v[168:171], a[220:223], a[128:131], v[168:171]
    v_mfma_f32_16x16x32_bf16 v[172:175], a[220:223], a[132:135], v[172:175]
    v_mfma_f32_16x16x32_bf16 v[88:91], v[208:211], a[152:155], v[88:91]
    v_mfma_f32_16x16x32_bf16 v[92:95], v[208:211], a[156:159], v[92:95]
    v_mfma_f32_16x16x32_bf16 v[104:107], v[212:215], a[152:155], v[104:107]
    v_mfma_f32_16x16x32_bf16 v[108:111], v[212:215], a[156:159], v[108:111]
    v_mfma_f32_16x16x32_bf16 v[120:123], v[216:219], a[152:155], v[120:123]
    v_mfma_f32_16x16x32_bf16 v[124:127], v[216:219], a[156:159], v[124:127]
    v_mfma_f32_16x16x32_bf16 v[136:139], v[220:223], a[152:155], v[136:139]
    v_mfma_f32_16x16x32_bf16 v[140:143], v[220:223], a[156:159], v[140:143]
    v_mfma_f32_16x16x32_bf16 v[152:155], v[224:227], a[152:155], v[152:155]
    v_mfma_f32_16x16x32_bf16 v[156:159], v[224:227], a[156:159], v[156:159]
    ds_write_b128 v9, v[88:91] offset:4096
    v_mfma_f32_16x16x32_bf16 v[168:171], v[228:231], a[152:155], v[168:171]
    v_mfma_f32_16x16x32_bf16 v[172:175], v[228:231], a[156:159], v[172:175]
    ds_write_b128 v9, v[92:95] offset:5120
    v_mfma_f32_16x16x32_bf16 v[80:83], a[200:203], a[120:123], v[80:83]
    v_mfma_f32_16x16x32_bf16 v[84:87], a[200:203], a[124:127], v[84:87]
    ds_write_b128 v9, v[104:107] offset:6144
    v_mfma_f32_16x16x32_bf16 v[96:99], a[204:207], a[120:123], v[96:99]
    v_mfma_f32_16x16x32_bf16 v[100:103], a[204:207], a[124:127], v[100:103]
    ds_write_b128 v9, v[108:111] offset:7168
    v_mfma_f32_16x16x32_bf16 v[112:115], a[208:211], a[120:123], v[112:115]
    v_mfma_f32_16x16x32_bf16 v[116:119], a[208:211], a[124:127], v[116:119]
    ds_write_b128 v9, v[120:123] offset:8192
    v_mfma_f32_16x16x32_bf16 v[128:131], a[212:215], a[120:123], v[128:131]
    v_mfma_f32_16x16x32_bf16 v[132:135], a[212:215], a[124:127], v[132:135]
    ds_write_b128 v9, v[124:127] offset:9216
    v_mfma_f32_16x16x32_bf16 v[144:147], a[216:219], a[120:123], v[144:147]
    v_mfma_f32_16x16x32_bf16 v[148:151], a[216:219], a[124:127], v[148:151]
    ds_write_b128 v9, v[136:139] offset:10240
    v_mfma_f32_16x16x32_bf16 v[160:163], a[220:223], a[120:123], v[160:163]
    v_mfma_f32_16x16x32_bf16 v[164:167], a[220:223], a[124:127], v[164:167]
    ds_write_b128 v9, v[140:143] offset:11264
    v_mfma_f32_16x16x32_bf16 v[80:83], v[208:211], a[144:147], v[80:83]
    v_mfma_f32_16x16x32_bf16 v[84:87], v[208:211], a[148:151], v[84:87]
    ds_write_b128 v9, v[152:155] offset:12288
    v_mfma_f32_16x16x32_bf16 v[96:99], v[212:215], a[144:147], v[96:99]
    v_mfma_f32_16x16x32_bf16 v[100:103], v[212:215], a[148:151], v[100:103]
    ds_write_b128 v9, v[156:159] offset:13312
    v_mfma_f32_16x16x32_bf16 v[112:115], v[216:219], a[144:147], v[112:115]
    v_mfma_f32_16x16x32_bf16 v[116:119], v[216:219], a[148:151], v[116:119]
    ds_write_b128 v9, v[168:171] offset:14336
    v_mfma_f32_16x16x32_bf16 v[128:131], v[220:223], a[144:147], v[128:131]
    v_mfma_f32_16x16x32_bf16 v[132:135], v[220:223], a[148:151], v[132:135]
    ds_write_b128 v9, v[172:175] offset:15360
    v_mfma_f32_16x16x32_bf16 v[144:147], v[224:227], a[144:147], v[144:147]
    v_mfma_f32_16x16x32_bf16 v[148:151], v[224:227], a[148:151], v[148:151]
    v_mfma_f32_16x16x32_bf16 v[160:163], v[228:231], a[144:147], v[160:163]
    v_mfma_f32_16x16x32_bf16 v[164:167], v[228:231], a[148:151], v[164:167]
    s_waitcnt lgkmcnt(0)
    s_barrier
    ds_read_b128 v[192:195], v10 offset:4096
    ds_read_b128 v[196:199], v10 offset:5120
    ds_read_b128 v[200:203], v10 offset:6144
    ds_read_b128 v[204:207], v10 offset:7168
    ds_read_b128 v[208:211], v10 offset:8192
    ds_read_b128 v[212:215], v10 offset:9216
    ds_read_b128 v[216:219], v10 offset:10240
    ds_read_b128 v[220:223], v10 offset:11264
    ds_read_b128 v[224:227], v10 offset:12288
    ds_read_b128 v[228:231], v10 offset:13312
    ds_read_b128 v[232:235], v10 offset:14336
    ds_read_b128 v[236:239], v10 offset:15360
    s_waitcnt lgkmcnt(8)
    v_add_f32 v192, v192, v80
    v_add_f32 v193, v193, v81
    v_add_f32 v194, v194, v82
    v_add_f32 v195, v195, v83
    v_add_f32 v196, v196, v84
    v_add_f32 v197, v197, v85
    v_add_f32 v198, v198, v86
    v_add_f32 v199, v199, v87
    v_add_f32 v200, v200, v96
    v_add_f32 v201, v201, v97
    v_add_f32 v202, v202, v98
    v_add_f32 v203, v203, v99
    v_add_f32 v204, v204, v100
    v_add_f32 v205, v205, v101
    v_add_f32 v206, v206, v102
    v_add_f32 v207, v207, v103
    v_cvt_pk_bf16_f32 v80, v192, v193
    v_cvt_pk_bf16_f32 v81, v194, v195
    v_cvt_pk_bf16_f32 v82, v200, v201
    v_cvt_pk_bf16_f32 v83, v202, v203
    buffer_store_dwordx4 v[80:83], v15, s[28:31], s44 offen offset:0 sc1
    v_cvt_pk_bf16_f32 v88, v196, v197
    v_cvt_pk_bf16_f32 v89, v198, v199
    v_cvt_pk_bf16_f32 v90, v204, v205
    v_cvt_pk_bf16_f32 v91, v206, v207
    buffer_store_dwordx4 v[88:91], v15, s[56:59], s44 offen offset:1024 sc1
    s_waitcnt lgkmcnt(4)
    v_add_f32 v208, v208, v112
    v_add_f32 v209, v209, v113
    v_add_f32 v210, v210, v114
    v_add_f32 v211, v211, v115
    v_add_f32 v212, v212, v116
    v_add_f32 v213, v213, v117
    v_add_f32 v214, v214, v118
    v_add_f32 v215, v215, v119
    v_add_f32 v216, v216, v128
    v_add_f32 v217, v217, v129
    v_add_f32 v218, v218, v130
    v_add_f32 v219, v219, v131
    v_add_f32 v220, v220, v132
    v_add_f32 v221, v221, v133
    v_add_f32 v222, v222, v134
    v_add_f32 v223, v223, v135
    v_cvt_pk_bf16_f32 v112, v208, v209
    v_cvt_pk_bf16_f32 v113, v210, v211
    v_cvt_pk_bf16_f32 v114, v216, v217
    v_cvt_pk_bf16_f32 v115, v218, v219
    buffer_store_dwordx4 v[112:115], v15, s[28:31], s45 offen offset:0 sc1
    v_cvt_pk_bf16_f32 v120, v212, v213
    v_cvt_pk_bf16_f32 v121, v214, v215
    v_cvt_pk_bf16_f32 v122, v220, v221
    v_cvt_pk_bf16_f32 v123, v222, v223
    buffer_store_dwordx4 v[120:123], v15, s[56:59], s45 offen offset:1024 sc1
    s_waitcnt lgkmcnt(0)
    v_add_f32 v224, v224, v144
    v_add_f32 v225, v225, v145
    v_add_f32 v226, v226, v146
    v_add_f32 v227, v227, v147
    v_add_f32 v228, v228, v148
    v_add_f32 v229, v229, v149
    v_add_f32 v230, v230, v150
    v_add_f32 v231, v231, v151
    v_add_f32 v232, v232, v160
    v_add_f32 v233, v233, v161
    v_add_f32 v234, v234, v162
    v_add_f32 v235, v235, v163
    v_add_f32 v236, v236, v164
    v_add_f32 v237, v237, v165
    v_add_f32 v238, v238, v166
    v_add_f32 v239, v239, v167
    v_cvt_pk_bf16_f32 v144, v224, v225
    v_cvt_pk_bf16_f32 v145, v226, v227
    v_cvt_pk_bf16_f32 v146, v232, v233
    v_cvt_pk_bf16_f32 v147, v234, v235
    buffer_store_dwordx4 v[144:147], v15, s[28:31], s46 offen offset:0 sc1
    v_cvt_pk_bf16_f32 v152, v228, v229
    v_cvt_pk_bf16_f32 v153, v230, v231
    v_cvt_pk_bf16_f32 v154, v236, v237
    v_cvt_pk_bf16_f32 v155, v238, v239
    buffer_store_dwordx4 v[152:155], v15, s[56:59], s46 offen offset:1024 sc1
    v_mfma_f32_16x16x32_bf16 v[56:59], a[64:67], a[8:11], v[56:59]
    s_mul_i32 s68, s93, 12
    v_mfma_f32_16x16x32_bf16 v[60:63], a[64:67], a[12:15], v[60:63]
    s_add_u32 s68, s68, s40
    v_mfma_f32_16x16x32_bf16 v[72:75], a[68:71], a[8:11], v[72:75]
    s_lshl_b32 s68, s68, 11
    v_mfma_f32_16x16x32_bf16 v[76:79], a[68:71], a[12:15], v[76:79]
    s_lshl_b32 s3, s95, 2
    v_mfma_f32_16x16x32_bf16 v[56:59], a[88:91], a[24:27], v[56:59]
    s_and_b32 s69, s40, 1
    v_mfma_f32_16x16x32_bf16 v[60:63], a[88:91], a[28:31], v[60:63]
    s_lshl_b32 s69, s69, 1
    v_mfma_f32_16x16x32_bf16 v[72:75], a[92:95], a[24:27], v[72:75]
    s_add_u32 s3, s3, s69
    v_mfma_f32_16x16x32_bf16 v[76:79], a[92:95], a[28:31], v[76:79]
    s_lshr_b32 s69, s40, 1
    v_mfma_f32_16x16x32_bf16 v[56:59], a[112:115], a[40:43], v[56:59]
    s_add_u32 s3, s3, s69
    v_mfma_f32_16x16x32_bf16 v[60:63], a[112:115], a[44:47], v[60:63]
    s_lshl_b32 s3, s3, 15
    v_mfma_f32_16x16x32_bf16 v[72:75], a[116:119], a[40:43], v[72:75]
    s_lshl_b32 s69, s94, 8
    v_mfma_f32_16x16x32_bf16 v[76:79], a[116:119], a[44:47], v[76:79]
    s_add_u32 s3, s3, s69
    v_mfma_f32_16x16x32_bf16 v[56:59], a[136:139], a[56:59], v[56:59]
    s_lshl_b32 s69, s93, 6
    v_mfma_f32_16x16x32_bf16 v[60:63], a[136:139], a[60:63], v[60:63]
    s_add_u32 s3, s3, s69
    v_mfma_f32_16x16x32_bf16 v[72:75], a[140:143], a[56:59], v[72:75]
    v_mfma_f32_16x16x32_bf16 v[76:79], a[140:143], a[60:63], v[76:79]
    v_mfma_f32_16x16x32_bf16 v[56:59], a[160:163], a[80:83], v[56:59]
    v_mfma_f32_16x16x32_bf16 v[60:63], a[160:163], a[84:87], v[60:63]
    v_mfma_f32_16x16x32_bf16 v[72:75], a[164:167], a[80:83], v[72:75]
    v_mfma_f32_16x16x32_bf16 v[76:79], a[164:167], a[84:87], v[76:79]
    v_mfma_f32_16x16x32_bf16 v[56:59], a[168:171], a[104:107], v[56:59]
    v_mfma_f32_16x16x32_bf16 v[60:63], a[168:171], a[108:111], v[60:63]
    v_mfma_f32_16x16x32_bf16 v[72:75], a[172:175], a[104:107], v[72:75]
    v_mfma_f32_16x16x32_bf16 v[76:79], a[172:175], a[108:111], v[76:79]
    v_mfma_f32_16x16x32_bf16 v[56:59], a[176:179], a[128:131], v[56:59]
    v_mfma_f32_16x16x32_bf16 v[60:63], a[176:179], a[132:135], v[60:63]
    v_mfma_f32_16x16x32_bf16 v[72:75], a[180:183], a[128:131], v[72:75]
    v_mfma_f32_16x16x32_bf16 v[76:79], a[180:183], a[132:135], v[76:79]
    v_mfma_f32_16x16x32_bf16 v[56:59], a[184:187], a[152:155], v[56:59]
    v_mfma_f32_16x16x32_bf16 v[60:63], a[184:187], a[156:159], v[60:63]
    v_mfma_f32_16x16x32_bf16 v[72:75], a[188:191], a[152:155], v[72:75]
    v_mfma_f32_16x16x32_bf16 v[76:79], a[188:191], a[156:159], v[76:79]
    v_mfma_f32_16x16x32_bf16 v[48:51], a[64:67], a[0:3], v[48:51]
    v_mfma_f32_16x16x32_bf16 v[52:55], a[64:67], a[4:7], v[52:55]
    v_mfma_f32_16x16x32_bf16 v[64:67], a[68:71], a[0:3], v[64:67]
    v_mfma_f32_16x16x32_bf16 v[68:71], a[68:71], a[4:7], v[68:71]
    v_mfma_f32_16x16x32_bf16 v[48:51], a[88:91], a[16:19], v[48:51]
    ds_write_b128 v9, v[56:59] offset:0
    v_mfma_f32_16x16x32_bf16 v[52:55], a[88:91], a[20:23], v[52:55]
    v_mfma_f32_16x16x32_bf16 v[64:67], a[92:95], a[16:19], v[64:67]
    v_mfma_f32_16x16x32_bf16 v[68:71], a[92:95], a[20:23], v[68:71]
    v_mfma_f32_16x16x32_bf16 v[48:51], a[112:115], a[32:35], v[48:51]
    v_mfma_f32_16x16x32_bf16 v[52:55], a[112:115], a[36:39], v[52:55]
    v_mfma_f32_16x16x32_bf16 v[64:67], a[116:119], a[32:35], v[64:67]
    ds_write_b128 v9, v[60:63] offset:1024
    v_mfma_f32_16x16x32_bf16 v[68:71], a[116:119], a[36:39], v[68:71]
    v_mfma_f32_16x16x32_bf16 v[48:51], a[136:139], a[48:51], v[48:51]
    v_mfma_f32_16x16x32_bf16 v[52:55], a[136:139], a[52:55], v[52:55]
    v_mfma_f32_16x16x32_bf16 v[64:67], a[140:143], a[48:51], v[64:67]
    v_mfma_f32_16x16x32_bf16 v[68:71], a[140:143], a[52:55], v[68:71]
    v_mfma_f32_16x16x32_bf16 v[48:51], a[160:163], a[72:75], v[48:51]
    v_mfma_f32_16x16x32_bf16 v[52:55], a[160:163], a[76:79], v[52:55]
    ds_write_b128 v9, v[72:75] offset:2048
    v_mfma_f32_16x16x32_bf16 v[64:67], a[164:167], a[72:75], v[64:67]
    v_mfma_f32_16x16x32_bf16 v[68:71], a[164:167], a[76:79], v[68:71]
    v_mfma_f32_16x16x32_bf16 v[48:51], a[168:171], a[96:99], v[48:51]
    v_mfma_f32_16x16x32_bf16 v[52:55], a[168:171], a[100:103], v[52:55]
    v_mfma_f32_16x16x32_bf16 v[64:67], a[172:175], a[96:99], v[64:67]
    v_mfma_f32_16x16x32_bf16 v[68:71], a[172:175], a[100:103], v[68:71]
    ds_write_b128 v9, v[76:79] offset:3072
    v_mfma_f32_16x16x32_bf16 v[48:51], a[176:179], a[120:123], v[48:51]
    v_mfma_f32_16x16x32_bf16 v[52:55], a[176:179], a[124:127], v[52:55]
    v_mfma_f32_16x16x32_bf16 v[64:67], a[180:183], a[120:123], v[64:67]
    v_mfma_f32_16x16x32_bf16 v[68:71], a[180:183], a[124:127], v[68:71]
    v_mfma_f32_16x16x32_bf16 v[48:51], a[184:187], a[144:147], v[48:51]
    v_mfma_f32_16x16x32_bf16 v[52:55], a[184:187], a[148:151], v[52:55]
    v_mfma_f32_16x16x32_bf16 v[64:67], a[188:191], a[144:147], v[64:67]
    v_mfma_f32_16x16x32_bf16 v[68:71], a[188:191], a[148:151], v[68:71]
    s_waitcnt vmcnt(0)
    s_mov_b64 exec, 1
    buffer_store_dwordx2 v[44:45], v13, s[84:87], s66 offen sc1
    s_mov_b64 exec, -1
    s_waitcnt lgkmcnt(0)
    s_barrier
    ds_read_b128 v[176:179], v10 offset:0
    ds_read_b128 v[180:183], v10 offset:1024
    ds_read_b128 v[184:187], v10 offset:2048
    ds_read_b128 v[188:191], v10 offset:3072
    s_waitcnt lgkmcnt(0)
    v_add_f32 v176, v176, v48
    v_add_f32 v177, v177, v49
    v_add_f32 v178, v178, v50
    v_add_f32 v179, v179, v51
    v_add_f32 v180, v180, v52
    v_add_f32 v181, v181, v53
    v_add_f32 v182, v182, v54
    v_add_f32 v183, v183, v55
    v_add_f32 v184, v184, v64
    v_add_f32 v185, v185, v65
    v_add_f32 v186, v186, v66
    v_add_f32 v187, v187, v67
    v_add_f32 v188, v188, v68
    v_add_f32 v189, v189, v69
    v_add_f32 v190, v190, v70
    v_add_f32 v191, v191, v71
    s_branch L_poll2
L_red1:
    v_mfma_f32_16x16x32_bf16 v[80:83], a[200:203], a[120:123], v[80:83]
    v_mfma_f32_16x16x32_bf16 v[84:87], a[200:203], a[124:127], v[84:87]
    v_mfma_f32_16x16x32_bf16 v[96:99], a[204:207], a[120:123], v[96:99]
    v_mfma_f32_16x16x32_bf16 v[100:103], a[204:207], a[124:127], v[100:103]
    v_mfma_f32_16x16x32_bf16 v[112:115], a[208:211], a[120:123], v[112:115]
    v_mfma_f32_16x16x32_bf16 v[116:119], a[208:211], a[124:127], v[116:119]
    v_mfma_f32_16x16x32_bf16 v[128:131], a[212:215], a[120:123], v[128:131]
    v_mfma_f32_16x16x32_bf16 v[132:135], a[212:215], a[124:127], v[132:135]
    v_mfma_f32_16x16x32_bf16 v[144:147], a[216:219], a[120:123], v[144:147]
    v_mfma_f32_16x16x32_bf16 v[148:151], a[216:219], a[124:127], v[148:151]
    v_mfma_f32_16x16x32_bf16 v[160:163], a[220:223], a[120:123], v[160:163]
    v_mfma_f32_16x16x32_bf16 v[164:167], a[220:223], a[124:127], v[164:167]
    v_mfma_f32_16x16x32_bf16 v[80:83], v[208:211], a[144:147], v[80:83]
    v_mfma_f32_16x16x32_bf16 v[84:87], v[208:211], a[148:151], v[84:87]
    v_mfma_f32_16x16x32_bf16 v[96:99], v[212:215], a[144:147], v[96:99]
    v_mfma_f32_16x16x32_bf16 v[100:103], v[212:215], a[148:151], v[100:103]
    v_mfma_f32_16x16x32_bf16 v[112:115], v[216:219], a[144:147], v[112:115]
    v_mfma_f32_16x16x32_bf16 v[116:119], v[216:219], a[148:151], v[116:119]
    v_mfma_f32_16x16x32_bf16 v[128:131], v[220:223], a[144:147], v[128:131]
    v_mfma_f32_16x16x32_bf16 v[132:135], v[220:223], a[148:151], v[132:135]
    v_mfma_f32_16x16x32_bf16 v[144:147], v[224:227], a[144:147], v[144:147]
    v_mfma_f32_16x16x32_bf16 v[148:151], v[224:227], a[148:151], v[148:151]
    ds_write_b128 v9, v[80:83] offset:4096
    v_mfma_f32_16x16x32_bf16 v[160:163], v[228:231], a[144:147], v[160:163]
    v_mfma_f32_16x16x32_bf16 v[164:167], v[228:231], a[148:151], v[164:167]
    ds_write_b128 v9, v[84:87] offset:5120
    v_mfma_f32_16x16x32_bf16 v[88:91], a[200:203], a[128:131], v[88:91]
    v_mfma_f32_16x16x32_bf16 v[92:95], a[200:203], a[132:135], v[92:95]
    ds_write_b128 v9, v[96:99] offset:6144
    v_mfma_f32_16x16x32_bf16 v[104:107], a[204:207], a[128:131], v[104:107]
    v_mfma_f32_16x16x32_bf16 v[108:111], a[204:207], a[132:135], v[108:111]
    ds_write_b128 v9, v[100:103] offset:7168
    v_mfma_f32_16x16x32_bf16 v[120:123], a[208:211], a[128:131], v[120:123]
    v_mfma_f32_16x16x32_bf16 v[124:127], a[208:211], a[132:135], v[124:127]
    ds_write_b128 v9, v[112:115] offset:8192
    v_mfma_f32_16x16x32_bf16 v[136:139], a[212:215], a[128:131], v[136:139]
    v_mfma_f32_16x16x32_bf16 v[140:143], a[212:215], a[132:135], v[140:143]
    ds_write_b128 v9, v[116:119] offset:9216
    v_mfma_f32_16x16x32_bf16 v[152:155], a[216:219], a[128:131], v[152:155]
    v_mfma_f32_16x16x32_bf16 v[156:159], a[216:219], a[132:135], v[156:159]
    ds_write_b128 v9, v[128:131] offset:10240
    v_mfma_f32_16x16x32_bf16 v[168:171], a[220:223], a[128:131], v[168:171]
    v_mfma_f32_16x16x32_bf16 v[172:175], a[220:223], a[132:135], v[172:175]
    ds_write_b128 v9, v[132:135] offset:11264
    v_mfma_f32_16x16x32_bf16 v[88:91], v[208:211], a[152:155], v[88:91]
    v_mfma_f32_16x16x32_bf16 v[92:95], v[208:211], a[156:159], v[92:95]
    ds_write_b128 v9, v[144:147] offset:12288
    v_mfma_f32_16x16x32_bf16 v[104:107], v[212:215], a[152:155], v[104:107]
    v_mfma_f32_16x16x32_bf16 v[108:111], v[212:215], a[156:159], v[108:111]
    ds_write_b128 v9, v[148:151] offset:13312
    v_mfma_f32_16x16x32_bf16 v[120:123], v[216:219], a[152:155], v[120:123]
    v_mfma_f32_16x16x32_bf16 v[124:127], v[216:219], a[156:159], v[124:127]
    ds_write_b128 v9, v[160:163] offset:14336
    v_mfma_f32_16x16x32_bf16 v[136:139], v[220:223], a[152:155], v[136:139]
    v_mfma_f32_16x16x32_bf16 v[140:143], v[220:223], a[156:159], v[140:143]
    ds_write_b128 v9, v[164:167] offset:15360
    v_mfma_f32_16x16x32_bf16 v[152:155], v[224:227], a[152:155], v[152:155]
    v_mfma_f32_16x16x32_bf16 v[156:159], v[224:227], a[156:159], v[156:159]
    v_mfma_f32_16x16x32_bf16 v[168:171], v[228:231], a[152:155], v[168:171]
    v_mfma_f32_16x16x32_bf16 v[172:175], v[228:231], a[156:159], v[172:175]
    s_waitcnt lgkmcnt(0)
    s_barrier
    ds_read_b128 v[192:195], v10 offset:4096
    ds_read_b128 v[196:199], v10 offset:5120
    ds_read_b128 v[200:203], v10 offset:6144
    ds_read_b128 v[204:207], v10 offset:7168
    ds_read_b128 v[208:211], v10 offset:8192
    ds_read_b128 v[212:215], v10 offset:9216
    ds_read_b128 v[216:219], v10 offset:10240
    ds_read_b128 v[220:223], v10 offset:11264
    ds_read_b128 v[224:227], v10 offset:12288
    ds_read_b128 v[228:231], v10 offset:13312
    ds_read_b128 v[232:235], v10 offset:14336
    ds_read_b128 v[236:239], v10 offset:15360
    s_waitcnt lgkmcnt(8)
    v_add_f32 v192, v192, v88
    v_add_f32 v193, v193, v89
    v_add_f32 v194, v194, v90
    v_add_f32 v195, v195, v91
    v_add_f32 v196, v196, v92
    v_add_f32 v197, v197, v93
    v_add_f32 v198, v198, v94
    v_add_f32 v199, v199, v95
    v_add_f32 v200, v200, v104
    v_add_f32 v201, v201, v105
    v_add_f32 v202, v202, v106
    v_add_f32 v203, v203, v107
    v_add_f32 v204, v204, v108
    v_add_f32 v205, v205, v109
    v_add_f32 v206, v206, v110
    v_add_f32 v207, v207, v111
    v_cvt_pk_bf16_f32 v80, v192, v193
    v_cvt_pk_bf16_f32 v81, v194, v195
    v_cvt_pk_bf16_f32 v82, v200, v201
    v_cvt_pk_bf16_f32 v83, v202, v203
    buffer_store_dwordx4 v[80:83], v15, s[28:31], s44 offen offset:0 sc1
    v_cvt_pk_bf16_f32 v88, v196, v197
    v_cvt_pk_bf16_f32 v89, v198, v199
    v_cvt_pk_bf16_f32 v90, v204, v205
    v_cvt_pk_bf16_f32 v91, v206, v207
    buffer_store_dwordx4 v[88:91], v15, s[56:59], s44 offen offset:1024 sc1
    s_waitcnt lgkmcnt(4)
    v_add_f32 v208, v208, v120
    v_add_f32 v209, v209, v121
    v_add_f32 v210, v210, v122
    v_add_f32 v211, v211, v123
    v_add_f32 v212, v212, v124
    v_add_f32 v213, v213, v125
    v_add_f32 v214, v214, v126
    v_add_f32 v215, v215, v127
    v_add_f32 v216, v216, v136
    v_add_f32 v217, v217, v137
    v_add_f32 v218, v218, v138
    v_add_f32 v219, v219, v139
    v_add_f32 v220, v220, v140
    v_add_f32 v221, v221, v141
    v_add_f32 v222, v222, v142
    v_add_f32 v223, v223, v143
    v_cvt_pk_bf16_f32 v112, v208, v209
    v_cvt_pk_bf16_f32 v113, v210, v211
    v_cvt_pk_bf16_f32 v114, v216, v217
    v_cvt_pk_bf16_f32 v115, v218, v219
    buffer_store_dwordx4 v[112:115], v15, s[28:31], s45 offen offset:0 sc1
    v_cvt_pk_bf16_f32 v120, v212, v213
    v_cvt_pk_bf16_f32 v121, v214, v215
    v_cvt_pk_bf16_f32 v122, v220, v221
    v_cvt_pk_bf16_f32 v123, v222, v223
    buffer_store_dwordx4 v[120:123], v15, s[56:59], s45 offen offset:1024 sc1
    s_waitcnt lgkmcnt(0)
    v_add_f32 v224, v224, v152
    v_add_f32 v225, v225, v153
    v_add_f32 v226, v226, v154
    v_add_f32 v227, v227, v155
    v_add_f32 v228, v228, v156
    v_add_f32 v229, v229, v157
    v_add_f32 v230, v230, v158
    v_add_f32 v231, v231, v159
    v_add_f32 v232, v232, v168
    v_add_f32 v233, v233, v169
    v_add_f32 v234, v234, v170
    v_add_f32 v235, v235, v171
    v_add_f32 v236, v236, v172
    v_add_f32 v237, v237, v173
    v_add_f32 v238, v238, v174
    v_add_f32 v239, v239, v175
    v_cvt_pk_bf16_f32 v144, v224, v225
    v_cvt_pk_bf16_f32 v145, v226, v227
    v_cvt_pk_bf16_f32 v146, v232, v233
    v_cvt_pk_bf16_f32 v147, v234, v235
    buffer_store_dwordx4 v[144:147], v15, s[28:31], s46 offen offset:0 sc1
    v_cvt_pk_bf16_f32 v152, v228, v229
    v_cvt_pk_bf16_f32 v153, v230, v231
    v_cvt_pk_bf16_f32 v154, v236, v237
    v_cvt_pk_bf16_f32 v155, v238, v239
    buffer_store_dwordx4 v[152:155], v15, s[56:59], s46 offen offset:1024 sc1
    v_mfma_f32_16x16x32_bf16 v[48:51], a[64:67], a[0:3], v[48:51]
    s_mul_i32 s68, s93, 12
    v_mfma_f32_16x16x32_bf16 v[52:55], a[64:67], a[4:7], v[52:55]
    s_add_u32 s68, s68, s40
    v_mfma_f32_16x16x32_bf16 v[64:67], a[68:71], a[0:3], v[64:67]
    s_lshl_b32 s68, s68, 11
    v_mfma_f32_16x16x32_bf16 v[68:71], a[68:71], a[4:7], v[68:71]
    s_lshl_b32 s3, s95, 2
    v_mfma_f32_16x16x32_bf16 v[48:51], a[88:91], a[16:19], v[48:51]
    s_and_b32 s69, s40, 1
    v_mfma_f32_16x16x32_bf16 v[52:55], a[88:91], a[20:23], v[52:55]
    s_lshl_b32 s69, s69, 1
    v_mfma_f32_16x16x32_bf16 v[64:67], a[92:95], a[16:19], v[64:67]
    s_add_u32 s3, s3, s69
    v_mfma_f32_16x16x32_bf16 v[68:71], a[92:95], a[20:23], v[68:71]
    s_lshr_b32 s69, s40, 1
    v_mfma_f32_16x16x32_bf16 v[48:51], a[112:115], a[32:35], v[48:51]
    s_add_u32 s3, s3, s69
    v_mfma_f32_16x16x32_bf16 v[52:55], a[112:115], a[36:39], v[52:55]
    s_lshl_b32 s3, s3, 15
    v_mfma_f32_16x16x32_bf16 v[64:67], a[116:119], a[32:35], v[64:67]
    s_lshl_b32 s69, s94, 8
    v_mfma_f32_16x16x32_bf16 v[68:71], a[116:119], a[36:39], v[68:71]
    s_add_u32 s3, s3, s69
    v_mfma_f32_16x16x32_bf16 v[48:51], a[136:139], a[48:51], v[48:51]
    s_lshl_b32 s69, s93, 6
    v_mfma_f32_16x16x32_bf16 v[52:55], a[136:139], a[52:55], v[52:55]
    s_add_u32 s3, s3, s69
    v_mfma_f32_16x16x32_bf16 v[64:67], a[140:143], a[48:51], v[64:67]
    v_mfma_f32_16x16x32_bf16 v[68:71], a[140:143], a[52:55], v[68:71]
    v_mfma_f32_16x16x32_bf16 v[48:51], a[160:163], a[72:75], v[48:51]
    v_mfma_f32_16x16x32_bf16 v[52:55], a[160:163], a[76:79], v[52:55]
    v_mfma_f32_16x16x32_bf16 v[64:67], a[164:167], a[72:75], v[64:67]
    v_mfma_f32_16x16x32_bf16 v[68:71], a[164:167], a[76:79], v[68:71]
    v_mfma_f32_16x16x32_bf16 v[48:51], a[168:171], a[96:99], v[48:51]
    v_mfma_f32_16x16x32_bf16 v[52:55], a[168:171], a[100:103], v[52:55]
    v_mfma_f32_16x16x32_bf16 v[64:67], a[172:175], a[96:99], v[64:67]
    v_mfma_f32_16x16x32_bf16 v[68:71], a[172:175], a[100:103], v[68:71]
    v_mfma_f32_16x16x32_bf16 v[48:51], a[176:179], a[120:123], v[48:51]
    v_mfma_f32_16x16x32_bf16 v[52:55], a[176:179], a[124:127], v[52:55]
    v_mfma_f32_16x16x32_bf16 v[64:67], a[180:183], a[120:123], v[64:67]
    v_mfma_f32_16x16x32_bf16 v[68:71], a[180:183], a[124:127], v[68:71]
    v_mfma_f32_16x16x32_bf16 v[48:51], a[184:187], a[144:147], v[48:51]
    v_mfma_f32_16x16x32_bf16 v[52:55], a[184:187], a[148:151], v[52:55]
    v_mfma_f32_16x16x32_bf16 v[64:67], a[188:191], a[144:147], v[64:67]
    v_mfma_f32_16x16x32_bf16 v[68:71], a[188:191], a[148:151], v[68:71]
    v_mfma_f32_16x16x32_bf16 v[56:59], a[64:67], a[8:11], v[56:59]
    v_mfma_f32_16x16x32_bf16 v[60:63], a[64:67], a[12:15], v[60:63]
    v_mfma_f32_16x16x32_bf16 v[72:75], a[68:71], a[8:11], v[72:75]
    v_mfma_f32_16x16x32_bf16 v[76:79], a[68:71], a[12:15], v[76:79]
    v_mfma_f32_16x16x32_bf16 v[56:59], a[88:91], a[24:27], v[56:59]
    ds_write_b128 v9, v[48:51] offset:0
    v_mfma_f32_16x16x32_bf16 v[60:63], a[88:91], a[28:31], v[60:63]
    v_mfma_f32_16x16x32_bf16 v[72:75], a[92:95], a[24:27], v[72:75]
    v_mfma_f32_16x16x32_bf16 v[76:79], a[92:95], a[28:31], v[76:79]
    v_mfma_f32_16x16x32_bf16 v[56:59], a[112:115], a[40:43], v[56:59]
    v_mfma_f32_16x16x32_bf16 v[60:63], a[112:115], a[44:47], v[60:63]
    v_mfma_f32_16x16x32_bf16 v[72:75], a[116:119], a[40:43], v[72:75]
    ds_write_b128 v9, v[52:55] offset:1024
    v_mfma_f32_16x16x32_bf16 v[76:79], a[116:119], a[44:47], v[76:79]
    v_mfma_f32_16x16x32_bf16 v[56:59], a[136:139], a[56:59], v[56:59]
    v_mfma_f32_16x16x32_bf16 v[60:63], a[136:139], a[60:63], v[60:63]
    v_mfma_f32_16x16x32_bf16 v[72:75], a[140:143], a[56:59], v[72:75]
    v_mfma_f32_16x16x32_bf16 v[76:79], a[140:143], a[60:63], v[76:79]
    v_mfma_f32_16x16x32_bf16 v[56:59], a[160:163], a[80:83], v[56:59]
    v_mfma_f32_16x16x32_bf16 v[60:63], a[160:163], a[84:87], v[60:63]
    ds_write_b128 v9, v[64:67] offset:2048
    v_mfma_f32_16x16x32_bf16 v[72:75], a[164:167], a[80:83], v[72:75]
    v_mfma_f32_16x16x32_bf16 v[76:79], a[164:167], a[84:87], v[76:79]
    v_mfma_f32_16x16x32_bf16 v[56:59], a[168:171], a[104:107], v[56:59]
    v_mfma_f32_16x16x32_bf16 v[60:63], a[168:171], a[108:111], v[60:63]
    v_mfma_f32_16x16x32_bf16 v[72:75], a[172:175], a[104:107], v[72:75]
    v_mfma_f32_16x16x32_bf16 v[76:79], a[172:175], a[108:111], v[76:79]
    ds_write_b128 v9, v[68:71] offset:3072
    v_mfma_f32_16x16x32_bf16 v[56:59], a[176:179], a[128:131], v[56:59]
    v_mfma_f32_16x16x32_bf16 v[60:63], a[176:179], a[132:135], v[60:63]
    v_mfma_f32_16x16x32_bf16 v[72:75], a[180:183], a[128:131], v[72:75]
    v_mfma_f32_16x16x32_bf16 v[76:79], a[180:183], a[132:135], v[76:79]
    v_mfma_f32_16x16x32_bf16 v[56:59], a[184:187], a[152:155], v[56:59]
    v_mfma_f32_16x16x32_bf16 v[60:63], a[184:187], a[156:159], v[60:63]
    v_mfma_f32_16x16x32_bf16 v[72:75], a[188:191], a[152:155], v[72:75]
    v_mfma_f32_16x16x32_bf16 v[76:79], a[188:191], a[156:159], v[76:79]
    s_waitcnt vmcnt(0)
    s_mov_b64 exec, 1
    buffer_store_dwordx2 v[44:45], v13, s[84:87], s66 offen sc1
    s_mov_b64 exec, -1
    s_waitcnt lgkmcnt(0)
    s_barrier
    ds_read_b128 v[176:179], v10 offset:0
    ds_read_b128 v[180:183], v10 offset:1024
    ds_read_b128 v[184:187], v10 offset:2048
    ds_read_b128 v[188:191], v10 offset:3072
    s_waitcnt lgkmcnt(0)
    v_add_f32 v176, v176, v56
    v_add_f32 v177, v177, v57
    v_add_f32 v178, v178, v58
    v_add_f32 v179, v179, v59
    v_add_f32 v180, v180, v60
    v_add_f32 v181, v181, v61
    v_add_f32 v182, v182, v62
    v_add_f32 v183, v183, v63
    v_add_f32 v184, v184, v72
    v_add_f32 v185, v185, v73
    v_add_f32 v186, v186, v74
    v_add_f32 v187, v187, v75
    v_add_f32 v188, v188, v76
    v_add_f32 v189, v189, v77
    v_add_f32 v190, v190, v78
    v_add_f32 v191, v191, v79
L_poll2:
    buffer_load_dwordx2 v[252:253], v11, s[84:87], s65 offen sc1
    s_waitcnt vmcnt(0)
    v_cmp_ne_u64 vcc, v[252:253], v[44:45]
    s_add_u32 s49, s49, 1
    s_cmp_ge_u32 s49, 0x80000
    s_cbranch_scc1 L_end
    s_cbranch_vccnz L_poll2
L_ready2:
    buffer_load_dwordx4 v[48:51], v15, s[28:31], s68 offen offset:0 sc1
    buffer_load_dwordx4 v[52:55], v15, s[56:59], s68 offen offset:1024 sc1
    s_add_u32 s68, s68, 8192
    buffer_load_dwordx4 v[56:59], v15, s[28:31], s68 offen offset:0 sc1
    buffer_load_dwordx4 v[60:63], v15, s[56:59], s68 offen offset:1024 sc1
    s_add_u32 s68, s68, 8192
    buffer_load_dwordx4 v[64:67], v15, s[28:31], s68 offen offset:0 sc1
    buffer_load_dwordx4 v[68:71], v15, s[56:59], s68 offen offset:1024 sc1
    s_waitcnt vmcnt(4)
    v_lshlrev_b32 v80, 16, v48
    v_and_b32 v81, 0xffff0000, v48
    v_add_f32 v176, v176, v80
    v_add_f32 v177, v177, v81
    v_lshlrev_b32 v80, 16, v49
    v_and_b32 v81, 0xffff0000, v49
    v_add_f32 v178, v178, v80
    v_add_f32 v179, v179, v81
    v_lshlrev_b32 v80, 16, v50
    v_and_b32 v81, 0xffff0000, v50
    v_add_f32 v184, v184, v80
    v_add_f32 v185, v185, v81
    v_lshlrev_b32 v80, 16, v51
    v_and_b32 v81, 0xffff0000, v51
    v_add_f32 v186, v186, v80
    v_add_f32 v187, v187, v81
    v_lshlrev_b32 v80, 16, v52
    v_and_b32 v81, 0xffff0000, v52
    v_add_f32 v180, v180, v80
    v_add_f32 v181, v181, v81
    v_lshlrev_b32 v80, 16, v53
    v_and_b32 v81, 0xffff0000, v53
    v_add_f32 v182, v182, v80
    v_add_f32 v183, v183, v81
    v_lshlrev_b32 v80, 16, v54
    v_and_b32 v81, 0xffff0000, v54
    v_add_f32 v188, v188, v80
    v_add_f32 v189, v189, v81
    v_lshlrev_b32 v80, 16, v55
    v_and_b32 v81, 0xffff0000, v55
    v_add_f32 v190, v190, v80
    v_add_f32 v191, v191, v81
    s_waitcnt vmcnt(2)
    v_lshlrev_b32 v80, 16, v56
    v_and_b32 v81, 0xffff0000, v56
    v_add_f32 v176, v176, v80
    v_add_f32 v177, v177, v81
    v_lshlrev_b32 v80, 16, v57
    v_and_b32 v81, 0xffff0000, v57
    v_add_f32 v178, v178, v80
    v_add_f32 v179, v179, v81
    v_lshlrev_b32 v80, 16, v58
    v_and_b32 v81, 0xffff0000, v58
    v_add_f32 v184, v184, v80
    v_add_f32 v185, v185, v81
    v_lshlrev_b32 v80, 16, v59
    v_and_b32 v81, 0xffff0000, v59
    v_add_f32 v186, v186, v80
    v_add_f32 v187, v187, v81
    v_lshlrev_b32 v80, 16, v60
    v_and_b32 v81, 0xffff0000, v60
    v_add_f32 v180, v180, v80
    v_add_f32 v181, v181, v81
    v_lshlrev_b32 v80, 16, v61
    v_and_b32 v81, 0xffff0000, v61
    v_add_f32 v182, v182, v80
    v_add_f32 v183, v183, v81
    v_lshlrev_b32 v80, 16, v62
    v_and_b32 v81, 0xffff0000, v62
    v_add_f32 v188, v188, v80
    v_add_f32 v189, v189, v81
    v_lshlrev_b32 v80, 16, v63
    v_and_b32 v81, 0xffff0000, v63
    v_add_f32 v190, v190, v80
    v_add_f32 v191, v191, v81
    s_waitcnt vmcnt(0)
    v_lshlrev_b32 v80, 16, v64
    v_and_b32 v81, 0xffff0000, v64
    v_add_f32 v176, v176, v80
    v_add_f32 v177, v177, v81
    v_lshlrev_b32 v80, 16, v65
    v_and_b32 v81, 0xffff0000, v65
    v_add_f32 v178, v178, v80
    v_add_f32 v179, v179, v81
    v_lshlrev_b32 v80, 16, v66
    v_and_b32 v81, 0xffff0000, v66
    v_add_f32 v184, v184, v80
    v_add_f32 v185, v185, v81
    v_lshlrev_b32 v80, 16, v67
    v_and_b32 v81, 0xffff0000, v67
    v_add_f32 v186, v186, v80
    v_add_f32 v187, v187, v81
    v_lshlrev_b32 v80, 16, v68
    v_and_b32 v81, 0xffff0000, v68
    v_add_f32 v180, v180, v80
    v_add_f32 v181, v181, v81
    v_lshlrev_b32 v80, 16, v69
    v_and_b32 v81, 0xffff0000, v69
    v_add_f32 v182, v182, v80
    v_add_f32 v183, v183, v81
    v_lshlrev_b32 v80, 16, v70
    v_and_b32 v81, 0xffff0000, v70
    v_add_f32 v188, v188, v80
    v_add_f32 v189, v189, v81
    v_lshlrev_b32 v80, 16, v71
    v_and_b32 v81, 0xffff0000, v71
    v_add_f32 v190, v190, v80
    v_add_f32 v191, v191, v81
    v_cvt_pk_bf16_f32 v84, v176, v177
    v_cvt_pk_bf16_f32 v85, v178, v179
    v_cvt_pk_bf16_f32 v86, v184, v185
    v_cvt_pk_bf16_f32 v87, v186, v187
    v_cvt_pk_bf16_f32 v88, v180, v181
    v_cvt_pk_bf16_f32 v89, v182, v183
    v_cvt_pk_bf16_f32 v90, v188, v189
    v_cvt_pk_bf16_f32 v91, v190, v191
    s_nop 0
    v_permlane32_swap_b32 v84, v86
    v_permlane32_swap_b32 v85, v87
    v_permlane32_swap_b32 v88, v90
    v_permlane32_swap_b32 v89, v91
    v_permlane16_swap_b32 v84, v86
    v_permlane16_swap_b32 v85, v87
    v_permlane16_swap_b32 v88, v90
    v_permlane16_swap_b32 v89, v91
    buffer_store_dwordx4 v[84:87], v12, s[20:23], s3 offen
    s_add_u32 s3, s3, 0x4000
    buffer_store_dwordx4 v[88:91], v12, s[20:23], s3 offen
    s_endpgm
L_codeend:
L_fallback:
    s_mov_b32 s62, 1
    s_waitcnt vmcnt(0) lgkmcnt(0)
    s_mov_b32 s28, s6
    s_mov_b32 s29, s7
    s_mov_b32 s30, 262144
    s_mov_b32 s31, 0x20000
    s_mov_b32 s32, s8
    s_mov_b32 s33, s9
    s_mov_b32 s34, 262144
    s_mov_b32 s35, 0x20000
    v_add_u32 v9, 0, v3
    v_xor_b32 v9, v9, v4
    v_lshlrev_b32 v9, 4, v9
    v_lshl_add_u32 v28, v3, 8, v9
    v_add_u32 v9, 4, v3
    v_xor_b32 v9, v9, v4
    v_lshlrev_b32 v9, 4, v9
    v_lshl_add_u32 v29, v3, 8, v9
    v_add_u32 v9, 8, v3
    v_xor_b32 v9, v9, v4
    v_lshlrev_b32 v9, 4, v9
    v_lshl_add_u32 v30, v3, 8, v9
    v_add_u32 v9, 12, v3
    v_xor_b32 v9, v9, v4
    v_lshlrev_b32 v9, 4, v9
    v_lshl_add_u32 v31, v3, 8, v9
    v_add_u32 v9, 0, v3
    v_lshlrev_b32 v9, 1, v9
    v_xor_b32 v9, v9, v4
    v_lshlrev_b32 v9, 4, v9
    v_lshl_add_u32 v32, v3, 8, v9
    v_mov_b32 v34, v32
    v_add_u32 v9, 4, v3
    v_lshlrev_b32 v9, 1, v9
    v_xor_b32 v9, v9, v4
    v_lshlrev_b32 v9, 4, v9
    v_lshl_add_u32 v33, v3, 8, v9
    v_mov_b32 v35, v33
    v_mov_b32 v10, 0xff800000
    v_mov_b32 v11, 0xff800000
    v_mov_b32 v12, 0xff800000
    v_mov_b32 v13, 0xff800000
    s_mov_b32 s61, 0
    s_mov_b32 s65, s64
    s_mov_b32 m0, s64
    s_barrier
L_fb:
    buffer_load_dwordx4 v28, s[28:31], s65 offen offset:0 nt lds
    buffer_load_dwordx4 v29, s[28:31], s65 offen offset:1024 nt lds
    buffer_load_dwordx4 v30, s[28:31], s65 offen offset:2048 nt lds
    buffer_load_dwordx4 v31, s[28:31], s65 offen offset:3072 nt lds
    s_waitcnt vmcnt(0)
    s_barrier
    ds_read_b128 a[160:163], v16 offset:0
    ds_read_b128 a[164:167], v17 offset:0
    ds_read_b128 a[168:171], v18 offset:0
    ds_read_b128 a[172:175], v19 offset:0
    ds_read_b128 a[176:179], v16 offset:4096
    ds_read_b128 a[180:183], v17 offset:4096
    ds_read_b128 a[184:187], v18 offset:4096
    ds_read_b128 a[188:191], v19 offset:4096
    s_waitcnt lgkmcnt(0)
    v_mfma_f32_16x16x32_bf16 v[112:115], a[160:163], v[48:51], 0
    v_mfma_f32_16x16x32_bf16 v[112:115], a[164:167], v[52:55], v[112:115]
    v_mfma_f32_16x16x32_bf16 v[112:115], a[168:171], v[56:59], v[112:115]
    v_mfma_f32_16x16x32_bf16 v[112:115], a[172:175], v[60:63], v[112:115]
    v_mfma_f32_16x16x32_bf16 v[128:131], a[176:179], v[48:51], 0
    v_mfma_f32_16x16x32_bf16 v[128:131], a[180:183], v[52:55], v[128:131]
    v_mfma_f32_16x16x32_bf16 v[128:131], a[184:187], v[56:59], v[128:131]
    v_mfma_f32_16x16x32_bf16 v[128:131], a[188:191], v[60:63], v[128:131]
    v_mfma_f32_16x16x32_bf16 v[116:119], a[160:163], v[64:67], 0
    v_mfma_f32_16x16x32_bf16 v[116:119], a[164:167], v[68:71], v[116:119]
    v_mfma_f32_16x16x32_bf16 v[116:119], a[168:171], v[72:75], v[116:119]
    v_mfma_f32_16x16x32_bf16 v[116:119], a[172:175], v[76:79], v[116:119]
    v_mfma_f32_16x16x32_bf16 v[132:135], a[176:179], v[64:67], 0
    v_mfma_f32_16x16x32_bf16 v[132:135], a[180:183], v[68:71], v[132:135]
    v_mfma_f32_16x16x32_bf16 v[132:135], a[184:187], v[72:75], v[132:135]
    v_mfma_f32_16x16x32_bf16 v[132:135], a[188:191], v[76:79], v[132:135]
    v_mfma_f32_16x16x32_bf16 v[120:123], a[160:163], v[80:83], 0
    v_mfma_f32_16x16x32_bf16 v[120:123], a[164:167], v[84:87], v[120:123]
    v_mfma_f32_16x16x32_bf16 v[120:123], a[168:171], v[88:91], v[120:123]
    v_mfma_f32_16x16x32_bf16 v[120:123], a[172:175], v[92:95], v[120:123]
    v_mfma_f32_16x16x32_bf16 v[136:139], a[176:179], v[80:83], 0
    v_mfma_f32_16x16x32_bf16 v[136:139], a[180:183], v[84:87], v[136:139]
    v_mfma_f32_16x16x32_bf16 v[136:139], a[184:187], v[88:91], v[136:139]
    v_mfma_f32_16x16x32_bf16 v[136:139], a[188:191], v[92:95], v[136:139]
    v_mfma_f32_16x16x32_bf16 v[124:127], a[160:163], v[96:99], 0
    v_mfma_f32_16x16x32_bf16 v[124:127], a[164:167], v[100:103], v[124:127]
    v_mfma_f32_16x16x32_bf16 v[124:127], a[168:171], v[104:107], v[124:127]
    v_mfma_f32_16x16x32_bf16 v[124:127], a[172:175], v[108:111], v[124:127]
    v_mfma_f32_16x16x32_bf16 v[140:143], a[176:179], v[96:99], 0
    v_mfma_f32_16x16x32_bf16 v[140:143], a[180:183], v[100:103], v[140:143]
    v_mfma_f32_16x16x32_bf16 v[140:143], a[184:187], v[104:107], v[140:143]
    v_mfma_f32_16x16x32_bf16 v[140:143], a[188:191], v[108:111], v[140:143]
    s_nop 7
    v_max3_f32 v10, v10, v112, v113
    v_max3_f32 v10, v10, v114, v115
    v_max3_f32 v10, v10, v128, v129
    v_max3_f32 v10, v10, v130, v131
    v_max3_f32 v11, v11, v116, v117
    v_max3_f32 v11, v11, v118, v119
    v_max3_f32 v11, v11, v132, v133
    v_max3_f32 v11, v11, v134, v135
    v_max3_f32 v12, v12, v120, v121
    v_max3_f32 v12, v12, v122, v123
    v_max3_f32 v12, v12, v136, v137
    v_max3_f32 v12, v12, v138, v139
    v_max3_f32 v13, v13, v124, v125
    v_max3_f32 v13, v13, v126, v127
    v_max3_f32 v13, v13, v140, v141
    v_max3_f32 v13, v13, v142, v143
    ds_read_b128 a[160:163], v16 offset:8192
    ds_read_b128 a[164:167], v17 offset:8192
    ds_read_b128 a[168:171], v18 offset:8192
    ds_read_b128 a[172:175], v19 offset:8192
    ds_read_b128 a[176:179], v16 offset:12288
    ds_read_b128 a[180:183], v17 offset:12288
    ds_read_b128 a[184:187], v18 offset:12288
    ds_read_b128 a[188:191], v19 offset:12288
    s_waitcnt lgkmcnt(0)
    v_mfma_f32_16x16x32_bf16 v[112:115], a[160:163], v[48:51], 0
    v_mfma_f32_16x16x32_bf16 v[112:115], a[164:167], v[52:55], v[112:115]
    v_mfma_f32_16x16x32_bf16 v[112:115], a[168:171], v[56:59], v[112:115]
    v_mfma_f32_16x16x32_bf16 v[112:115], a[172:175], v[60:63], v[112:115]
    v_mfma_f32_16x16x32_bf16 v[128:131], a[176:179], v[48:51], 0
    v_mfma_f32_16x16x32_bf16 v[128:131], a[180:183], v[52:55], v[128:131]
    v_mfma_f32_16x16x32_bf16 v[128:131], a[184:187], v[56:59], v[128:131]
    v_mfma_f32_16x16x32_bf16 v[128:131], a[188:191], v[60:63], v[128:131]
    v_mfma_f32_16x16x32_bf16 v[116:119], a[160:163], v[64:67], 0
    v_mfma_f32_16x16x32_bf16 v[116:119], a[164:167], v[68:71], v[116:119]
    v_mfma_f32_16x16x32_bf16 v[116:119], a[168:171], v[72:75], v[116:119]
    v_mfma_f32_16x16x32_bf16 v[116:119], a[172:175], v[76:79], v[116:119]
    v_mfma_f32_16x16x32_bf16 v[132:135], a[176:179], v[64:67], 0
    v_mfma_f32_16x16x32_bf16 v[132:135], a[180:183], v[68:71], v[132:135]
    v_mfma_f32_16x16x32_bf16 v[132:135], a[184:187], v[72:75], v[132:135]
    v_mfma_f32_16x16x32_bf16 v[132:135], a[188:191], v[76:79], v[132:135]
    v_mfma_f32_16x16x32_bf16 v[120:123], a[160:163], v[80:83], 0
    v_mfma_f32_16x16x32_bf16 v[120:123], a[164:167], v[84:87], v[120:123]
    v_mfma_f32_16x16x32_bf16 v[120:123], a[168:171], v[88:91], v[120:123]
    v_mfma_f32_16x16x32_bf16 v[120:123], a[172:175], v[92:95], v[120:123]
    v_mfma_f32_16x16x32_bf16 v[136:139], a[176:179], v[80:83], 0
    v_mfma_f32_16x16x32_bf16 v[136:139], a[180:183], v[84:87], v[136:139]
    v_mfma_f32_16x16x32_bf16 v[136:139], a[184:187], v[88:91], v[136:139]
    v_mfma_f32_16x16x32_bf16 v[136:139], a[188:191], v[92:95], v[136:139]
    v_mfma_f32_16x16x32_bf16 v[124:127], a[160:163], v[96:99], 0
    v_mfma_f32_16x16x32_bf16 v[124:127], a[164:167], v[100:103], v[124:127]
    v_mfma_f32_16x16x32_bf16 v[124:127], a[168:171], v[104:107], v[124:127]
    v_mfma_f32_16x16x32_bf16 v[124:127], a[172:175], v[108:111], v[124:127]
    v_mfma_f32_16x16x32_bf16 v[140:143], a[176:179], v[96:99], 0
    v_mfma_f32_16x16x32_bf16 v[140:143], a[180:183], v[100:103], v[140:143]
    v_mfma_f32_16x16x32_bf16 v[140:143], a[184:187], v[104:107], v[140:143]
    v_mfma_f32_16x16x32_bf16 v[140:143], a[188:191], v[108:111], v[140:143]
    s_nop 7
    v_max3_f32 v10, v10, v112, v113
    v_max3_f32 v10, v10, v114, v115
    v_max3_f32 v10, v10, v128, v129
    v_max3_f32 v10, v10, v130, v131
    v_max3_f32 v11, v11, v116, v117
    v_max3_f32 v11, v11, v118, v119
    v_max3_f32 v11, v11, v132, v133
    v_max3_f32 v11, v11, v134, v135
    v_max3_f32 v12, v12, v120, v121
    v_max3_f32 v12, v12, v122, v123
    v_max3_f32 v12, v12, v136, v137
    v_max3_f32 v12, v12, v138, v139
    v_max3_f32 v13, v13, v124, v125
    v_max3_f32 v13, v13, v126, v127
    v_max3_f32 v13, v13, v140, v141
    v_max3_f32 v13, v13, v142, v143
    s_barrier
    s_add_u32 s65, s65, 0x4000
    s_add_u32 s61, s61, 1
    s_cmp_lt_u32 s61, 16
    s_cbranch_scc1 L_fb
    v_mov_b32 v9, v10
    s_nop 1
    v_permlane16_swap_b32 v10, v9
    s_nop 0
    v_max_f32 v10, v10, v9
    v_mov_b32 v9, v10
    s_nop 1
    v_permlane32_swap_b32 v10, v9
    s_nop 0
    v_max_f32 v10, v10, v9
    v_sub_f32 v176, 0, v10
    v_sub_f32 v177, 0, v10
    v_sub_f32 v178, 0, v10
    v_sub_f32 v179, 0, v10
    v_mov_b32 v9, v11
    s_nop 1
    v_permlane16_swap_b32 v11, v9
    s_nop 0
    v_max_f32 v11, v11, v9
    v_mov_b32 v9, v11
    s_nop 1
    v_permlane32_swap_b32 v11, v9
    s_nop 0
    v_max_f32 v11, v11, v9
    v_sub_f32 v180, 0, v11
    v_sub_f32 v181, 0, v11
    v_sub_f32 v182, 0, v11
    v_sub_f32 v183, 0, v11
    v_mov_b32 v9, v12
    s_nop 1
    v_permlane16_swap_b32 v12, v9
    s_nop 0
    v_max_f32 v12, v12, v9
    v_mov_b32 v9, v12
    s_nop 1
    v_permlane32_swap_b32 v12, v9
    s_nop 0
    v_max_f32 v12, v12, v9
    v_sub_f32 v184, 0, v12
    v_sub_f32 v185, 0, v12
    v_sub_f32 v186, 0, v12
    v_sub_f32 v187, 0, v12
    v_mov_b32 v9, v13
    s_nop 1
    v_permlane16_swap_b32 v13, v9
    s_nop 0
    v_max_f32 v13, v13, v9
    v_mov_b32 v9, v13
    s_nop 1
    v_permlane32_swap_b32 v13, v9
    s_nop 0
    v_max_f32 v13, v13, v9
    v_sub_f32 v188, 0, v13
    v_sub_f32 v189, 0, v13
    v_sub_f32 v190, 0, v13
    v_sub_f32 v191, 0, v13
    v_accvgpr_write_b32 a0, 0
    v_accvgpr_write_b32 a1, 0
    v_accvgpr_write_b32 a2, 0
    v_accvgpr_write_b32 a3, 0
    v_accvgpr_write_b32 a4, 0
    v_accvgpr_write_b32 a5, 0
    v_accvgpr_write_b32 a6, 0
    v_accvgpr_write_b32 a7, 0
    v_accvgpr_write_b32 a8, 0
    v_accvgpr_write_b32 a9, 0
    v_accvgpr_write_b32 a10, 0
    v_accvgpr_write_b32 a11, 0
    v_accvgpr_write_b32 a12, 0
    v_accvgpr_write_b32 a13, 0
    v_accvgpr_write_b32 a14, 0
    v_accvgpr_write_b32 a15, 0
    v_accvgpr_write_b32 a16, 0
    v_accvgpr_write_b32 a17, 0
    v_accvgpr_write_b32 a18, 0
    v_accvgpr_write_b32 a19, 0
    v_accvgpr_write_b32 a20, 0
    v_accvgpr_write_b32 a21, 0
    v_accvgpr_write_b32 a22, 0
    v_accvgpr_write_b32 a23, 0
    v_accvgpr_write_b32 a24, 0
    v_accvgpr_write_b32 a25, 0
    v_accvgpr_write_b32 a26, 0
    v_accvgpr_write_b32 a27, 0
    v_accvgpr_write_b32 a28, 0
    v_accvgpr_write_b32 a29, 0
    v_accvgpr_write_b32 a30, 0
    v_accvgpr_write_b32 a31, 0
    v_accvgpr_write_b32 a32, 0
    v_accvgpr_write_b32 a33, 0
    v_accvgpr_write_b32 a34, 0
    v_accvgpr_write_b32 a35, 0
    v_accvgpr_write_b32 a36, 0
    v_accvgpr_write_b32 a37, 0
    v_accvgpr_write_b32 a38, 0
    v_accvgpr_write_b32 a39, 0
    v_accvgpr_write_b32 a40, 0
    v_accvgpr_write_b32 a41, 0
    v_accvgpr_write_b32 a42, 0
    v_accvgpr_write_b32 a43, 0
    v_accvgpr_write_b32 a44, 0
    v_accvgpr_write_b32 a45, 0
    v_accvgpr_write_b32 a46, 0
    v_accvgpr_write_b32 a47, 0
    v_accvgpr_write_b32 a48, 0
    v_accvgpr_write_b32 a49, 0
    v_accvgpr_write_b32 a50, 0
    v_accvgpr_write_b32 a51, 0
    v_accvgpr_write_b32 a52, 0
    v_accvgpr_write_b32 a53, 0
    v_accvgpr_write_b32 a54, 0
    v_accvgpr_write_b32 a55, 0
    v_accvgpr_write_b32 a56, 0
    v_accvgpr_write_b32 a57, 0
    v_accvgpr_write_b32 a58, 0
    v_accvgpr_write_b32 a59, 0
    v_accvgpr_write_b32 a60, 0
    v_accvgpr_write_b32 a61, 0
    v_accvgpr_write_b32 a62, 0
    v_accvgpr_write_b32 a63, 0
    v_accvgpr_write_b32 a64, 0
    v_accvgpr_write_b32 a65, 0
    v_accvgpr_write_b32 a66, 0
    v_accvgpr_write_b32 a67, 0
    v_accvgpr_write_b32 a68, 0
    v_accvgpr_write_b32 a69, 0
    v_accvgpr_write_b32 a70, 0
    v_accvgpr_write_b32 a71, 0
    v_accvgpr_write_b32 a72, 0
    v_accvgpr_write_b32 a73, 0
    v_accvgpr_write_b32 a74, 0
    v_accvgpr_write_b32 a75, 0
    v_accvgpr_write_b32 a76, 0
    v_accvgpr_write_b32 a77, 0
    v_accvgpr_write_b32 a78, 0
    v_accvgpr_write_b32 a79, 0
    v_accvgpr_write_b32 a80, 0
    v_accvgpr_write_b32 a81, 0
    v_accvgpr_write_b32 a82, 0
    v_accvgpr_write_b32 a83, 0
    v_accvgpr_write_b32 a84, 0
    v_accvgpr_write_b32 a85, 0
    v_accvgpr_write_b32 a86, 0
    v_accvgpr_write_b32 a87, 0
    v_accvgpr_write_b32 a88, 0
    v_accvgpr_write_b32 a89, 0
    v_accvgpr_write_b32 a90, 0
    v_accvgpr_write_b32 a91, 0
    v_accvgpr_write_b32 a92, 0
    v_accvgpr_write_b32 a93, 0
    v_accvgpr_write_b32 a94, 0
    v_accvgpr_write_b32 a95, 0
    v_accvgpr_write_b32 a96, 0
    v_accvgpr_write_b32 a97, 0
    v_accvgpr_write_b32 a98, 0
    v_accvgpr_write_b32 a99, 0
    v_accvgpr_write_b32 a100, 0
    v_accvgpr_write_b32 a101, 0
    v_accvgpr_write_b32 a102, 0
    v_accvgpr_write_b32 a103, 0
    v_accvgpr_write_b32 a104, 0
    v_accvgpr_write_b32 a105, 0
    v_accvgpr_write_b32 a106, 0
    v_accvgpr_write_b32 a107, 0
    v_accvgpr_write_b32 a108, 0
    v_accvgpr_write_b32 a109, 0
    v_accvgpr_write_b32 a110, 0
    v_accvgpr_write_b32 a111, 0
    v_accvgpr_write_b32 a112, 0
    v_accvgpr_write_b32 a113, 0
    v_accvgpr_write_b32 a114, 0
    v_accvgpr_write_b32 a115, 0
    v_accvgpr_write_b32 a116, 0
    v_accvgpr_write_b32 a117, 0
    v_accvgpr_write_b32 a118, 0
    v_accvgpr_write_b32 a119, 0
    v_accvgpr_write_b32 a120, 0
    v_accvgpr_write_b32 a121, 0
    v_accvgpr_write_b32 a122, 0
    v_accvgpr_write_b32 a123, 0
    v_accvgpr_write_b32 a124, 0
    v_accvgpr_write_b32 a125, 0
    v_accvgpr_write_b32 a126, 0
    v_accvgpr_write_b32 a127, 0
    v_accvgpr_write_b32 a128, 0
    v_accvgpr_write_b32 a129, 0
    v_accvgpr_write_b32 a130, 0
    v_accvgpr_write_b32 a131, 0
    v_accvgpr_write_b32 a132, 0
    v_accvgpr_write_b32 a133, 0
    v_accvgpr_write_b32 a134, 0
    v_accvgpr_write_b32 a135, 0
    v_accvgpr_write_b32 a136, 0
    v_accvgpr_write_b32 a137, 0
    v_accvgpr_write_b32 a138, 0
    v_accvgpr_write_b32 a139, 0
    v_accvgpr_write_b32 a140, 0
    v_accvgpr_write_b32 a141, 0
    v_accvgpr_write_b32 a142, 0
    v_accvgpr_write_b32 a143, 0
    s_add_u32 m0, s64, 0
    s_add_u32 s65, s64, 0
    buffer_load_dwordx4 v28, s[28:31], s65 offen offset:0 nt lds
    buffer_load_dwordx4 v29, s[28:31], s65 offen offset:1024 nt lds
    buffer_load_dwordx4 v30, s[28:31], s65 offen offset:2048 nt lds
    buffer_load_dwordx4 v31, s[28:31], s65 offen offset:3072 nt lds
    s_add_u32 m0, s64, 16384
    s_add_u32 s65, s64, 16384
    buffer_load_dwordx4 v28, s[28:31], s65 offen offset:0 nt lds
    buffer_load_dwordx4 v29, s[28:31], s65 offen offset:1024 nt lds
    buffer_load_dwordx4 v30, s[28:31], s65 offen offset:2048 nt lds
    buffer_load_dwordx4 v31, s[28:31], s65 offen offset:3072 nt lds
    s_add_u32 m0, s64, 65536
    s_add_u32 s66, s64, 0
    buffer_load_dwordx4 v32, s[32:35], s66 offen offset:0 nt lds
    buffer_load_dwordx4 v33, s[32:35], s66 offen offset:1024 nt lds
    buffer_load_dwordx4 v34, s[32:35], s66 offen offset:2048 nt lds
    buffer_load_dwordx4 v35, s[32:35], s66 offen offset:3072 nt lds
    s_add_u32 m0, s64, 81920
    s_add_u32 s66, s64, 16384
    buffer_load_dwordx4 v32, s[32:35], s66 offen offset:0 nt lds
    buffer_load_dwordx4 v33, s[32:35], s66 offen offset:1024 nt lds
    buffer_load_dwordx4 v34, s[32:35], s66 offen offset:2048 nt lds
    buffer_load_dwordx4 v35, s[32:35], s66 offen offset:3072 nt lds
    s_add_u32 m0, s64, 49152
    s_add_u32 s65, s64, 32768
    buffer_load_dwordx4 v28, s[28:31], s65 offen offset:0 nt lds
    buffer_load_dwordx4 v29, s[28:31], s65 offen offset:1024 nt lds
    buffer_load_dwordx4 v30, s[28:31], s65 offen offset:2048 nt lds
    buffer_load_dwordx4 v31, s[28:31], s65 offen offset:3072 nt lds
    s_add_u32 m0, s64, 32768
    s_add_u32 s65, s64, 49152
    buffer_load_dwordx4 v28, s[28:31], s65 offen offset:0 nt lds
    buffer_load_dwordx4 v29, s[28:31], s65 offen offset:1024 nt lds
    buffer_load_dwordx4 v30, s[28:31], s65 offen offset:2048 nt lds
    buffer_load_dwordx4 v31, s[28:31], s65 offen offset:3072 nt lds
    s_add_u32 m0, s64, 114688
    s_add_u32 s66, s64, 32768
    buffer_load_dwordx4 v32, s[32:35], s66 offen offset:0 nt lds
    buffer_load_dwordx4 v33, s[32:35], s66 offen offset:1024 nt lds
    buffer_load_dwordx4 v34, s[32:35], s66 offen offset:2048 nt lds
    buffer_load_dwordx4 v35, s[32:35], s66 offen offset:3072 nt lds
    s_waitcnt vmcnt(0)
    s_barrier
    ds_read_b128 a[160:163], v16 offset:0
    ds_read_b128 a[164:167], v17 offset:0
    ds_read_b128 a[168:171], v18 offset:0
    ds_read_b128 a[172:175], v19 offset:0
    ds_read_b128 a[176:179], v16 offset:4096
    ds_read_b128 a[180:183], v17 offset:4096
    ds_read_b128 a[184:187], v18 offset:4096
    ds_read_b128 a[188:191], v19 offset:4096
    v_mov_b32 v14, 0x3f803f80
    v_accvgpr_write_b32 a144, v14
    v_accvgpr_write_b32 a145, v14
    v_accvgpr_write_b32 a146, v14
    v_accvgpr_write_b32 a147, v14
    s_mov_b32 s60, 0x4000
    s_mov_b32 s61, 0
    s_mov_b32 s49, 0
    s_mov_b32 s44, 0
    s_mov_b32 s45, 0x1000
    s_mov_b32 s46, 0x2000
    s_mov_b32 s47, 0x3000

    s_waitcnt lgkmcnt(0)
    v_mfma_f32_16x16x32_bf16 v[112:115], a[160:163], v[48:51], v[176:179]
    v_mfma_f32_16x16x32_bf16 v[112:115], a[164:167], v[52:55], v[112:115]
    v_mfma_f32_16x16x32_bf16 v[112:115], a[168:171], v[56:59], v[112:115]
    v_mfma_f32_16x16x32_bf16 v[112:115], a[172:175], v[60:63], v[112:115]
    v_mfma_f32_16x16x32_bf16 v[128:131], a[176:179], v[48:51], v[176:179]
    v_mfma_f32_16x16x32_bf16 v[128:131], a[180:183], v[52:55], v[128:131]
    v_mfma_f32_16x16x32_bf16 v[128:131], a[184:187], v[56:59], v[128:131]
    v_mfma_f32_16x16x32_bf16 v[128:131], a[188:191], v[60:63], v[128:131]
    v_mfma_f32_16x16x32_bf16 v[116:119], a[160:163], v[64:67], v[180:183]
    v_mfma_f32_16x16x32_bf16 v[116:119], a[164:167], v[68:71], v[116:119]
    v_mfma_f32_16x16x32_bf16 v[116:119], a[168:171], v[72:75], v[116:119]
    v_mfma_f32_16x16x32_bf16 v[116:119], a[172:175], v[76:79], v[116:119]
    v_mfma_f32_16x16x32_bf16 v[132:135], a[176:179], v[64:67], v[180:183]
    v_mfma_f32_16x16x32_bf16 v[132:135], a[180:183], v[68:71], v[132:135]
    v_mfma_f32_16x16x32_bf16 v[132:135], a[184:187], v[72:75], v[132:135]
    v_mfma_f32_16x16x32_bf16 v[132:135], a[188:191], v[76:79], v[132:135]
    v_mfma_f32_16x16x32_bf16 v[120:123], a[160:163], v[80:83], v[184:187]
    v_mfma_f32_16x16x32_bf16 v[120:123], a[164:167], v[84:87], v[120:123]
    v_mfma_f32_16x16x32_bf16 v[120:123], a[168:171], v[88:91], v[120:123]
    v_mfma_f32_16x16x32_bf16 v[120:123], a[172:175], v[92:95], v[120:123]
    v_mfma_f32_16x16x32_bf16 v[136:139], a[176:179], v[80:83], v[184:187]
    v_mfma_f32_16x16x32_bf16 v[136:139], a[180:183], v[84:87], v[136:139]
    v_mfma_f32_16x16x32_bf16 v[136:139], a[184:187], v[88:91], v[136:139]
    v_mfma_f32_16x16x32_bf16 v[136:139], a[188:191], v[92:95], v[136:139]
    v_mfma_f32_16x16x32_bf16 v[124:127], a[160:163], v[96:99], v[188:191]
    v_mfma_f32_16x16x32_bf16 v[124:127], a[164:167], v[100:103], v[124:127]
    v_mfma_f32_16x16x32_bf16 v[124:127], a[168:171], v[104:107], v[124:127]
    v_mfma_f32_16x16x32_bf16 v[124:127], a[172:175], v[108:111], v[124:127]
    v_mfma_f32_16x16x32_bf16 v[140:143], a[176:179], v[96:99], v[188:191]
    v_mfma_f32_16x16x32_bf16 v[140:143], a[180:183], v[100:103], v[140:143]
    v_mfma_f32_16x16x32_bf16 v[140:143], a[184:187], v[104:107], v[140:143]
    v_mfma_f32_16x16x32_bf16 v[140:143], a[188:191], v[108:111], v[140:143]
    ds_read_b128 a[160:163], v16 offset:8192
    ds_read_b128 a[164:167], v17 offset:8192
    ds_read_b128 a[168:171], v18 offset:8192
    ds_read_b128 a[172:175], v19 offset:8192
    ds_read_b128 a[176:179], v16 offset:12288
    ds_read_b128 a[180:183], v17 offset:12288
    ds_read_b128 a[184:187], v18 offset:12288
    ds_read_b128 a[188:191], v19 offset:12288
    v_exp_f32 v112, v112
    v_exp_f32 v113, v113
    v_exp_f32 v114, v114
    v_exp_f32 v115, v115
    v_exp_f32 v128, v128
    v_exp_f32 v129, v129
    v_exp_f32 v130, v130
    v_exp_f32 v131, v131
    v_exp_f32 v116, v116
    v_exp_f32 v117, v117
    v_exp_f32 v118, v118
    v_exp_f32 v119, v119
    v_exp_f32 v132, v132
    v_exp_f32 v133, v133
    v_exp_f32 v134, v134
    v_exp_f32 v135, v135
    v_exp_f32 v120, v120
    v_exp_f32 v121, v121
    v_exp_f32 v122, v122
    v_exp_f32 v123, v123
    v_exp_f32 v136, v136
    v_exp_f32 v137, v137
    v_exp_f32 v138, v138
    v_exp_f32 v139, v139
    v_exp_f32 v124, v124
    v_exp_f32 v125, v125
    v_exp_f32 v126, v126
    v_cvt_pk_bf16_f32 v144, v112, v113
    v_cvt_pk_bf16_f32 v145, v114, v115
    v_cvt_pk_bf16_f32 v146, v128, v129
    v_cvt_pk_bf16_f32 v147, v130, v131
    v_cvt_pk_bf16_f32 v152, v116, v117
    v_cvt_pk_bf16_f32 v153, v118, v119
    v_cvt_pk_bf16_f32 v154, v132, v133
    v_cvt_pk_bf16_f32 v155, v134, v135
    v_cvt_pk_bf16_f32 v160, v120, v121
    v_cvt_pk_bf16_f32 v161, v122, v123
    v_cvt_pk_bf16_f32 v162, v136, v137
    v_cvt_pk_bf16_f32 v163, v138, v139
    v_cvt_pk_bf16_f32 v168, v124, v125
    s_cmp_lg_u32 s40, 3
    s_cbranch_scc1 L_rolesC
    v_lshlrev_b32 v13, 2, v2
    v_add_u32 v39, 156416, v13
    v_add_u32 v13, 155648, v13
    v_mov_b32 v36, -1
    v_mov_b32 v40, -1
    ds_write_b32 v13, v36 offset:0
    ds_write_b32 v13, v36 offset:256
    ds_write_b32 v13, v36 offset:512
    v_mov_b32 v38, 0
    ds_write_b32 v13, v38 offset:1024
    v_mov_b32 v38, 3
    ds_write_b32 v39, v38
    v_mov_b32 v38, 3
    s_branch L_loader
L_end:
    s_endpgm
.section .rodata,"a"
.p2align 6
.amdhsa_kernel standalone__mha_block_cached__near_ridge_kernel
  .amdhsa_next_free_vgpr 512
  .amdhsa_next_free_sgpr 102
  .amdhsa_accum_offset 256
  .amdhsa_group_segment_fixed_size 0
  .amdhsa_kernarg_size 64
  .amdhsa_user_sgpr_count 2
  .amdhsa_user_sgpr_kernarg_segment_ptr 1
  .amdhsa_system_sgpr_workgroup_id_x 1
.end_amdhsa_kernel
```
